```python
import torch

def _softmax(x, axis=-1):
    return torch.softmax(x, dim=axis)
def _gelu(x):
    return torch.nn.functional.gelu(x, approximate="tanh")
def _silu(x):
    return torch.nn.functional.silu(x)
def _sigmoid(x):
    return torch.sigmoid(x)
def _layernorm(x, axis=-1, eps=1e-5):
    m = x.mean(dim=axis, keepdim=True)
    v = x.var(dim=axis, keepdim=True, unbiased=False)
    return (x - m) / torch.sqrt(v + eps)
def _scatter_add(tgt, idx, src, axis=0):
    return tgt.clone().index_add_(axis, idx, src)
def _segment_sum(src, seg, n):
    out = torch.zeros((n,) + src.shape[1:], dtype=src.dtype)
    return out.index_add_(0, seg, src)
def _pad(x, pw):
    flat = tuple(v for pair in reversed(pw) for v in pair)
    return torch.nn.functional.pad(x, flat)

kernel_name = 'standalone__gqa_softmax__near_ridge'

def setup_inputs():

    _w = (lambda a: (lambda t: t.to(torch.bfloat16) if t.is_floating_point() else t)(torch.as_tensor(a)))
    B, Hq, Hkv, Sq, Sk, D = 16, 32, 32, 512, 512, 128
    return {
        "q": _w((lambda *s: torch.randn(*s, dtype=torch.bfloat16) * 0.8)(B, Hq, Sq, D)),
        "k": _w((lambda *s: torch.randn(*s, dtype=torch.bfloat16) * 0.8)(B, Hkv, Sk, D)),
        "v": _w((lambda *s: torch.randn(*s, dtype=torch.bfloat16) * 0.05)(B, Hkv, Sk, D)),
    }

def reference(q, k, v):
    B, Hq, Sq, D = q.shape
    Hkv = k.shape[1]
    rep = Hq // Hkv
    k = (lambda x, n, axis: torch.repeat_interleave(x, n, dim=axis))(k, rep, axis=1)
    v = (lambda x, n, axis: torch.repeat_interleave(x, n, dim=axis))(v, rep, axis=1)
    scale = D ** -0.5
    scores = torch.einsum("bhqd,bhkd->bhqk", q, k) * scale
    p = _softmax(scores, axis=-1)
    return torch.einsum("bhqk,bhkd->bhqd", p, v)
```

```asm
; @launch grid=(256,1,1) block=(256,1,1) lds=163840
.amdgcn_target "amdgcn-amd-amdhsa--gfx950"
.text
.globl standalone__gqa_softmax__near_ridge_kernel
.p2align 8
.type standalone__gqa_softmax__near_ridge_kernel,@function
standalone__gqa_softmax__near_ridge_kernel:
  s_cmp_ge_u32 s2, 256
  s_cbranch_scc1 DONE
  s_load_dwordx4 s[36:39], s[0:1], 0
  s_load_dwordx4 s[40:43], s[0:1], 16
  v_lshrrev_b32 v1, 6, v0
  s_nop 0
  v_readfirstlane_b32 s34, v1
  v_and_b32 v0, 63, v0
  v_and_b32 v3, 15, v0
  v_lshrrev_b32 v1, 4, v0
  v_lshlrev_b32 v2, 8, v1
  v_or_b32 v4, 0, v1
  v_xor_b32 v4, v4, v3
  v_lshl_add_u32 v250, v4, 4, v2
  v_or_b32 v4, 4, v1
  v_xor_b32 v4, v4, v3
  v_lshl_add_u32 v251, v4, 4, v2
  v_or_b32 v4, 8, v1
  v_xor_b32 v4, v4, v3
  v_lshl_add_u32 v252, v4, 4, v2
  v_or_b32 v4, 12, v1
  v_xor_b32 v4, v4, v3
  v_lshl_add_u32 v253, v4, 4, v2
  v_lshrrev_b32 v4, 2, v3
  v_xor_b32 v4, v4, v1
  v_lshl_add_u32 v4, v4, 6, v2
  v_and_b32 v1, 3, v0
  v_lshl_add_u32 v254, v1, 4, v4
  s_and_b32 s35, s2, 7
  s_lshr_b32 s44, s2, 3
  s_and_b32 s45, s44, 1
  s_lshr_b32 s44, s44, 1
  s_mov_b32 s51, 0
  s_lshl_b32 s35, s35, 4
  s_add_u32 s35, s35, s44
  s_lshl_b32 s35, s35, 17
  s_lshl_b32 s20, s34, 12
  s_lshl_b32 s30, s34, 13
  s_add_u32 s30, s30, 131072
  s_lshl_b32 s45, s45, 16
  s_lshl_b32 s44, s34, 14
  s_add_u32 s45, s45, s44
  s_add_u32 s23, s35, s45
  s_mov_b32 s24, 0x7f000000
  s_mov_b32 s84, 0x3f803f80
  s_mov_b32 s28, 0x3e0293ee
  s_mov_b32 s29, 0x44800000
  s_mov_b32 s27, -1
  s_mov_b32 s49, 0xfe4000
  s_mov_b32 s50, 0x4000
  s_cmp_ge_u32 s34, 2
  s_cselect_b32 s25, s49, s50
  s_cselect_b32 s26, s50, s49
  v_lshrrev_b32 v1, 3, v0
  v_and_b32 v2, 7, v0
  v_lshlrev_b32 v1, 8, v1
  v_lshl_add_u32 v255, v2, 4, v1
  s_mov_b32 s80, 0x7f000000
  s_mov_b32 s81, 0x7f000000
  s_mov_b32 s82, 0x7f000000
  s_mov_b32 s83, 0x7f000000
  s_waitcnt lgkmcnt(0)
  s_mov_b32 s4, s36
  s_and_b32 s5, s37, 0xffff
  s_mov_b32 s6, 0x4000000
  s_mov_b32 s7, 0x20000
  s_mov_b32 s8, s38
  s_and_b32 s9, s39, 0xffff
  s_mov_b32 s10, 0x4000000
  s_mov_b32 s11, 0x20000
  s_mov_b32 s12, s40
  s_and_b32 s13, s41, 0xffff
  s_mov_b32 s14, 0x4000000
  s_mov_b32 s15, 0x20000
  s_mov_b32 s16, s42
  s_and_b32 s17, s43, 0xffff
  s_mov_b32 s18, 0x4000000
  s_mov_b32 s19, 0x20000
  s_lshl_b32 s46, s34, 13
  s_add_u32 s46, s46, 98304
  s_add_u32 s31, s23, 0
  s_add_u32 m0, s30, 0
  s_nop 0
  buffer_load_dwordx4 v250, s[4:7], s31 offen offset:0 nt lds
  buffer_load_dwordx4 v251, s[4:7], s31 offen offset:1024 nt lds
  buffer_load_dwordx4 v252, s[4:7], s31 offen offset:2048 nt lds
  buffer_load_dwordx4 v253, s[4:7], s31 offen offset:3072 nt lds
  s_add_u32 s31, s23, 4096
  s_add_u32 m0, s30, 4096
  s_nop 0
  buffer_load_dwordx4 v250, s[4:7], s31 offen offset:0 nt lds
  buffer_load_dwordx4 v251, s[4:7], s31 offen offset:1024 nt lds
  buffer_load_dwordx4 v252, s[4:7], s31 offen offset:2048 nt lds
  buffer_load_dwordx4 v253, s[4:7], s31 offen offset:3072 nt lds
  s_add_u32 s31, s23, 8192
  s_add_u32 m0, s46, 0
  s_nop 0
  buffer_load_dwordx4 v250, s[4:7], s31 offen offset:0 nt lds
  buffer_load_dwordx4 v251, s[4:7], s31 offen offset:1024 nt lds
  buffer_load_dwordx4 v252, s[4:7], s31 offen offset:2048 nt lds
  buffer_load_dwordx4 v253, s[4:7], s31 offen offset:3072 nt lds
  s_add_u32 s31, s23, 12288
  s_add_u32 m0, s46, 4096
  s_nop 0
  buffer_load_dwordx4 v250, s[4:7], s31 offen offset:0 nt lds
  buffer_load_dwordx4 v251, s[4:7], s31 offen offset:1024 nt lds
  buffer_load_dwordx4 v252, s[4:7], s31 offen offset:2048 nt lds
  buffer_load_dwordx4 v253, s[4:7], s31 offen offset:3072 nt lds
  s_and_b32 s47, s34, 1
  s_lshl_b32 s47, s47, 7
  s_nop 0
  v_xor_b32 v5, s47, v250
  v_xor_b32 v6, s47, v251
  s_lshl_b32 s47, s34, 11
  s_add_u32 s31, s35, s47
  s_add_u32 s31, s31, s51
  s_add_u32 m0, s47, 8192
  s_nop 0
  buffer_load_dwordx4 v5, s[8:11], s31 offen offset:0 nt lds
  buffer_load_dwordx4 v6, s[8:11], s31 offen offset:1024 nt lds
  s_lshr_b32 s47, s34, 1
  s_add_u32 s47, s47, 1
  s_lshl_b32 s47, s47, 13
  s_and_b32 s48, s34, 1
  s_lshl_b32 s48, s48, 12
  s_add_u32 s60, s47, s48
  s_add_u32 s60, s60, s51
  s_and_b32 s60, s60, 0x1ffff
  s_add_u32 s62, s20, s51
  s_mov_b32 s61, s35
  s_mov_b32 s63, s35
  s_add_u32 s21, s61, s60
  s_add_u32 s22, s63, s62
  s_add_u32 m0, s20, 16384
  s_nop 0
  buffer_load_dwordx4 v250, s[8:11], s21 offen offset:0 nt lds
  buffer_load_dwordx4 v251, s[8:11], s21 offen offset:1024 nt lds
  buffer_load_dwordx4 v252, s[8:11], s21 offen offset:2048 nt lds
  buffer_load_dwordx4 v253, s[8:11], s21 offen offset:3072 nt lds
  s_add_u32 m0, s20, 65536
  s_nop 0
  buffer_load_dwordx4 v254, s[12:15], s22 offen offset:0 nt lds
  buffer_load_dwordx4 v254, s[12:15], s22 offen offset:1024 nt lds
  buffer_load_dwordx4 v254, s[12:15], s22 offen offset:2048 nt lds
  buffer_load_dwordx4 v254, s[12:15], s22 offen offset:3072 nt lds
  s_add_u32 s21, s21, 0x4000
  s_add_u32 m0, s20, 32768
  s_nop 0
  buffer_load_dwordx4 v250, s[8:11], s21 offen offset:0 nt lds
  buffer_load_dwordx4 v251, s[8:11], s21 offen offset:1024 nt lds
  buffer_load_dwordx4 v252, s[8:11], s21 offen offset:2048 nt lds
  buffer_load_dwordx4 v253, s[8:11], s21 offen offset:3072 nt lds
  s_add_u32 s22, s22, 0x4000
  s_add_u32 m0, s20, 81920
  s_nop 0
  buffer_load_dwordx4 v254, s[12:15], s22 offen offset:0 nt lds
  buffer_load_dwordx4 v254, s[12:15], s22 offen offset:1024 nt lds
  buffer_load_dwordx4 v254, s[12:15], s22 offen offset:2048 nt lds
  buffer_load_dwordx4 v254, s[12:15], s22 offen offset:3072 nt lds
  v_and_b32 v1, 31, v0
  v_lshrrev_b32 v2, 5, v0
  v_and_b32 v3, 15, v0
  v_or_b32 v4, 0, v2
  v_xor_b32 v4, v4, v3
  v_lshlrev_b32 v4, 4, v4
  v_lshl_add_u32 v238, v1, 8, v4
  v_or_b32 v4, 2, v2
  v_xor_b32 v4, v4, v3
  v_lshlrev_b32 v4, 4, v4
  v_lshl_add_u32 v239, v1, 8, v4
  v_or_b32 v4, 4, v2
  v_xor_b32 v4, v4, v3
  v_lshlrev_b32 v4, 4, v4
  v_lshl_add_u32 v240, v1, 8, v4
  v_or_b32 v4, 6, v2
  v_xor_b32 v4, v4, v3
  v_lshlrev_b32 v4, 4, v4
  v_lshl_add_u32 v241, v1, 8, v4
  v_or_b32 v4, 8, v2
  v_xor_b32 v4, v4, v3
  v_lshlrev_b32 v4, 4, v4
  v_lshl_add_u32 v242, v1, 8, v4
  v_or_b32 v4, 10, v2
  v_xor_b32 v4, v4, v3
  v_lshlrev_b32 v4, 4, v4
  v_lshl_add_u32 v243, v1, 8, v4
  v_or_b32 v4, 12, v2
  v_xor_b32 v4, v4, v3
  v_lshlrev_b32 v4, 4, v4
  v_lshl_add_u32 v244, v1, 8, v4
  v_or_b32 v4, 14, v2
  v_xor_b32 v4, v4, v3
  v_lshlrev_b32 v4, 4, v4
  v_lshl_add_u32 v245, v1, 8, v4
  v_lshrrev_b32 v1, 2, v3
  v_lshl_add_u32 v2, v2, 2, v1
  v_lshlrev_b32 v2, 8, v2
  v_bfe_u32 v4, v0, 4, 1
  v_lshl_add_u32 v2, v4, 5, v2
  v_and_b32 v4, 3, v0
  v_lshl_add_u32 v2, v4, 3, v2
  v_add_u32 v2, 0x10000, v2
  v_xor_b32 v4, 0, v1
  v_lshl_add_u32 v246, v4, 6, v2
  v_xor_b32 v4, 1, v1
  v_lshl_add_u32 v247, v4, 6, v2
  v_xor_b32 v4, 2, v1
  v_lshl_add_u32 v248, v4, 6, v2
  v_xor_b32 v4, 3, v1
  v_lshl_add_u32 v249, v4, 6, v2
  v_add_u32 v160, s30, v238
  v_add_u32 v161, s30, v239
  v_add_u32 v162, s30, v240
  v_add_u32 v163, s30, v241
  v_add_u32 v164, s30, v242
  v_add_u32 v165, s30, v243
  v_add_u32 v166, s30, v244
  v_add_u32 v167, s30, v245
  v_add_u32 v176, s46, v238
  v_add_u32 v177, s46, v239
  v_add_u32 v178, s46, v240
  v_add_u32 v179, s46, v241
  v_add_u32 v180, s46, v242
  v_add_u32 v181, s46, v243
  v_add_u32 v182, s46, v244
  v_add_u32 v183, s46, v245
  s_waitcnt vmcnt(16)
  s_barrier
  ds_read_b128 a[96:99], v176 offset:0
  ds_read_b128 a[100:103], v177 offset:0
  ds_read_b128 a[104:107], v178 offset:0
  ds_read_b128 a[108:111], v179 offset:0
  ds_read_b128 a[112:115], v180 offset:0
  ds_read_b128 a[116:119], v181 offset:0
  ds_read_b128 a[120:123], v182 offset:0
  ds_read_b128 a[124:127], v183 offset:0
  ds_read_b128 a[64:67], v160 offset:0
  ds_read_b128 a[68:71], v161 offset:0
  ds_read_b128 a[72:75], v162 offset:0
  ds_read_b128 a[76:79], v163 offset:0
  ds_read_b128 a[80:83], v164 offset:0
  ds_read_b128 a[84:87], v165 offset:0
  ds_read_b128 a[88:91], v166 offset:0
  ds_read_b128 a[92:95], v167 offset:0
  ds_read_b128 a[128:131], v238 offset:8192
  ds_read_b128 a[132:135], v239 offset:8192
  ds_read_b128 a[136:139], v240 offset:8192
  ds_read_b128 a[140:143], v241 offset:8192
  ds_read_b128 a[144:147], v242 offset:8192
  ds_read_b128 a[148:151], v243 offset:8192
  ds_read_b128 a[152:155], v244 offset:8192
  ds_read_b128 a[156:159], v245 offset:8192
  s_waitcnt lgkmcnt(0)
  s_barrier
  s_add_u32 s21, s21, 0x4000
  s_add_u32 m0, s20, 49152
  s_nop 0
  buffer_load_dwordx4 v250, s[8:11], s21 offen offset:0 nt lds
  buffer_load_dwordx4 v251, s[8:11], s21 offen offset:1024 nt lds
  buffer_load_dwordx4 v252, s[8:11], s21 offen offset:2048 nt lds
  buffer_load_dwordx4 v253, s[8:11], s21 offen offset:3072 nt lds
  s_add_u32 s22, s22, 0x4000
  s_add_u32 m0, s20, 98304
  s_nop 0
  buffer_load_dwordx4 v254, s[12:15], s22 offen offset:0 nt lds
  buffer_load_dwordx4 v254, s[12:15], s22 offen offset:1024 nt lds
  buffer_load_dwordx4 v254, s[12:15], s22 offen offset:2048 nt lds
  buffer_load_dwordx4 v254, s[12:15], s22 offen offset:3072 nt lds
  s_waitcnt lgkmcnt(0)
  v_lshlrev_b32 v208, 4, v0
  v_add_u32 v208, s30, v208
  v_mov_b32 v209, v208
  v_mov_b32 v210, v208
  v_mov_b32 v211, v208
  v_mov_b32 v216, v208
  v_mov_b32 v221, v208
  v_mfma_f32_32x32x16_bf16 v[128:143], a[128:131], a[64:67], 0
  v_mfma_f32_32x32x16_bf16 v[144:159], a[128:131], a[96:99], 0
  v_mfma_f32_32x32x16_bf16 v[128:143], a[132:135], a[68:71], v[128:143]
  v_mfma_f32_32x32x16_bf16 v[144:159], a[132:135], a[100:103], v[144:159]
  v_mfma_f32_32x32x16_bf16 v[128:143], a[136:139], a[72:75], v[128:143]
  v_mfma_f32_32x32x16_bf16 v[144:159], a[136:139], a[104:107], v[144:159]
  v_mfma_f32_32x32x16_bf16 v[128:143], a[140:143], a[76:79], v[128:143]
  v_mfma_f32_32x32x16_bf16 v[144:159], a[140:143], a[108:111], v[144:159]
  v_mfma_f32_32x32x16_bf16 v[128:143], a[144:147], a[80:83], v[128:143]
  v_mfma_f32_32x32x16_bf16 v[144:159], a[144:147], a[112:115], v[144:159]
  v_mfma_f32_32x32x16_bf16 v[128:143], a[148:151], a[84:87], v[128:143]
  v_mfma_f32_32x32x16_bf16 v[144:159], a[148:151], a[116:119], v[144:159]
  v_mfma_f32_32x32x16_bf16 v[128:143], a[152:155], a[88:91], v[128:143]
  v_mfma_f32_32x32x16_bf16 v[144:159], a[152:155], a[120:123], v[144:159]
  v_mfma_f32_32x32x16_bf16 v[128:143], a[156:159], a[92:95], v[128:143]
  v_mfma_f32_32x32x16_bf16 v[144:159], a[156:159], a[124:127], v[144:159]
  s_waitcnt vmcnt(16)
  s_nop 7
  s_nop 7
  s_barrier
  ds_read_b128 a[128:131], v238 offset:16384
  s_add_u32 s21, s21, 0x4000
  s_add_u32 m0, s20, 0
  v_max3_f32 v224, v128, v129, v130
  ds_read_b128 a[132:135], v239 offset:16384
  v_max3_f32 v224, v224, v131, v132
  v_max3_f32 v224, v224, v133, v134
  v_max3_f32 v225, v144, v145, v146
  v_max3_f32 v224, v224, v135, v136
  ds_read_b128 a[136:139], v240 offset:16384
  v_max3_f32 v225, v225, v147, v148
  v_max3_f32 v224, v224, v137, v138
  v_max3_f32 v225, v225, v149, v150
  v_max3_f32 v224, v224, v139, v140
  ds_read_b128 a[140:143], v241 offset:16384
  v_max3_f32 v225, v225, v151, v152
  s_nop 1
  v_max3_f32 v224, v224, v141, v142
  v_max3_f32 v225, v225, v153, v154
  ds_read_b128 a[144:147], v242 offset:16384
  v_max_f32 v224, v224, v143
  v_max3_f32 v225, v225, v155, v156
  v_mov_b32 v226, v224
  v_max3_f32 v225, v225, v157, v158
  v_max_f32 v225, v225, v159
  ds_read_b128 a[148:151], v243 offset:16384
  v_mov_b32 v227, v225
  v_permlane32_swap_b32 v224, v226
  s_nop 0
  v_permlane32_swap_b32 v225, v227
  ds_read_b128 a[152:155], v244 offset:16384
  v_max_f32 v224, v224, v226
  v_max_f32 v225, v225, v227
  v_mul_f32 v232, s28, v224
  v_mul_f32 v233, s28, v225
  ds_read_b128 a[156:159], v245 offset:16384
  v_fma_f32 v224, v128, s28, -v232
  v_fma_f32 v225, v129, s28, -v232
  v_exp_f32 v224, v224
  buffer_load_dwordx4 v250, s[8:11], s21 offen offset:0 nt lds
  v_exp_f32 v225, v225
  v_fma_f32 v226, v130, s28, -v232
  v_fma_f32 v227, v131, s28, -v232
  v_add_f32 v236, v224, v225
  buffer_load_dwordx4 v251, s[8:11], s21 offen offset:1024 nt lds
  v_exp_f32 v226, v226
  v_fma_f32 v228, v132, s28, -v232
  v_cvt_pk_bf16_f32 v192, v224, v225
  v_exp_f32 v227, v227
  v_fma_f32 v229, v133, s28, -v232
  v_add_f32 v236, v236, v226
  buffer_load_dwordx4 v252, s[8:11], s21 offen offset:2048 nt lds
  v_exp_f32 v228, v228
  v_fma_f32 v230, v134, s28, -v232
  buffer_load_dwordx4 v253, s[8:11], s21 offen offset:3072 nt lds
  v_exp_f32 v229, v229
  v_fma_f32 v231, v135, s28, -v232
  v_exp_f32 v230, v230
  v_exp_f32 v231, v231
  v_fma_f32 v224, v136, s28, -v232
  v_add_f32 v236, v236, v227
  v_fma_f32 v225, v137, s28, -v232
  v_add_f32 v236, v236, v228
  v_exp_f32 v224, v224
  v_add_f32 v236, v236, v229
  v_exp_f32 v225, v225
  s_waitcnt lgkmcnt(0)
  s_branch LOOP
.p2align 6
LOOP:
  s_cmp_lt_i32 s27, 0
  s_cbranch_scc1 AFTER
  v_mbcnt_lo_u32_b32 v219, -1, 0
  v_mbcnt_hi_u32_b32 v219, -1, v219
  v_and_b32 v222, 31, v219
  v_bfe_u32 v220, v219, 3, 1
  v_xor_b32 v220, v220, v222
  v_lshrrev_b32 v216, 5, v219
  v_xor_b32 v220, v220, v216
  v_and_b32 v220, 7, v220
  v_lshlrev_b32 v208, 7, v222
  v_lshl_add_u32 v208, v220, 4, v208
  v_add_u32 v208, s30, v208
  v_xor_b32 v209, 32, v208
  v_xor_b32 v210, 64, v208
  v_xor_b32 v211, 0x60, v208
  v_lshrrev_b32 v220, 3, v219
  v_and_b32 v219, 7, v219
  v_xor_b32 v219, v220, v219
  v_lshlrev_b32 v216, 7, v220
  v_lshl_add_u32 v216, v219, 4, v216
  v_add_u32 v216, s30, v216
  v_xor_b32 v221, 16, v216
  s_add_u32 s80, s24, 0x0
  s_add_u32 s81, s24, 0x1000
  s_add_u32 s82, s24, 0x2000
  s_add_u32 s83, s24, 0x3000
  v_pk_mul_f32 v[0:1], v[0:1], v[234:235] op_sel_hi:[1,0]
  v_pk_mul_f32 v[2:3], v[2:3], v[234:235] op_sel_hi:[1,0]
  v_pk_mul_f32 v[4:5], v[4:5], v[234:235] op_sel_hi:[1,0]
  v_pk_mul_f32 v[6:7], v[6:7], v[234:235] op_sel_hi:[1,0]
  v_pk_mul_f32 v[8:9], v[8:9], v[234:235] op_sel_hi:[1,0]
  v_cvt_pk_bf16_f32 v0, v0, v1
  v_pk_mul_f32 v[10:11], v[10:11], v[234:235] op_sel_hi:[1,0]
  v_cvt_pk_bf16_f32 v1, v2, v3
  v_pk_mul_f32 v[12:13], v[12:13], v[234:235] op_sel_hi:[1,0]
  v_cvt_pk_bf16_f32 v2, v4, v5
  v_pk_mul_f32 v[14:15], v[14:15], v[234:235] op_sel_hi:[1,0]
  v_cvt_pk_bf16_f32 v3, v6, v7
  v_pk_mul_f32 v[16:17], v[16:17], v[234:235] op_sel_hi:[1,0]
  v_cvt_pk_bf16_f32 v8, v8, v9
  v_pk_mul_f32 v[18:19], v[18:19], v[234:235] op_sel_hi:[1,0]
  v_cvt_pk_bf16_f32 v9, v10, v11
  v_pk_mul_f32 v[20:21], v[20:21], v[234:235] op_sel_hi:[1,0]
  v_cvt_pk_bf16_f32 v10, v12, v13
  v_pk_mul_f32 v[22:23], v[22:23], v[234:235] op_sel_hi:[1,0]
  v_cvt_pk_bf16_f32 v11, v14, v15
  v_permlane32_swap_b32 v0, v2
  v_permlane32_swap_b32 v1, v3
  ds_write_b128 v208, v[0:3] offset:0
  v_pk_mul_f32 v[24:25], v[24:25], v[234:235] op_sel_hi:[1,0]
  v_cvt_pk_bf16_f32 v16, v16, v17
  v_pk_mul_f32 v[26:27], v[26:27], v[234:235] op_sel_hi:[1,0]
  v_cvt_pk_bf16_f32 v17, v18, v19
  v_pk_mul_f32 v[28:29], v[28:29], v[234:235] op_sel_hi:[1,0]
  v_cvt_pk_bf16_f32 v18, v20, v21
  v_pk_mul_f32 v[30:31], v[30:31], v[234:235] op_sel_hi:[1,0]
  v_cvt_pk_bf16_f32 v19, v22, v23
  v_permlane32_swap_b32 v8, v10
  v_permlane32_swap_b32 v9, v11
  ds_write_b128 v209, v[8:11] offset:0
  v_pk_mul_f32 v[32:33], v[32:33], v[234:235] op_sel_hi:[1,0]
  v_cvt_pk_bf16_f32 v24, v24, v25
  v_pk_mul_f32 v[34:35], v[34:35], v[234:235] op_sel_hi:[1,0]
  v_cvt_pk_bf16_f32 v25, v26, v27
  v_pk_mul_f32 v[36:37], v[36:37], v[234:235] op_sel_hi:[1,0]
  v_cvt_pk_bf16_f32 v26, v28, v29
  v_pk_mul_f32 v[38:39], v[38:39], v[234:235] op_sel_hi:[1,0]
  v_cvt_pk_bf16_f32 v27, v30, v31
  v_permlane32_swap_b32 v16, v18
  v_permlane32_swap_b32 v17, v19
  ds_write_b128 v210, v[16:19] offset:0
  v_pk_mul_f32 v[40:41], v[40:41], v[234:235] op_sel_hi:[1,0]
  v_cvt_pk_bf16_f32 v32, v32, v33
  v_pk_mul_f32 v[42:43], v[42:43], v[234:235] op_sel_hi:[1,0]
  v_cvt_pk_bf16_f32 v33, v34, v35
  v_pk_mul_f32 v[44:45], v[44:45], v[234:235] op_sel_hi:[1,0]
  v_cvt_pk_bf16_f32 v34, v36, v37
  v_pk_mul_f32 v[46:47], v[46:47], v[234:235] op_sel_hi:[1,0]
  v_cvt_pk_bf16_f32 v35, v38, v39
  v_permlane32_swap_b32 v24, v26
  v_permlane32_swap_b32 v25, v27
  ds_write_b128 v211, v[24:27] offset:0
  v_pk_mul_f32 v[48:49], v[48:49], v[234:235] op_sel_hi:[1,0]
  v_cvt_pk_bf16_f32 v40, v40, v41
  v_pk_mul_f32 v[50:51], v[50:51], v[234:235] op_sel_hi:[1,0]
  v_cvt_pk_bf16_f32 v41, v42, v43
  ds_read_b128 a[192:195], v216 offset:0
  v_pk_mul_f32 v[52:53], v[52:53], v[234:235] op_sel_hi:[1,0]
  v_cvt_pk_bf16_f32 v42, v44, v45
  v_pk_mul_f32 v[54:55], v[54:55], v[234:235] op_sel_hi:[1,0]
  v_cvt_pk_bf16_f32 v43, v46, v47
  v_permlane32_swap_b32 v32, v34
  v_permlane32_swap_b32 v33, v35
  ds_write_b128 v208, v[32:35] offset:4096
  v_pk_mul_f32 v[56:57], v[56:57], v[234:235] op_sel_hi:[1,0]
  v_cvt_pk_bf16_f32 v48, v48, v49
  v_pk_mul_f32 v[58:59], v[58:59], v[234:235] op_sel_hi:[1,0]
  v_cvt_pk_bf16_f32 v49, v50, v51
  ds_read_b128 a[196:199], v221 offset:1024
  v_pk_mul_f32 v[60:61], v[60:61], v[234:235] op_sel_hi:[1,0]
  v_cvt_pk_bf16_f32 v50, v52, v53
  v_pk_mul_f32 v[62:63], v[62:63], v[234:235] op_sel_hi:[1,0]
  v_cvt_pk_bf16_f32 v51, v54, v55
  v_permlane32_swap_b32 v40, v42
  v_permlane32_swap_b32 v41, v43
  ds_write_b128 v209, v[40:43] offset:4096
  v_pk_mul_f32 v[64:65], v[64:65], v[234:235] op_sel:[0,1] op_sel_hi:[1,1]
  v_cvt_pk_bf16_f32 v56, v56, v57
  v_pk_mul_f32 v[66:67], v[66:67], v[234:235] op_sel:[0,1] op_sel_hi:[1,1]
  v_cvt_pk_bf16_f32 v57, v58, v59
  ds_read_b128 a[200:203], v216 offset:2048
  v_pk_mul_f32 v[68:69], v[68:69], v[234:235] op_sel:[0,1] op_sel_hi:[1,1]
  v_cvt_pk_bf16_f32 v58, v60, v61
  v_pk_mul_f32 v[70:71], v[70:71], v[234:235] op_sel:[0,1] op_sel_hi:[1,1]
  v_cvt_pk_bf16_f32 v59, v62, v63
  v_permlane32_swap_b32 v48, v50
  v_permlane32_swap_b32 v49, v51
  ds_write_b128 v210, v[48:51] offset:4096
  v_pk_mul_f32 v[72:73], v[72:73], v[234:235] op_sel:[0,1] op_sel_hi:[1,1]
  v_cvt_pk_bf16_f32 v64, v64, v65
  v_pk_mul_f32 v[74:75], v[74:75], v[234:235] op_sel:[0,1] op_sel_hi:[1,1]
  v_cvt_pk_bf16_f32 v65, v66, v67
  ds_read_b128 a[204:207], v221 offset:3072
  v_pk_mul_f32 v[76:77], v[76:77], v[234:235] op_sel:[0,1] op_sel_hi:[1,1]
  v_cvt_pk_bf16_f32 v66, v68, v69
  v_pk_mul_f32 v[78:79], v[78:79], v[234:235] op_sel:[0,1] op_sel_hi:[1,1]
  v_cvt_pk_bf16_f32 v67, v70, v71
  v_permlane32_swap_b32 v56, v58
  v_permlane32_swap_b32 v57, v59
  ds_write_b128 v211, v[56:59] offset:4096
  v_pk_mul_f32 v[80:81], v[80:81], v[234:235] op_sel:[0,1] op_sel_hi:[1,1]
  v_cvt_pk_bf16_f32 v72, v72, v73
  v_pk_mul_f32 v[82:83], v[82:83], v[234:235] op_sel:[0,1] op_sel_hi:[1,1]
  v_cvt_pk_bf16_f32 v73, v74, v75
  ds_read_b128 a[208:211], v216 offset:4096
  v_pk_mul_f32 v[84:85], v[84:85], v[234:235] op_sel:[0,1] op_sel_hi:[1,1]
  v_cvt_pk_bf16_f32 v74, v76, v77
  v_pk_mul_f32 v[86:87], v[86:87], v[234:235] op_sel:[0,1] op_sel_hi:[1,1]
  v_cvt_pk_bf16_f32 v75, v78, v79
  v_permlane32_swap_b32 v64, v66
  v_permlane32_swap_b32 v65, v67
  ds_write_b128 v208, v[64:67] offset:0
  v_pk_mul_f32 v[88:89], v[88:89], v[234:235] op_sel:[0,1] op_sel_hi:[1,1]
  v_cvt_pk_bf16_f32 v80, v80, v81
  v_pk_mul_f32 v[90:91], v[90:91], v[234:235] op_sel:[0,1] op_sel_hi:[1,1]
  v_cvt_pk_bf16_f32 v81, v82, v83
  ds_read_b128 a[212:215], v221 offset:5120
  v_pk_mul_f32 v[92:93], v[92:93], v[234:235] op_sel:[0,1] op_sel_hi:[1,1]
  v_cvt_pk_bf16_f32 v82, v84, v85
  v_pk_mul_f32 v[94:95], v[94:95], v[234:235] op_sel:[0,1] op_sel_hi:[1,1]
  v_cvt_pk_bf16_f32 v83, v86, v87
  v_permlane32_swap_b32 v72, v74
  v_permlane32_swap_b32 v73, v75
  ds_write_b128 v209, v[72:75] offset:0
  v_pk_mul_f32 v[96:97], v[96:97], v[234:235] op_sel:[0,1] op_sel_hi:[1,1]
  v_cvt_pk_bf16_f32 v88, v88, v89
  v_pk_mul_f32 v[98:99], v[98:99], v[234:235] op_sel:[0,1] op_sel_hi:[1,1]
  v_cvt_pk_bf16_f32 v89, v90, v91
  ds_read_b128 a[216:219], v216 offset:6144
  v_pk_mul_f32 v[100:101], v[100:101], v[234:235] op_sel:[0,1] op_sel_hi:[1,1]
  v_cvt_pk_bf16_f32 v90, v92, v93
  v_pk_mul_f32 v[102:103], v[102:103], v[234:235] op_sel:[0,1] op_sel_hi:[1,1]
  v_cvt_pk_bf16_f32 v91, v94, v95
  v_permlane32_swap_b32 v80, v82
  v_permlane32_swap_b32 v81, v83
  ds_write_b128 v210, v[80:83] offset:0
  v_pk_mul_f32 v[104:105], v[104:105], v[234:235] op_sel:[0,1] op_sel_hi:[1,1]
  v_cvt_pk_bf16_f32 v96, v96, v97
  v_pk_mul_f32 v[106:107], v[106:107], v[234:235] op_sel:[0,1] op_sel_hi:[1,1]
  v_cvt_pk_bf16_f32 v97, v98, v99
  ds_read_b128 a[220:223], v221 offset:7168
  v_pk_mul_f32 v[108:109], v[108:109], v[234:235] op_sel:[0,1] op_sel_hi:[1,1]
  v_cvt_pk_bf16_f32 v98, v100, v101
  v_pk_mul_f32 v[110:111], v[110:111], v[234:235] op_sel:[0,1] op_sel_hi:[1,1]
  v_cvt_pk_bf16_f32 v99, v102, v103
  v_permlane32_swap_b32 v88, v90
  v_permlane32_swap_b32 v89, v91
  ds_write_b128 v211, v[88:91] offset:0
  v_pk_mul_f32 v[112:113], v[112:113], v[234:235] op_sel:[0,1] op_sel_hi:[1,1]
  v_cvt_pk_bf16_f32 v104, v104, v105
  v_pk_mul_f32 v[114:115], v[114:115], v[234:235] op_sel:[0,1] op_sel_hi:[1,1]
  v_cvt_pk_bf16_f32 v105, v106, v107
  v_pk_mul_f32 v[116:117], v[116:117], v[234:235] op_sel:[0,1] op_sel_hi:[1,1]
  v_cvt_pk_bf16_f32 v106, v108, v109
  v_pk_mul_f32 v[118:119], v[118:119], v[234:235] op_sel:[0,1] op_sel_hi:[1,1]
  v_cvt_pk_bf16_f32 v107, v110, v111
  v_permlane32_swap_b32 v96, v98
  v_permlane32_swap_b32 v97, v99
  v_pk_mul_f32 v[120:121], v[120:121], v[234:235] op_sel:[0,1] op_sel_hi:[1,1]
  v_cvt_pk_bf16_f32 v112, v112, v113
  v_pk_mul_f32 v[122:123], v[122:123], v[234:235] op_sel:[0,1] op_sel_hi:[1,1]
  v_cvt_pk_bf16_f32 v113, v114, v115
  v_pk_mul_f32 v[124:125], v[124:125], v[234:235] op_sel:[0,1] op_sel_hi:[1,1]
  v_cvt_pk_bf16_f32 v114, v116, v117
  v_pk_mul_f32 v[126:127], v[126:127], v[234:235] op_sel:[0,1] op_sel_hi:[1,1]
  v_cvt_pk_bf16_f32 v115, v118, v119
  v_permlane32_swap_b32 v104, v106
  v_permlane32_swap_b32 v105, v107
  v_cvt_pk_bf16_f32 v120, v120, v121
  v_cvt_pk_bf16_f32 v121, v122, v123
  v_cvt_pk_bf16_f32 v122, v124, v125
  v_cvt_pk_bf16_f32 v123, v126, v127
  v_permlane32_swap_b32 v112, v114
  v_permlane32_swap_b32 v113, v115
  v_permlane32_swap_b32 v120, v122
  v_permlane32_swap_b32 v121, v123
AFTER:
  s_add_u32 s27, s27, 1
  s_cmp_eq_u32 s27, 4
  s_cbranch_scc1 FIN
  s_mov_b32 s24, s23
  s_add_u32 s23, s23, 0x1000000
  v_mfma_f32_32x32x16_bf16 v[160:175], a[128:131], a[64:67], 0
  ds_read_b64_tr_b16 a[160:161], v246 offset:0
  ds_read_b64_tr_b16 a[162:163], v246 offset:2048
  ds_read_b128 a[224:227], v216 offset:0
  v_add_f32 v236, v236, v230
  v_cvt_pk_bf16_f32 v193, v226, v227
  v_fma_f32 v226, v138, s28, -v232
  v_mfma_f32_32x32x16_bf16 v[176:191], a[128:131], a[96:99], 0
  ds_read_b64_tr_b16 a[164:165], v247 offset:0
  ds_read_b128 a[228:231], v221 offset:1024
  v_exp_f32 v226, v226
  v_fma_f32 v227, v139, s28, -v232
  v_add_f32 v236, v236, v231
  v_mfma_f32_32x32x16_bf16 v[160:175], a[132:135], a[68:71], v[160:175]
  ds_read_b64_tr_b16 a[166:167], v247 offset:2048
  ds_read_b128 a[232:235], v216 offset:2048
  v_exp_f32 v227, v227
  v_add_f32 v236, v236, v224
  v_cvt_pk_bf16_f32 v194, v228, v229
  v_mfma_f32_32x32x16_bf16 v[176:191], a[132:135], a[100:103], v[176:191]
  ds_read_b64_tr_b16 a[168:169], v248 offset:0
  ds_read_b64_tr_b16 a[170:171], v248 offset:2048
  ds_read_b128 a[236:239], v221 offset:3072
  v_fma_f32 v228, v140, s28, -v232
  v_add_f32 v236, v236, v225
  v_fma_f32 v229, v141, s28, -v232
  v_mfma_f32_32x32x16_bf16 v[160:175], a[136:139], a[72:75], v[160:175]
  ds_read_b64_tr_b16 a[172:173], v249 offset:0
  v_exp_f32 v228, v228
  v_add_f32 v236, v236, v226
  v_exp_f32 v229, v229
  v_mfma_f32_32x32x16_bf16 v[176:191], a[136:139], a[104:107], v[176:191]
  ds_read_b64_tr_b16 a[174:175], v249 offset:2048
  ds_write_b128 v208, v[96:99] offset:4096
  v_add_f32 v236, v236, v227
  v_cvt_pk_bf16_f32 v195, v230, v231
  v_fma_f32 v230, v142, s28, -v232
  v_mfma_f32_32x32x16_bf16 v[160:175], a[140:143], a[76:79], v[160:175]
  ds_read_b64_tr_b16 a[176:177], v246 offset:4096
  ds_read_b64_tr_b16 a[178:179], v246 offset:6144
  ds_write_b128 v209, v[104:107] offset:4096
  v_fma_f32 v231, v143, s28, -v232
  v_accvgpr_mov_b32 a0, a64
  v_mfma_f32_32x32x16_bf16 v[176:191], a[140:143], a[108:111], v[176:191]
  ds_read_b64_tr_b16 a[180:181], v247 offset:4096
  ds_write_b128 v210, v[112:115] offset:4096
  v_exp_f32 v230, v230
  v_accvgpr_mov_b32 a1, a65
  v_mfma_f32_32x32x16_bf16 v[160:175], a[144:147], a[80:83], v[160:175]
  ds_read_b64_tr_b16 a[182:183], v247 offset:6144
  ds_write_b128 v211, v[120:123] offset:4096
  v_exp_f32 v231, v231
  v_accvgpr_mov_b32 a2, a66
  v_mfma_f32_32x32x16_bf16 v[176:191], a[144:147], a[112:115], v[176:191]
  ds_read_b64_tr_b16 a[184:185], v248 offset:4096
  ds_read_b64_tr_b16 a[186:187], v248 offset:6144
  v_add_f32 v236, v236, v228
  v_cvt_pk_bf16_f32 v196, v224, v225
  v_fma_f32 v224, v144, s28, -v233
  v_accvgpr_mov_b32 a3, a67
  v_mfma_f32_32x32x16_bf16 v[160:175], a[148:151], a[84:87], v[160:175]
  ds_read_b64_tr_b16 a[188:189], v249 offset:4096
  ds_read_b128 a[240:243], v216 offset:4096
  v_exp_f32 v224, v224
  v_fma_f32 v225, v145, s28, -v233
  v_accvgpr_mov_b32 a4, a68
  v_mfma_f32_32x32x16_bf16 v[176:191], a[148:151], a[116:119], v[176:191]
  ds_read_b64_tr_b16 a[190:191], v249 offset:6144
  ds_read_b128 a[244:247], v221 offset:5120
  v_exp_f32 v225, v225
  v_add_f32 v236, v236, v229
  v_accvgpr_mov_b32 a5, a69
  v_mfma_f32_32x32x16_bf16 v[160:175], a[152:155], a[88:91], v[160:175]
  ds_read_b128 a[248:251], v216 offset:6144
  v_add_f32 v236, v236, v230
  v_cvt_pk_bf16_f32 v197, v226, v227
  v_fma_f32 v226, v146, s28, -v233
  v_add_f32 v236, v236, v231
  v_accvgpr_mov_b32 a6, a70
  v_mfma_f32_32x32x16_bf16 v[176:191], a[152:155], a[120:123], v[176:191]
  ds_read_b128 a[252:255], v221 offset:7168
  v_exp_f32 v226, v226
  v_fma_f32 v227, v147, s28, -v233
  v_add_f32 v237, v224, v225
  v_accvgpr_mov_b32 a7, a71
  v_mfma_f32_32x32x16_bf16 v[160:175], a[156:159], a[92:95], v[160:175]
  v_exp_f32 v227, v227
  v_add_f32 v237, v237, v226
  v_cvt_pk_bf16_f32 v198, v228, v229
  v_fma_f32 v228, v148, s28, -v233
  v_add_f32 v237, v237, v227
  v_fma_f32 v229, v149, s28, -v233
  v_exp_f32 v228, v228
  v_cvt_pk_bf16_f32 v199, v230, v231
  v_exp_f32 v229, v229
  v_fma_f32 v230, v150, s28, -v233
  v_add_f32 v237, v237, v228
  v_fma_f32 v231, v151, s28, -v233
  v_exp_f32 v230, v230
  v_add_f32 v237, v237, v229
  v_exp_f32 v231, v231
  v_add_f32 v237, v237, v230
  v_cvt_pk_bf16_f32 v200, v224, v225
  v_fma_f32 v224, v152, s28, -v233
  v_add_f32 v237, v237, v231
  v_fma_f32 v225, v153, s28, -v233
  v_exp_f32 v224, v224
  v_cvt_pk_bf16_f32 v201, v226, v227
  v_exp_f32 v225, v225
  v_fma_f32 v226, v154, s28, -v233
  v_add_f32 v237, v237, v224
  v_fma_f32 v227, v155, s28, -v233
  v_exp_f32 v226, v226
  v_add_f32 v237, v237, v225
  v_exp_f32 v227, v227
  v_add_f32 v237, v237, v226
  v_cvt_pk_bf16_f32 v202, v228, v229
  v_fma_f32 v228, v156, s28, -v233
  v_add_f32 v237, v237, v227
  v_fma_f32 v229, v157, s28, -v233
  v_exp_f32 v228, v228
  v_cvt_pk_bf16_f32 v203, v230, v231
  v_exp_f32 v229, v229
  v_fma_f32 v230, v158, s28, -v233
  v_add_f32 v237, v237, v228
  v_fma_f32 v231, v159, s28, -v233
  v_exp_f32 v230, v230
  v_add_f32 v237, v237, v229
  v_exp_f32 v231, v231
  v_add_f32 v237, v237, v230
  v_cvt_pk_bf16_f32 v204, v224, v225
  v_add_f32 v237, v237, v231
  v_mfma_f32_32x32x16_bf16 v[176:191], a[156:159], a[124:127], v[176:191]
  v_cvt_pk_bf16_f32 v205, v226, v227
  v_cvt_pk_bf16_f32 v206, v228, v229
  v_cvt_pk_bf16_f32 v207, v230, v231
  s_waitcnt lgkmcnt(0)
  v_mfma_f32_32x32x16_bf16 v[0:15], a[160:163], v[192:195], 0
  s_add_u32 s22, s22, 0x4000
  s_add_u32 m0, s20, 114688
  v_mov_b32 v234, v236
  v_mov_b32 v235, v237
  v_mfma_f32_32x32x16_bf16 v[64:79], a[160:163], v[200:203], 0
  ds_read_b128 a[128:131], v238 offset:24576
  v_fma_f32 v224, v160, s28, -v232
  v_fma_f32 v225, v161, s28, -v232
  v_fma_f32 v226, v162, s28, -v232
  v_exp_f32 v224, v224
  v_mfma_f32_32x32x16_bf16 v[16:31], a[164:167], v[192:195], 0
  ds_read_b128 a[132:135], v239 offset:24576
  buffer_load_dwordx4 v254, s[12:15], s22 offen offset:0 nt lds
  v_exp_f32 v225, v225
  v_fma_f32 v227, v163, s28, -v232
  v_fma_f32 v228, v164, s28, -v232
  v_mfma_f32_32x32x16_bf16 v[80:95], a[164:167], v[200:203], 0
  ds_read_b128 a[136:139], v240 offset:24576
  buffer_load_dwordx4 v254, s[12:15], s22 offen offset:1024 nt lds
  v_exp_f32 v226, v226
  v_fma_f32 v229, v165, s28, -v232
  v_add_f32 v236, v224, v225
  v_mfma_f32_32x32x16_bf16 v[32:47], a[168:171], v[192:195], 0
  ds_read_b128 a[140:143], v241 offset:24576
  v_exp_f32 v227, v227
  v_fma_f32 v230, v166, s28, -v232
  v_exp_f32 v228, v228
  v_mfma_f32_32x32x16_bf16 v[96:111], a[168:171], v[200:203], 0
  ds_read_b128 a[144:147], v242 offset:24576
  buffer_load_dwordx4 v254, s[12:15], s22 offen offset:2048 nt lds
  v_exp_f32 v229, v229
  v_fma_f32 v231, v167, s28, -v232
  v_add_f32 v236, v236, v226
  v_mfma_f32_32x32x16_bf16 v[48:63], a[172:175], v[192:195], 0
  ds_read_b128 a[148:151], v243 offset:24576
  v_exp_f32 v230, v230
  v_add_f32 v236, v236, v227
  v_exp_f32 v231, v231
  v_mfma_f32_32x32x16_bf16 v[112:127], a[172:175], v[200:203], 0
  ds_read_b128 a[152:155], v244 offset:24576
  buffer_load_dwordx4 v254, s[12:15], s22 offen offset:3072 nt lds
  v_add_f32 v236, v236, v228
  v_cvt_pk_bf16_f32 v208, v224, v225
  v_fma_f32 v224, v168, s28, -v232
  v_add_f32 v236, v236, v229
  v_mfma_f32_32x32x16_bf16 v[0:15], a[176:179], v[196:199], v[0:15]
  ds_read_b128 a[156:159], v245 offset:24576
  v_exp_f32 v224, v224
  v_fma_f32 v225, v169, s28, -v232
  v_add_f32 v236, v236, v230
  v_cvt_pk_bf16_f32 v209, v226, v227
  v_mfma_f32_32x32x16_bf16 v[64:79], a[176:179], v[204:207], v[64:79]
  s_add_u32 s31, s23, 0
  s_add_u32 m0, s30, 0
  v_exp_f32 v225, v225
  v_accvgpr_mov_b32 a8, a72
  v_accvgpr_mov_b32 a14, a78
  v_mfma_f32_32x32x16_bf16 v[16:31], a[180:183], v[196:199], v[16:31]
  buffer_load_dwordx4 v250, s[4:7], s31 offen offset:0 nt lds
  v_fma_f32 v226, v170, s28, -v232
  v_add_f32 v236, v236, v231
  v_fma_f32 v227, v171, s28, -v232
  v_accvgpr_mov_b32 a9, a73
  v_accvgpr_mov_b32 a15, a79
  v_mfma_f32_32x32x16_bf16 v[80:95], a[180:183], v[204:207], v[80:95]
  v_exp_f32 v226, v226
  v_add_f32 v236, v236, v224
  v_exp_f32 v227, v227
  v_accvgpr_mov_b32 a10, a74
  v_mfma_f32_32x32x16_bf16 v[32:47], a[184:187], v[196:199], v[32:47]
  buffer_load_dwordx4 v251, s[4:7], s31 offen offset:1024 nt lds
  v_add_f32 v236, v236, v225
  v_cvt_pk_bf16_f32 v210, v228, v229
  v_fma_f32 v228, v172, s28, -v232
  v_add_f32 v236, v236, v226
  v_accvgpr_mov_b32 a11, a75
  v_mfma_f32_32x32x16_bf16 v[96:111], a[184:187], v[204:207], v[96:111]
  v_exp_f32 v228, v228
  v_fma_f32 v229, v173, s28, -v232
  v_add_f32 v236, v236, v227
  v_cvt_pk_bf16_f32 v211, v230, v231
  v_accvgpr_mov_b32 a12, a76
  v_mfma_f32_32x32x16_bf16 v[48:63], a[188:191], v[196:199], v[48:63]
  v_exp_f32 v229, v229
  v_fma_f32 v230, v174, s28, -v232
  v_add_f32 v236, v236, v228
  v_fma_f32 v231, v175, s28, -v232
  v_accvgpr_mov_b32 a13, a77
  v_mfma_f32_32x32x16_bf16 v[112:127], a[188:191], v[204:207], v[112:127]
  v_exp_f32 v230, v230
  v_add_f32 v236, v236, v229
  v_exp_f32 v231, v231
  s_waitcnt lgkmcnt(0)
  v_mfma_f32_32x32x16_bf16 v[128:143], a[128:131], a[64:67], 0
  ds_read_b64_tr_b16 a[160:161], v246 offset:8192
  ds_read_b64_tr_b16 a[162:163], v246 offset:10240
  v_add_f32 v236, v236, v230
  v_cvt_pk_bf16_f32 v212, v224, v225
  v_fma_f32 v224, v176, s28, -v233
  v_add_f32 v236, v236, v231
  v_mfma_f32_32x32x16_bf16 v[144:159], a[128:131], a[96:99], 0
  ds_read_b64_tr_b16 a[164:165], v247 offset:8192
  v_exp_f32 v224, v224
  v_fma_f32 v225, v177, s28, -v233
  v_cvt_pk_bf16_f32 v213, v226, v227
  v_fma_f32 v226, v178, s28, -v233
  v_mfma_f32_32x32x16_bf16 v[128:143], a[132:135], a[68:71], v[128:143]
  ds_read_b64_tr_b16 a[166:167], v247 offset:10240
  v_exp_f32 v225, v225
  v_fma_f32 v227, v179, s28, -v233
  v_exp_f32 v226, v226
  v_mfma_f32_32x32x16_bf16 v[144:159], a[132:135], a[100:103], v[144:159]
  ds_read_b64_tr_b16 a[168:169], v248 offset:8192
  ds_read_b64_tr_b16 a[170:171], v248 offset:10240
  v_exp_f32 v227, v227
  v_add_f32 v237, v224, v225
  v_cvt_pk_bf16_f32 v214, v228, v229
  v_mfma_f32_32x32x16_bf16 v[128:143], a[136:139], a[72:75], v[128:143]
  ds_read_b64_tr_b16 a[172:173], v249 offset:8192
  v_fma_f32 v228, v180, s28, -v233
  v_add_f32 v237, v237, v226
  v_fma_f32 v229, v181, s28, -v233
  v_exp_f32 v228, v228
  v_mfma_f32_32x32x16_bf16 v[144:159], a[136:139], a[104:107], v[144:159]
  ds_read_b64_tr_b16 a[174:175], v249 offset:10240
  v_exp_f32 v229, v229
  v_add_f32 v237, v237, v227
  v_cvt_pk_bf16_f32 v215, v230, v231
  v_fma_f32 v230, v182, s28, -v233
  v_mfma_f32_32x32x16_bf16 v[128:143], a[140:143], a[76:79], v[128:143]
  ds_read_b64_tr_b16 a[176:177], v246 offset:12288
  ds_read_b64_tr_b16 a[178:179], v246 offset:14336
  v_exp_f32 v230, v230
  v_fma_f32 v231, v183, s28, -v233
  v_accvgpr_mov_b32 a16, a80
  v_mfma_f32_32x32x16_bf16 v[144:159], a[140:143], a[108:111], v[144:159]
  ds_read_b64_tr_b16 a[180:181], v247 offset:12288
  v_exp_f32 v231, v231
  v_add_f32 v237, v237, v228
  v_cvt_pk_bf16_f32 v216, v224, v225
  v_accvgpr_mov_b32 a17, a81
  v_mfma_f32_32x32x16_bf16 v[128:143], a[144:147], a[80:83], v[128:143]
  ds_read_b64_tr_b16 a[182:183], v247 offset:14336
  v_fma_f32 v224, v184, s28, -v233
  v_add_f32 v237, v237, v229
  v_fma_f32 v225, v185, s28, -v233
  v_add_f32 v237, v237, v230
  v_accvgpr_mov_b32 a18, a82
  v_mfma_f32_32x32x16_bf16 v[144:159], a[144:147], a[112:115], v[144:159]
  ds_read_b64_tr_b16 a[184:185], v248 offset:12288
  ds_read_b64_tr_b16 a[186:187], v248 offset:14336
  v_exp_f32 v224, v224
  v_add_f32 v237, v237, v231
  v_accvgpr_mov_b32 a19, a83
  v_mfma_f32_32x32x16_bf16 v[128:143], a[148:151], a[84:87], v[128:143]
  ds_read_b64_tr_b16 a[188:189], v249 offset:12288
  v_exp_f32 v225, v225
  v_add_f32 v237, v237, v224
  v_cvt_pk_bf16_f32 v217, v226, v227
  v_accvgpr_mov_b32 a20, a84
  v_mfma_f32_32x32x16_bf16 v[144:159], a[148:151], a[116:119], v[144:159]
  ds_read_b64_tr_b16 a[190:191], v249 offset:14336
  v_fma_f32 v226, v186, s28, -v233
  v_add_f32 v237, v237, v225
  v_fma_f32 v227, v187, s28, -v233
  v_cvt_pk_bf16_f32 v218, v228, v229
  v_accvgpr_mov_b32 a21, a85
  v_mfma_f32_32x32x16_bf16 v[128:143], a[152:155], a[88:91], v[128:143]
  v_exp_f32 v226, v226
  v_fma_f32 v228, v188, s28, -v233
  v_exp_f32 v227, v227
  v_accvgpr_mov_b32 a22, a86
  v_mfma_f32_32x32x16_bf16 v[144:159], a[152:155], a[120:123], v[144:159]
  v_exp_f32 v228, v228
  v_fma_f32 v229, v189, s28, -v233
  v_add_f32 v237, v237, v226
  v_cvt_pk_bf16_f32 v219, v230, v231
  v_accvgpr_mov_b32 a23, a87
  v_mfma_f32_32x32x16_bf16 v[128:143], a[156:159], a[92:95], v[128:143]
  v_exp_f32 v229, v229
  v_fma_f32 v230, v190, s28, -v233
  v_add_f32 v237, v237, v227
  v_fma_f32 v231, v191, s28, -v233
  v_exp_f32 v230, v230
  v_add_f32 v237, v237, v228
  v_exp_f32 v231, v231
  v_add_f32 v237, v237, v229
  v_cvt_pk_bf16_f32 v220, v224, v225
  v_add_f32 v237, v237, v230
  s_nop 0
  v_add_f32 v237, v237, v231
  s_nop 0
  v_max_f32 v224, v236, v237
  v_cmp_lt_f32 vcc, s29, v224
  v_mfma_f32_32x32x16_bf16 v[144:159], a[156:159], a[124:127], v[144:159]
  v_cvt_pk_bf16_f32 v221, v226, v227
  v_cvt_pk_bf16_f32 v222, v228, v229
  v_cvt_pk_bf16_f32 v223, v230, v231
  s_cbranch_vccnz RARE_1
RET_1:
  s_waitcnt vmcnt(18) lgkmcnt(0)
  v_mfma_f32_32x32x16_bf16 v[0:15], a[160:163], v[208:211], v[0:15]
  s_barrier
  v_mfma_f32_32x32x16_bf16 v[64:79], a[160:163], v[216:219], v[64:79]
  ds_read_b128 a[128:131], v238 offset:32768
  s_add_u32 s21, s21, 0x4000
  s_add_u32 m0, s20, 16384
  v_fma_f32 v224, v128, s28, -v232
  v_add_f32 v234, v234, v236
  v_add_f32 v235, v235, v237
  v_mfma_f32_32x32x16_bf16 v[16:31], a[164:167], v[208:211], v[16:31]
  ds_read_b128 a[132:135], v239 offset:32768
  buffer_load_dwordx4 v250, s[8:11], s21 offen offset:0 nt lds
  v_exp_f32 v224, v224
  v_fma_f32 v225, v129, s28, -v232
  v_fma_f32 v226, v130, s28, -v232
  v_mfma_f32_32x32x16_bf16 v[80:95], a[164:167], v[216:219], v[80:95]
  ds_read_b128 a[136:139], v240 offset:32768
  buffer_load_dwordx4 v251, s[8:11], s21 offen offset:1024 nt lds
  v_exp_f32 v225, v225
  v_fma_f32 v227, v131, s28, -v232
  v_fma_f32 v228, v132, s28, -v232
  v_mfma_f32_32x32x16_bf16 v[32:47], a[168:171], v[208:211], v[32:47]
  ds_read_b128 a[140:143], v241 offset:32768
  v_exp_f32 v226, v226
  v_fma_f32 v229, v133, s28, -v232
  v_exp_f32 v227, v227
  v_mfma_f32_32x32x16_bf16 v[96:111], a[168:171], v[216:219], v[96:111]
  ds_read_b128 a[144:147], v242 offset:32768
  buffer_load_dwordx4 v252, s[8:11], s21 offen offset:2048 nt lds
  v_exp_f32 v228, v228
  v_fma_f32 v230, v134, s28, -v232
  v_add_f32 v236, v224, v225
  v_mfma_f32_32x32x16_bf16 v[48:63], a[172:175], v[208:211], v[48:63]
  ds_read_b128 a[148:151], v243 offset:32768
  v_exp_f32 v229, v229
  v_fma_f32 v231, v135, s28, -v232
  v_exp_f32 v230, v230
  v_mfma_f32_32x32x16_bf16 v[112:127], a[172:175], v[216:219], v[112:127]
  ds_read_b128 a[152:155], v244 offset:32768
  buffer_load_dwordx4 v253, s[8:11], s21 offen offset:3072 nt lds
  v_exp_f32 v231, v231
  v_add_f32 v236, v236, v226
  v_cvt_pk_bf16_f32 v192, v224, v225
  v_mfma_f32_32x32x16_bf16 v[0:15], a[176:179], v[212:215], v[0:15]
  ds_read_b128 a[156:159], v245 offset:32768
  v_fma_f32 v224, v136, s28, -v232
  v_add_f32 v236, v236, v227
  v_fma_f32 v225, v137, s28, -v232
  v_exp_f32 v224, v224
  v_mfma_f32_32x32x16_bf16 v[64:79], a[176:179], v[220:223], v[64:79]
  s_add_u32 s31, s23, 0
  s_add_u32 m0, s30, 0
  v_exp_f32 v225, v225
  v_accvgpr_mov_b32 a24, a88
  v_accvgpr_mov_b32 a30, a94
  v_mfma_f32_32x32x16_bf16 v[16:31], a[180:183], v[212:215], v[16:31]
  buffer_load_dwordx4 v252, s[4:7], s31 offen offset:2048 nt lds
  v_add_f32 v236, v236, v228
  v_cvt_pk_bf16_f32 v193, v226, v227
  v_fma_f32 v226, v138, s28, -v232
  v_accvgpr_mov_b32 a25, a89
  v_accvgpr_mov_b32 a31, a95
  v_mfma_f32_32x32x16_bf16 v[80:95], a[180:183], v[220:223], v[80:95]
  v_exp_f32 v226, v226
  v_fma_f32 v227, v139, s28, -v232
  v_add_f32 v236, v236, v229
  v_cvt_pk_bf16_f32 v194, v228, v229
  v_accvgpr_mov_b32 a26, a90
  v_mfma_f32_32x32x16_bf16 v[32:47], a[184:187], v[212:215], v[32:47]
  buffer_load_dwordx4 v253, s[4:7], s31 offen offset:3072 nt lds
  v_exp_f32 v227, v227
  v_fma_f32 v228, v140, s28, -v232
  v_add_f32 v236, v236, v230
  v_accvgpr_mov_b32 a27, a91
  v_mfma_f32_32x32x16_bf16 v[96:111], a[184:187], v[220:223], v[96:111]
  v_exp_f32 v228, v228
  v_fma_f32 v229, v141, s28, -v232
  v_add_f32 v236, v236, v231
  v_cvt_pk_bf16_f32 v195, v230, v231
  v_accvgpr_mov_b32 a28, a92
  v_mfma_f32_32x32x16_bf16 v[48:63], a[188:191], v[212:215], v[48:63]
  v_exp_f32 v229, v229
  v_fma_f32 v230, v142, s28, -v232
  v_add_f32 v236, v236, v224
  v_fma_f32 v231, v143, s28, -v232
  v_accvgpr_mov_b32 a29, a93
  v_mfma_f32_32x32x16_bf16 v[112:127], a[188:191], v[220:223], v[112:127]
  v_exp_f32 v230, v230
  v_add_f32 v236, v236, v225
  v_exp_f32 v231, v231
  s_waitcnt lgkmcnt(0)
  v_mfma_f32_32x32x16_bf16 v[160:175], a[128:131], a[64:67], 0
  ds_read_b64_tr_b16 a[160:161], v246 offset:16384
  ds_read_b64_tr_b16 a[162:163], v246 offset:18432
  v_add_f32 v236, v236, v226
  v_cvt_pk_bf16_f32 v196, v224, v225
  v_fma_f32 v224, v144, s28, -v233
  v_add_f32 v236, v236, v227
  v_mfma_f32_32x32x16_bf16 v[176:191], a[128:131], a[96:99], 0
  ds_read_b64_tr_b16 a[164:165], v247 offset:16384
  v_exp_f32 v224, v224
  v_fma_f32 v225, v145, s28, -v233
  v_add_f32 v236, v236, v228
  v_cvt_pk_bf16_f32 v197, v226, v227
  v_mfma_f32_32x32x16_bf16 v[160:175], a[132:135], a[68:71], v[160:175]
  ds_read_b64_tr_b16 a[166:167], v247 offset:18432
  v_exp_f32 v225, v225
  v_fma_f32 v226, v146, s28, -v233
  v_add_f32 v236, v236, v229
  v_fma_f32 v227, v147, s28, -v233
  v_mfma_f32_32x32x16_bf16 v[176:191], a[132:135], a[100:103], v[176:191]
  ds_read_b64_tr_b16 a[168:169], v248 offset:16384
  ds_read_b64_tr_b16 a[170:171], v248 offset:18432
  v_exp_f32 v226, v226
  v_add_f32 v236, v236, v230
  v_cvt_pk_bf16_f32 v198, v228, v229
  v_mfma_f32_32x32x16_bf16 v[160:175], a[136:139], a[72:75], v[160:175]
  ds_read_b64_tr_b16 a[172:173], v249 offset:16384
  v_exp_f32 v227, v227
  v_fma_f32 v228, v148, s28, -v233
  v_add_f32 v236, v236, v231
  v_fma_f32 v229, v149, s28, -v233
  v_mfma_f32_32x32x16_bf16 v[176:191], a[136:139], a[104:107], v[176:191]
  ds_read_b64_tr_b16 a[174:175], v249 offset:18432
  v_exp_f32 v228, v228
  v_add_f32 v237, v224, v225
  v_exp_f32 v229, v229
  v_mfma_f32_32x32x16_bf16 v[160:175], a[140:143], a[76:79], v[160:175]
  ds_read_b64_tr_b16 a[176:177], v246 offset:20480
  ds_read_b64_tr_b16 a[178:179], v246 offset:22528
  v_add_f32 v237, v237, v226
  v_cvt_pk_bf16_f32 v199, v230, v231
  v_fma_f32 v230, v150, s28, -v233
  v_accvgpr_mov_b32 a32, a96
  v_mfma_f32_32x32x16_bf16 v[176:191], a[140:143], a[108:111], v[176:191]
  ds_read_b64_tr_b16 a[180:181], v247 offset:20480
  v_exp_f32 v230, v230
  v_fma_f32 v231, v151, s28, -v233
  v_add_f32 v237, v237, v227
  v_accvgpr_mov_b32 a33, a97
  v_mfma_f32_32x32x16_bf16 v[160:175], a[144:147], a[80:83], v[160:175]
  ds_read_b64_tr_b16 a[182:183], v247 offset:22528
  v_exp_f32 v231, v231
  v_add_f32 v237, v237, v228
  v_cvt_pk_bf16_f32 v200, v224, v225
  v_accvgpr_mov_b32 a34, a98
  v_mfma_f32_32x32x16_bf16 v[176:191], a[144:147], a[112:115], v[176:191]
  ds_read_b64_tr_b16 a[184:185], v248 offset:20480
  ds_read_b64_tr_b16 a[186:187], v248 offset:22528
  v_fma_f32 v224, v152, s28, -v233
  v_add_f32 v237, v237, v229
  v_fma_f32 v225, v153, s28, -v233
  v_accvgpr_mov_b32 a35, a99
  v_mfma_f32_32x32x16_bf16 v[160:175], a[148:151], a[84:87], v[160:175]
  ds_read_b64_tr_b16 a[188:189], v249 offset:20480
  v_exp_f32 v224, v224
  v_add_f32 v237, v237, v230
  v_cvt_pk_bf16_f32 v201, v226, v227
  v_accvgpr_mov_b32 a36, a100
  v_mfma_f32_32x32x16_bf16 v[176:191], a[148:151], a[116:119], v[176:191]
  ds_read_b64_tr_b16 a[190:191], v249 offset:22528
  v_exp_f32 v225, v225
  v_fma_f32 v226, v154, s28, -v233
  v_add_f32 v237, v237, v231
  v_accvgpr_mov_b32 a37, a101
  v_mfma_f32_32x32x16_bf16 v[160:175], a[152:155], a[88:91], v[160:175]
  v_exp_f32 v226, v226
  v_fma_f32 v227, v155, s28, -v233
  v_add_f32 v237, v237, v224
  v_cvt_pk_bf16_f32 v202, v228, v229
  v_accvgpr_mov_b32 a38, a102
  v_mfma_f32_32x32x16_bf16 v[176:191], a[152:155], a[120:123], v[176:191]
  v_exp_f32 v227, v227
  v_fma_f32 v228, v156, s28, -v233
  v_add_f32 v237, v237, v225
  v_fma_f32 v229, v157, s28, -v233
  v_accvgpr_mov_b32 a39, a103
  v_mfma_f32_32x32x16_bf16 v[160:175], a[156:159], a[92:95], v[160:175]
  v_exp_f32 v228, v228
  v_add_f32 v237, v237, v226
  v_exp_f32 v229, v229
  v_add_f32 v237, v237, v227
  v_cvt_pk_bf16_f32 v203, v230, v231
  v_fma_f32 v230, v158, s28, -v233
  v_add_f32 v237, v237, v228
  v_fma_f32 v231, v159, s28, -v233
  v_exp_f32 v230, v230
  v_add_f32 v237, v237, v229
  v_exp_f32 v231, v231
  v_add_f32 v237, v237, v230
  v_cvt_pk_bf16_f32 v204, v224, v225
  v_add_f32 v237, v237, v231
  s_nop 0
  v_max_f32 v224, v236, v237
  v_cmp_lt_f32 vcc, s29, v224
  v_mfma_f32_32x32x16_bf16 v[176:191], a[156:159], a[124:127], v[176:191]
  v_cvt_pk_bf16_f32 v205, v226, v227
  v_cvt_pk_bf16_f32 v206, v228, v229
  v_cvt_pk_bf16_f32 v207, v230, v231
  s_cbranch_vccnz RARE_2
RET_2:
  s_waitcnt lgkmcnt(0)
  v_mfma_f32_32x32x16_bf16 v[0:15], a[160:163], v[192:195], v[0:15]
  s_add_u32 s22, s22, 0x4000
  s_add_u32 m0, s20, 65536
  v_add_f32 v234, v234, v236
  v_add_f32 v235, v235, v237
  v_mfma_f32_32x32x16_bf16 v[64:79], a[160:163], v[200:203], v[64:79]
  ds_read_b128 a[128:131], v238 offset:40960
  v_fma_f32 v224, v160, s28, -v232
  v_fma_f32 v225, v161, s28, -v232
  v_fma_f32 v226, v162, s28, -v232
  v_exp_f32 v224, v224
  v_mfma_f32_32x32x16_bf16 v[16:31], a[164:167], v[192:195], v[16:31]
  ds_read_b128 a[132:135], v239 offset:40960
  buffer_load_dwordx4 v254, s[12:15], s22 offen offset:0 nt lds
  v_exp_f32 v225, v225
  v_fma_f32 v227, v163, s28, -v232
  v_fma_f32 v228, v164, s28, -v232
  v_mfma_f32_32x32x16_bf16 v[80:95], a[164:167], v[200:203], v[80:95]
  ds_read_b128 a[136:139], v240 offset:40960
  buffer_load_dwordx4 v254, s[12:15], s22 offen offset:1024 nt lds
  v_exp_f32 v226, v226
  v_fma_f32 v229, v165, s28, -v232
  v_add_f32 v236, v224, v225
  v_mfma_f32_32x32x16_bf16 v[32:47], a[168:171], v[192:195], v[32:47]
  ds_read_b128 a[140:143], v241 offset:40960
  v_exp_f32 v227, v227
  v_fma_f32 v230, v166, s28, -v232
  v_exp_f32 v228, v228
  v_mfma_f32_32x32x16_bf16 v[96:111], a[168:171], v[200:203], v[96:111]
  ds_read_b128 a[144:147], v242 offset:40960
  buffer_load_dwordx4 v254, s[12:15], s22 offen offset:2048 nt lds
  v_exp_f32 v229, v229
  v_fma_f32 v231, v167, s28, -v232
  v_add_f32 v236, v236, v226
  v_mfma_f32_32x32x16_bf16 v[48:63], a[172:175], v[192:195], v[48:63]
  ds_read_b128 a[148:151], v243 offset:40960
  v_exp_f32 v230, v230
  v_add_f32 v236, v236, v227
  v_exp_f32 v231, v231
  v_mfma_f32_32x32x16_bf16 v[112:127], a[172:175], v[200:203], v[112:127]
  ds_read_b128 a[152:155], v244 offset:40960
  buffer_load_dwordx4 v254, s[12:15], s22 offen offset:3072 nt lds
  v_add_f32 v236, v236, v228
  v_cvt_pk_bf16_f32 v208, v224, v225
  v_fma_f32 v224, v168, s28, -v232
  v_add_f32 v236, v236, v229
  v_mfma_f32_32x32x16_bf16 v[0:15], a[176:179], v[196:199], v[0:15]
  ds_read_b128 a[156:159], v245 offset:40960
  v_exp_f32 v224, v224
  v_fma_f32 v225, v169, s28, -v232
  v_add_f32 v236, v236, v230
  v_cvt_pk_bf16_f32 v209, v226, v227
  v_mfma_f32_32x32x16_bf16 v[64:79], a[176:179], v[204:207], v[64:79]
  s_add_u32 s31, s23, 4096
  s_add_u32 m0, s30, 4096
  v_exp_f32 v225, v225
  v_accvgpr_mov_b32 a40, a104
  v_accvgpr_mov_b32 a46, a110
  v_mfma_f32_32x32x16_bf16 v[16:31], a[180:183], v[196:199], v[16:31]
  buffer_load_dwordx4 v250, s[4:7], s31 offen offset:0 nt lds
  v_fma_f32 v226, v170, s28, -v232
  v_add_f32 v236, v236, v231
  v_fma_f32 v227, v171, s28, -v232
  v_accvgpr_mov_b32 a41, a105
  v_accvgpr_mov_b32 a47, a111
  v_mfma_f32_32x32x16_bf16 v[80:95], a[180:183], v[204:207], v[80:95]
  v_exp_f32 v226, v226
  v_add_f32 v236, v236, v224
  v_exp_f32 v227, v227
  v_accvgpr_mov_b32 a42, a106
  v_mfma_f32_32x32x16_bf16 v[32:47], a[184:187], v[196:199], v[32:47]
  buffer_load_dwordx4 v251, s[4:7], s31 offen offset:1024 nt lds
  v_add_f32 v236, v236, v225
  v_cvt_pk_bf16_f32 v210, v228, v229
  v_fma_f32 v228, v172, s28, -v232
  v_add_f32 v236, v236, v226
  v_accvgpr_mov_b32 a43, a107
  v_mfma_f32_32x32x16_bf16 v[96:111], a[184:187], v[204:207], v[96:111]
  v_exp_f32 v228, v228
  v_fma_f32 v229, v173, s28, -v232
  v_add_f32 v236, v236, v227
  v_cvt_pk_bf16_f32 v211, v230, v231
  v_accvgpr_mov_b32 a44, a108
  v_mfma_f32_32x32x16_bf16 v[48:63], a[188:191], v[196:199], v[48:63]
  v_exp_f32 v229, v229
  v_fma_f32 v230, v174, s28, -v232
  v_add_f32 v236, v236, v228
  v_fma_f32 v231, v175, s28, -v232
  v_accvgpr_mov_b32 a45, a109
  v_mfma_f32_32x32x16_bf16 v[112:127], a[188:191], v[204:207], v[112:127]
  v_exp_f32 v230, v230
  v_add_f32 v236, v236, v229
  v_exp_f32 v231, v231
  s_waitcnt lgkmcnt(0)
  v_mfma_f32_32x32x16_bf16 v[128:143], a[128:131], a[64:67], 0
  ds_read_b64_tr_b16 a[160:161], v246 offset:24576
  ds_read_b64_tr_b16 a[162:163], v246 offset:26624
  v_add_f32 v236, v236, v230
  v_cvt_pk_bf16_f32 v212, v224, v225
  v_fma_f32 v224, v176, s28, -v233
  v_add_f32 v236, v236, v231
  v_mfma_f32_32x32x16_bf16 v[144:159], a[128:131], a[96:99], 0
  ds_read_b64_tr_b16 a[164:165], v247 offset:24576
  v_exp_f32 v224, v224
  v_fma_f32 v225, v177, s28, -v233
  v_cvt_pk_bf16_f32 v213, v226, v227
  v_fma_f32 v226, v178, s28, -v233
  v_mfma_f32_32x32x16_bf16 v[128:143], a[132:135], a[68:71], v[128:143]
  ds_read_b64_tr_b16 a[166:167], v247 offset:26624
  v_exp_f32 v225, v225
  v_fma_f32 v227, v179, s28, -v233
  v_exp_f32 v226, v226
  v_mfma_f32_32x32x16_bf16 v[144:159], a[132:135], a[100:103], v[144:159]
  ds_read_b64_tr_b16 a[168:169], v248 offset:24576
  ds_read_b64_tr_b16 a[170:171], v248 offset:26624
  v_exp_f32 v227, v227
  v_add_f32 v237, v224, v225
  v_cvt_pk_bf16_f32 v214, v228, v229
  v_mfma_f32_32x32x16_bf16 v[128:143], a[136:139], a[72:75], v[128:143]
  ds_read_b64_tr_b16 a[172:173], v249 offset:24576
  v_fma_f32 v228, v180, s28, -v233
  v_add_f32 v237, v237, v226
  v_fma_f32 v229, v181, s28, -v233
  v_exp_f32 v228, v228
  v_mfma_f32_32x32x16_bf16 v[144:159], a[136:139], a[104:107], v[144:159]
  ds_read_b64_tr_b16 a[174:175], v249 offset:26624
  v_exp_f32 v229, v229
  v_add_f32 v237, v237, v227
  v_cvt_pk_bf16_f32 v215, v230, v231
  v_fma_f32 v230, v182, s28, -v233
  v_mfma_f32_32x32x16_bf16 v[128:143], a[140:143], a[76:79], v[128:143]
  ds_read_b64_tr_b16 a[176:177], v246 offset:28672
  ds_read_b64_tr_b16 a[178:179], v246 offset:30720
  v_exp_f32 v230, v230
  v_fma_f32 v231, v183, s28, -v233
  v_accvgpr_mov_b32 a48, a112
  v_mfma_f32_32x32x16_bf16 v[144:159], a[140:143], a[108:111], v[144:159]
  ds_read_b64_tr_b16 a[180:181], v247 offset:28672
  v_exp_f32 v231, v231
  v_add_f32 v237, v237, v228
  v_cvt_pk_bf16_f32 v216, v224, v225
  v_accvgpr_mov_b32 a49, a113
  v_mfma_f32_32x32x16_bf16 v[128:143], a[144:147], a[80:83], v[128:143]
  ds_read_b64_tr_b16 a[182:183], v247 offset:30720
  v_fma_f32 v224, v184, s28, -v233
  v_add_f32 v237, v237, v229
  v_fma_f32 v225, v185, s28, -v233
  v_add_f32 v237, v237, v230
  v_accvgpr_mov_b32 a50, a114
  v_mfma_f32_32x32x16_bf16 v[144:159], a[144:147], a[112:115], v[144:159]
  ds_read_b64_tr_b16 a[184:185], v248 offset:28672
  ds_read_b64_tr_b16 a[186:187], v248 offset:30720
  v_exp_f32 v224, v224
  v_add_f32 v237, v237, v231
  v_accvgpr_mov_b32 a51, a115
  v_mfma_f32_32x32x16_bf16 v[128:143], a[148:151], a[84:87], v[128:143]
  ds_read_b64_tr_b16 a[188:189], v249 offset:28672
  v_exp_f32 v225, v225
  v_add_f32 v237, v237, v224
  v_cvt_pk_bf16_f32 v217, v226, v227
  v_accvgpr_mov_b32 a52, a116
  v_mfma_f32_32x32x16_bf16 v[144:159], a[148:151], a[116:119], v[144:159]
  ds_read_b64_tr_b16 a[190:191], v249 offset:30720
  v_fma_f32 v226, v186, s28, -v233
  v_add_f32 v237, v237, v225
  v_fma_f32 v227, v187, s28, -v233
  v_cvt_pk_bf16_f32 v218, v228, v229
  v_accvgpr_mov_b32 a53, a117
  v_mfma_f32_32x32x16_bf16 v[128:143], a[152:155], a[88:91], v[128:143]
  v_exp_f32 v226, v226
  v_fma_f32 v228, v188, s28, -v233
  v_exp_f32 v227, v227
  v_accvgpr_mov_b32 a54, a118
  v_mfma_f32_32x32x16_bf16 v[144:159], a[152:155], a[120:123], v[144:159]
  v_exp_f32 v228, v228
  v_fma_f32 v229, v189, s28, -v233
  v_add_f32 v237, v237, v226
  v_cvt_pk_bf16_f32 v219, v230, v231
  v_accvgpr_mov_b32 a55, a119
  v_mfma_f32_32x32x16_bf16 v[128:143], a[156:159], a[92:95], v[128:143]
  v_exp_f32 v229, v229
  v_fma_f32 v230, v190, s28, -v233
  v_add_f32 v237, v237, v227
  v_fma_f32 v231, v191, s28, -v233
  v_exp_f32 v230, v230
  v_add_f32 v237, v237, v228
  v_exp_f32 v231, v231
  v_add_f32 v237, v237, v229
  v_cvt_pk_bf16_f32 v220, v224, v225
  v_add_f32 v237, v237, v230
  s_nop 0
  v_add_f32 v237, v237, v231
  s_nop 0
  v_max_f32 v224, v236, v237
  v_cmp_lt_f32 vcc, s29, v224
  v_mfma_f32_32x32x16_bf16 v[144:159], a[156:159], a[124:127], v[144:159]
  v_cvt_pk_bf16_f32 v221, v226, v227
  v_cvt_pk_bf16_f32 v222, v228, v229
  v_cvt_pk_bf16_f32 v223, v230, v231
  s_cbranch_vccnz RARE_3
RET_3:
  s_waitcnt vmcnt(22) lgkmcnt(0)
  v_mfma_f32_32x32x16_bf16 v[0:15], a[160:163], v[208:211], v[0:15]
  s_barrier
  v_mfma_f32_32x32x16_bf16 v[64:79], a[160:163], v[216:219], v[64:79]
  ds_read_b128 a[128:131], v238 offset:49152
  s_add_u32 s21, s21, 0x4000
  s_add_u32 m0, s20, 32768
  v_fma_f32 v224, v128, s28, -v232
  v_add_f32 v234, v234, v236
  v_add_f32 v235, v235, v237
  v_mfma_f32_32x32x16_bf16 v[16:31], a[164:167], v[208:211], v[16:31]
  ds_read_b128 a[132:135], v239 offset:49152
  buffer_load_dwordx4 v250, s[8:11], s21 offen offset:0 nt lds
  v_exp_f32 v224, v224
  v_fma_f32 v225, v129, s28, -v232
  v_fma_f32 v226, v130, s28, -v232
  v_mfma_f32_32x32x16_bf16 v[80:95], a[164:167], v[216:219], v[80:95]
  ds_read_b128 a[136:139], v240 offset:49152
  buffer_load_dwordx4 v251, s[8:11], s21 offen offset:1024 nt lds
  v_exp_f32 v225, v225
  v_fma_f32 v227, v131, s28, -v232
  v_fma_f32 v228, v132, s28, -v232
  v_mfma_f32_32x32x16_bf16 v[32:47], a[168:171], v[208:211], v[32:47]
  ds_read_b128 a[140:143], v241 offset:49152
  v_exp_f32 v226, v226
  v_fma_f32 v229, v133, s28, -v232
  v_exp_f32 v227, v227
  v_mfma_f32_32x32x16_bf16 v[96:111], a[168:171], v[216:219], v[96:111]
  ds_read_b128 a[144:147], v242 offset:49152
  buffer_load_dwordx4 v252, s[8:11], s21 offen offset:2048 nt lds
  v_exp_f32 v228, v228
  v_fma_f32 v230, v134, s28, -v232
  v_add_f32 v236, v224, v225
  v_mfma_f32_32x32x16_bf16 v[48:63], a[172:175], v[208:211], v[48:63]
  ds_read_b128 a[148:151], v243 offset:49152
  v_exp_f32 v229, v229
  v_fma_f32 v231, v135, s28, -v232
  v_exp_f32 v230, v230
  v_mfma_f32_32x32x16_bf16 v[112:127], a[172:175], v[216:219], v[112:127]
  ds_read_b128 a[152:155], v244 offset:49152
  buffer_load_dwordx4 v253, s[8:11], s21 offen offset:3072 nt lds
  v_exp_f32 v231, v231
  v_add_f32 v236, v236, v226
  v_cvt_pk_bf16_f32 v192, v224, v225
  v_mfma_f32_32x32x16_bf16 v[0:15], a[176:179], v[212:215], v[0:15]
  ds_read_b128 a[156:159], v245 offset:49152
  v_fma_f32 v224, v136, s28, -v232
  v_add_f32 v236, v236, v227
  v_fma_f32 v225, v137, s28, -v232
  v_exp_f32 v224, v224
  v_mfma_f32_32x32x16_bf16 v[64:79], a[176:179], v[220:223], v[64:79]
  s_add_u32 s31, s23, 4096
  s_add_u32 m0, s30, 4096
  v_exp_f32 v225, v225
  v_accvgpr_mov_b32 a56, a120
  v_accvgpr_mov_b32 a62, a126
  v_mfma_f32_32x32x16_bf16 v[16:31], a[180:183], v[212:215], v[16:31]
  buffer_load_dwordx4 v252, s[4:7], s31 offen offset:2048 nt lds
  v_add_f32 v236, v236, v228
  v_cvt_pk_bf16_f32 v193, v226, v227
  v_fma_f32 v226, v138, s28, -v232
  v_accvgpr_mov_b32 a57, a121
  v_accvgpr_mov_b32 a63, a127
  v_mfma_f32_32x32x16_bf16 v[80:95], a[180:183], v[220:223], v[80:95]
  v_exp_f32 v226, v226
  v_fma_f32 v227, v139, s28, -v232
  v_add_f32 v236, v236, v229
  v_cvt_pk_bf16_f32 v194, v228, v229
  v_accvgpr_mov_b32 a58, a122
  v_mfma_f32_32x32x16_bf16 v[32:47], a[184:187], v[212:215], v[32:47]
  buffer_load_dwordx4 v253, s[4:7], s31 offen offset:3072 nt lds
  v_exp_f32 v227, v227
  v_fma_f32 v228, v140, s28, -v232
  v_add_f32 v236, v236, v230
  v_accvgpr_mov_b32 a59, a123
  v_mfma_f32_32x32x16_bf16 v[96:111], a[184:187], v[220:223], v[96:111]
  v_exp_f32 v228, v228
  v_fma_f32 v229, v141, s28, -v232
  v_add_f32 v236, v236, v231
  v_cvt_pk_bf16_f32 v195, v230, v231
  v_accvgpr_mov_b32 a60, a124
  v_mfma_f32_32x32x16_bf16 v[48:63], a[188:191], v[212:215], v[48:63]
  v_exp_f32 v229, v229
  v_fma_f32 v230, v142, s28, -v232
  v_add_f32 v236, v236, v224
  v_fma_f32 v231, v143, s28, -v232
  v_accvgpr_mov_b32 a61, a125
  v_mfma_f32_32x32x16_bf16 v[112:127], a[188:191], v[220:223], v[112:127]
  v_exp_f32 v230, v230
  v_add_f32 v236, v236, v225
  v_exp_f32 v231, v231
  s_waitcnt lgkmcnt(0)
  v_mfma_f32_32x32x16_bf16 v[160:175], a[128:131], a[0:3], 0
  ds_read_b64_tr_b16 a[160:161], v246 offset:32768
  ds_read_b64_tr_b16 a[162:163], v246 offset:34816
  v_add_f32 v236, v236, v226
  v_cvt_pk_bf16_f32 v196, v224, v225
  v_fma_f32 v224, v144, s28, -v233
  v_add_f32 v236, v236, v227
  v_mfma_f32_32x32x16_bf16 v[176:191], a[128:131], a[32:35], 0
  ds_read_b64_tr_b16 a[164:165], v247 offset:32768
  v_exp_f32 v224, v224
  v_fma_f32 v225, v145, s28, -v233
  v_add_f32 v236, v236, v228
  v_cvt_pk_bf16_f32 v197, v226, v227
  v_mfma_f32_32x32x16_bf16 v[160:175], a[132:135], a[4:7], v[160:175]
  ds_read_b64_tr_b16 a[166:167], v247 offset:34816
  v_exp_f32 v225, v225
  v_fma_f32 v226, v146, s28, -v233
  v_add_f32 v236, v236, v229
  v_fma_f32 v227, v147, s28, -v233
  v_mfma_f32_32x32x16_bf16 v[176:191], a[132:135], a[36:39], v[176:191]
  ds_read_b64_tr_b16 a[168:169], v248 offset:32768
  ds_read_b64_tr_b16 a[170:171], v248 offset:34816
  v_exp_f32 v226, v226
  v_add_f32 v236, v236, v230
  v_cvt_pk_bf16_f32 v198, v228, v229
  v_mfma_f32_32x32x16_bf16 v[160:175], a[136:139], a[8:11], v[160:175]
  ds_read_b64_tr_b16 a[172:173], v249 offset:32768
  v_exp_f32 v227, v227
  v_fma_f32 v228, v148, s28, -v233
  v_add_f32 v236, v236, v231
  v_fma_f32 v229, v149, s28, -v233
  v_mfma_f32_32x32x16_bf16 v[176:191], a[136:139], a[40:43], v[176:191]
  ds_read_b64_tr_b16 a[174:175], v249 offset:34816
  v_exp_f32 v228, v228
  v_add_f32 v237, v224, v225
  v_exp_f32 v229, v229
  v_mfma_f32_32x32x16_bf16 v[160:175], a[140:143], a[12:15], v[160:175]
  ds_read_b64_tr_b16 a[176:177], v246 offset:36864
  ds_read_b64_tr_b16 a[178:179], v246 offset:38912
  v_add_f32 v237, v237, v226
  v_cvt_pk_bf16_f32 v199, v230, v231
  v_fma_f32 v230, v150, s28, -v233
  v_add_f32 v237, v237, v227
  v_mfma_f32_32x32x16_bf16 v[176:191], a[140:143], a[44:47], v[176:191]
  ds_read_b64_tr_b16 a[180:181], v247 offset:36864
  v_exp_f32 v230, v230
  v_fma_f32 v231, v151, s28, -v233
  v_add_f32 v237, v237, v228
  v_cvt_pk_bf16_f32 v200, v224, v225
  v_mfma_f32_32x32x16_bf16 v[160:175], a[144:147], a[16:19], v[160:175]
  ds_read_b64_tr_b16 a[182:183], v247 offset:38912
  v_exp_f32 v231, v231
  v_fma_f32 v224, v152, s28, -v233
  v_add_f32 v237, v237, v229
  v_fma_f32 v225, v153, s28, -v233
  v_mfma_f32_32x32x16_bf16 v[176:191], a[144:147], a[48:51], v[176:191]
  ds_read_b64_tr_b16 a[184:185], v248 offset:36864
  ds_read_b64_tr_b16 a[186:187], v248 offset:38912
  v_exp_f32 v224, v224
  v_add_f32 v237, v237, v230
  v_cvt_pk_bf16_f32 v201, v226, v227
  v_mfma_f32_32x32x16_bf16 v[160:175], a[148:151], a[20:23], v[160:175]
  ds_read_b64_tr_b16 a[188:189], v249 offset:36864
  v_exp_f32 v225, v225
  v_fma_f32 v226, v154, s28, -v233
  v_add_f32 v237, v237, v231
  v_fma_f32 v227, v155, s28, -v233
  v_mfma_f32_32x32x16_bf16 v[176:191], a[148:151], a[52:55], v[176:191]
  ds_read_b64_tr_b16 a[190:191], v249 offset:38912
  v_exp_f32 v226, v226
  v_add_f32 v237, v237, v224
  v_exp_f32 v227, v227
  v_mfma_f32_32x32x16_bf16 v[160:175], a[152:155], a[24:27], v[160:175]
  buffer_store_dwordx4 a[192:195], v255, s[16:19], s80 offen offset:0 nt
  buffer_store_dwordx4 a[208:211], v255, s[16:19], s80 offen offset:128 nt
  v_add_f32 v237, v237, v225
  v_cvt_pk_bf16_f32 v202, v228, v229
  v_fma_f32 v228, v156, s28, -v233
  v_add_f32 v237, v237, v226
  v_mfma_f32_32x32x16_bf16 v[176:191], a[152:155], a[56:59], v[176:191]
  v_exp_f32 v228, v228
  v_fma_f32 v229, v157, s28, -v233
  v_add_f32 v237, v237, v227
  v_cvt_pk_bf16_f32 v203, v230, v231
  v_fma_f32 v230, v158, s28, -v233
  v_mfma_f32_32x32x16_bf16 v[160:175], a[156:159], a[28:31], v[160:175]
  v_exp_f32 v229, v229
  v_fma_f32 v231, v159, s28, -v233
  v_exp_f32 v230, v230
  v_add_f32 v237, v237, v228
  v_exp_f32 v231, v231
  v_add_f32 v237, v237, v229
  v_cvt_pk_bf16_f32 v204, v224, v225
  v_add_f32 v237, v237, v230
  s_nop 0
  v_add_f32 v237, v237, v231
  s_nop 0
  v_max_f32 v224, v236, v237
  v_cmp_lt_f32 vcc, s29, v224
  v_mfma_f32_32x32x16_bf16 v[176:191], a[156:159], a[60:63], v[176:191]
  v_cvt_pk_bf16_f32 v205, v226, v227
  v_cvt_pk_bf16_f32 v206, v228, v229
  v_cvt_pk_bf16_f32 v207, v230, v231
  s_cbranch_vccnz RARE_4
RET_4:
  s_waitcnt lgkmcnt(0)
  v_mfma_f32_32x32x16_bf16 v[0:15], a[160:163], v[192:195], v[0:15]
  s_add_u32 s22, s22, 0x4000
  s_add_u32 m0, s20, 81920
  v_add_f32 v234, v234, v236
  v_add_f32 v235, v235, v237
  v_mfma_f32_32x32x16_bf16 v[64:79], a[160:163], v[200:203], v[64:79]
  ds_read_b128 a[128:131], v238 offset:57344
  v_fma_f32 v224, v160, s28, -v232
  v_fma_f32 v225, v161, s28, -v232
  v_fma_f32 v226, v162, s28, -v232
  v_exp_f32 v224, v224
  v_mfma_f32_32x32x16_bf16 v[16:31], a[164:167], v[192:195], v[16:31]
  ds_read_b128 a[132:135], v239 offset:57344
  v_exp_f32 v225, v225
  v_fma_f32 v227, v163, s28, -v232
  v_exp_f32 v226, v226
  v_mfma_f32_32x32x16_bf16 v[80:95], a[164:167], v[200:203], v[80:95]
  ds_read_b128 a[136:139], v240 offset:57344
  v_exp_f32 v227, v227
  v_fma_f32 v228, v164, s28, -v232
  v_add_f32 v236, v224, v225
  v_fma_f32 v229, v165, s28, -v232
  v_mfma_f32_32x32x16_bf16 v[32:47], a[168:171], v[192:195], v[32:47]
  ds_read_b128 a[140:143], v241 offset:57344
  v_exp_f32 v228, v228
  v_fma_f32 v230, v166, s28, -v232
  v_exp_f32 v229, v229
  v_mfma_f32_32x32x16_bf16 v[96:111], a[168:171], v[200:203], v[96:111]
  ds_read_b128 a[144:147], v242 offset:57344
  v_exp_f32 v230, v230
  v_fma_f32 v231, v167, s28, -v232
  v_add_f32 v236, v236, v226
  v_cvt_pk_bf16_f32 v208, v224, v225
  v_mfma_f32_32x32x16_bf16 v[48:63], a[172:175], v[192:195], v[48:63]
  ds_read_b128 a[148:151], v243 offset:57344
  v_exp_f32 v231, v231
  v_fma_f32 v224, v168, s28, -v232
  v_add_f32 v236, v236, v227
  v_fma_f32 v225, v169, s28, -v232
  v_mfma_f32_32x32x16_bf16 v[112:127], a[172:175], v[200:203], v[112:127]
  ds_read_b128 a[152:155], v244 offset:57344
  v_exp_f32 v224, v224
  v_add_f32 v236, v236, v228
  v_exp_f32 v225, v225
  v_mfma_f32_32x32x16_bf16 v[0:15], a[176:179], v[196:199], v[0:15]
  ds_read_b128 a[156:159], v245 offset:57344
  v_add_f32 v236, v236, v229
  v_cvt_pk_bf16_f32 v209, v226, v227
  v_fma_f32 v226, v170, s28, -v232
  v_add_f32 v236, v236, v230
  v_fma_f32 v227, v171, s28, -v232
  v_mfma_f32_32x32x16_bf16 v[64:79], a[176:179], v[204:207], v[64:79]
  buffer_load_dwordx4 v254, s[12:15], s22 offen offset:0 nt lds
  v_exp_f32 v226, v226
  v_add_f32 v236, v236, v231
  v_exp_f32 v227, v227
  v_mfma_f32_32x32x16_bf16 v[16:31], a[180:183], v[196:199], v[16:31]
  buffer_load_dwordx4 v254, s[12:15], s22 offen offset:1024 nt lds
  v_add_f32 v236, v236, v224
  v_cvt_pk_bf16_f32 v210, v228, v229
  v_fma_f32 v228, v172, s28, -v232
  v_add_f32 v236, v236, v225
  v_fma_f32 v229, v173, s28, -v232
  v_mfma_f32_32x32x16_bf16 v[80:95], a[180:183], v[204:207], v[80:95]
  v_exp_f32 v228, v228
  v_add_f32 v236, v236, v226
  v_exp_f32 v229, v229
  v_add_f32 v236, v236, v227
  v_mfma_f32_32x32x16_bf16 v[32:47], a[184:187], v[196:199], v[32:47]
  buffer_load_dwordx4 v254, s[12:15], s22 offen offset:2048 nt lds
  v_add_f32 v236, v236, v228
  v_cvt_pk_bf16_f32 v211, v230, v231
  v_fma_f32 v230, v174, s28, -v232
  v_add_f32 v236, v236, v229
  v_fma_f32 v231, v175, s28, -v232
  v_mfma_f32_32x32x16_bf16 v[96:111], a[184:187], v[204:207], v[96:111]
  buffer_load_dwordx4 v254, s[12:15], s22 offen offset:3072 nt lds
  v_exp_f32 v230, v230
  v_cvt_pk_bf16_f32 v212, v224, v225
  v_exp_f32 v231, v231
  v_mfma_f32_32x32x16_bf16 v[48:63], a[188:191], v[196:199], v[48:63]
  v_fma_f32 v224, v176, s28, -v233
  v_add_f32 v236, v236, v230
  v_fma_f32 v225, v177, s28, -v233
  v_exp_f32 v224, v224
  v_add_f32 v236, v236, v231
  v_mfma_f32_32x32x16_bf16 v[112:127], a[188:191], v[204:207], v[112:127]
  v_exp_f32 v225, v225
  v_cvt_pk_bf16_f32 v213, v226, v227
  v_fma_f32 v226, v178, s28, -v233
  v_add_f32 v237, v224, v225
  s_waitcnt lgkmcnt(0)
  v_mfma_f32_32x32x16_bf16 v[128:143], a[128:131], a[0:3], 0
  ds_read_b64_tr_b16 a[160:161], v246 offset:40960
  ds_read_b64_tr_b16 a[162:163], v246 offset:43008
  v_exp_f32 v226, v226
  v_fma_f32 v227, v179, s28, -v233
  v_cvt_pk_bf16_f32 v214, v228, v229
  v_mfma_f32_32x32x16_bf16 v[144:159], a[128:131], a[32:35], 0
  ds_read_b64_tr_b16 a[164:165], v247 offset:40960
  v_exp_f32 v227, v227
  v_fma_f32 v228, v180, s28, -v233
  v_add_f32 v237, v237, v226
  v_fma_f32 v229, v181, s28, -v233
  v_mfma_f32_32x32x16_bf16 v[128:143], a[132:135], a[4:7], v[128:143]
  ds_read_b64_tr_b16 a[166:167], v247 offset:43008
  v_exp_f32 v228, v228
  v_add_f32 v237, v237, v227
  v_exp_f32 v229, v229
  v_mfma_f32_32x32x16_bf16 v[144:159], a[132:135], a[36:39], v[144:159]
  ds_read_b64_tr_b16 a[168:169], v248 offset:40960
  ds_read_b64_tr_b16 a[170:171], v248 offset:43008
  v_add_f32 v237, v237, v228
  v_cvt_pk_bf16_f32 v215, v230, v231
  v_fma_f32 v230, v182, s28, -v233
  v_add_f32 v237, v237, v229
  v_mfma_f32_32x32x16_bf16 v[128:143], a[136:139], a[8:11], v[128:143]
  ds_read_b64_tr_b16 a[172:173], v249 offset:40960
  v_exp_f32 v230, v230
  v_fma_f32 v231, v183, s28, -v233
  v_cvt_pk_bf16_f32 v216, v224, v225
  v_fma_f32 v224, v184, s28, -v233
  v_mfma_f32_32x32x16_bf16 v[144:159], a[136:139], a[40:43], v[144:159]
  ds_read_b64_tr_b16 a[174:175], v249 offset:43008
  v_exp_f32 v231, v231
  v_fma_f32 v225, v185, s28, -v233
  v_exp_f32 v224, v224
  v_mfma_f32_32x32x16_bf16 v[128:143], a[140:143], a[12:15], v[128:143]
  ds_read_b64_tr_b16 a[176:177], v246 offset:45056
  ds_read_b64_tr_b16 a[178:179], v246 offset:47104
  v_exp_f32 v225, v225
  v_add_f32 v237, v237, v230
  v_cvt_pk_bf16_f32 v217, v226, v227
  v_mfma_f32_32x32x16_bf16 v[144:159], a[140:143], a[44:47], v[144:159]
  ds_read_b64_tr_b16 a[180:181], v247 offset:45056
  v_fma_f32 v226, v186, s28, -v233
  v_add_f32 v237, v237, v231
  v_fma_f32 v227, v187, s28, -v233
  v_exp_f32 v226, v226
  v_mfma_f32_32x32x16_bf16 v[128:143], a[144:147], a[16:19], v[128:143]
  ds_read_b64_tr_b16 a[182:183], v247 offset:47104
  v_exp_f32 v227, v227
  v_add_f32 v237, v237, v224
  v_cvt_pk_bf16_f32 v218, v228, v229
  v_fma_f32 v228, v188, s28, -v233
  v_mfma_f32_32x32x16_bf16 v[144:159], a[144:147], a[48:51], v[144:159]
  ds_read_b64_tr_b16 a[184:185], v248 offset:45056
  ds_read_b64_tr_b16 a[186:187], v248 offset:47104
  v_exp_f32 v228, v228
  v_fma_f32 v229, v189, s28, -v233
  v_add_f32 v237, v237, v225
  v_mfma_f32_32x32x16_bf16 v[128:143], a[148:151], a[20:23], v[128:143]
  ds_read_b64_tr_b16 a[188:189], v249 offset:45056
  v_exp_f32 v229, v229
  v_add_f32 v237, v237, v226
  v_cvt_pk_bf16_f32 v219, v230, v231
  v_fma_f32 v230, v190, s28, -v233
  v_mfma_f32_32x32x16_bf16 v[144:159], a[148:151], a[52:55], v[144:159]
  ds_read_b64_tr_b16 a[190:191], v249 offset:47104
  v_exp_f32 v230, v230
  v_fma_f32 v231, v191, s28, -v233
  v_add_f32 v237, v237, v227
  v_cvt_pk_bf16_f32 v220, v224, v225
  v_mfma_f32_32x32x16_bf16 v[128:143], a[152:155], a[24:27], v[128:143]
  buffer_store_dwordx4 a[196:199], v255, s[16:19], s80 offen offset:2048 nt
  buffer_store_dwordx4 a[212:215], v255, s[16:19], s80 offen offset:2176 nt
  v_exp_f32 v231, v231
  v_add_f32 v237, v237, v228
  v_cvt_pk_bf16_f32 v221, v226, v227
  v_mfma_f32_32x32x16_bf16 v[144:159], a[152:155], a[56:59], v[144:159]
  v_add_f32 v237, v237, v229
  v_cvt_pk_bf16_f32 v222, v228, v229
  v_add_f32 v237, v237, v230
  v_cvt_pk_bf16_f32 v223, v230, v231
  v_add_f32 v237, v237, v231
  v_mfma_f32_32x32x16_bf16 v[128:143], a[156:159], a[28:31], v[128:143]
  v_max_f32 v224, v236, v237
  v_cmp_lt_f32 vcc, s29, v224
  v_mfma_f32_32x32x16_bf16 v[144:159], a[156:159], a[60:63], v[144:159]
  s_cbranch_vccnz RARE_5
RET_5:
  s_waitcnt vmcnt(28) lgkmcnt(0)
  v_mfma_f32_32x32x16_bf16 v[0:15], a[160:163], v[208:211], v[0:15]
  s_barrier
  v_mfma_f32_32x32x16_bf16 v[64:79], a[160:163], v[216:219], v[64:79]
  ds_read_b128 a[128:131], v238 offset:0
  s_add_u32 s21, s21, 0x4000
  s_add_u32 m0, s20, 49152
  s_nop 0
  v_fma_f32 v224, v128, s28, -v232
  v_add_f32 v234, v234, v236
  v_add_f32 v235, v235, v237
  v_mfma_f32_32x32x16_bf16 v[16:31], a[164:167], v[208:211], v[16:31]
  ds_read_b128 a[132:135], v239 offset:0
  v_exp_f32 v224, v224
  v_fma_f32 v225, v129, s28, -v232
  v_fma_f32 v226, v130, s28, -v232
  v_fma_f32 v227, v131, s28, -v232
  v_mfma_f32_32x32x16_bf16 v[80:95], a[164:167], v[216:219], v[80:95]
  ds_read_b128 a[136:139], v240 offset:0
  v_exp_f32 v225, v225
  v_fma_f32 v228, v132, s28, -v232
  v_exp_f32 v226, v226
  v_mfma_f32_32x32x16_bf16 v[32:47], a[168:171], v[208:211], v[32:47]
  ds_read_b128 a[140:143], v241 offset:0
  v_exp_f32 v227, v227
  v_fma_f32 v229, v133, s28, -v232
  v_exp_f32 v228, v228
  v_mfma_f32_32x32x16_bf16 v[96:111], a[168:171], v[216:219], v[96:111]
  ds_read_b128 a[144:147], v242 offset:0
  v_exp_f32 v229, v229
  v_fma_f32 v230, v134, s28, -v232
  v_add_f32 v236, v224, v225
  v_fma_f32 v231, v135, s28, -v232
  v_mfma_f32_32x32x16_bf16 v[48:63], a[172:175], v[208:211], v[48:63]
  ds_read_b128 a[148:151], v243 offset:0
  v_exp_f32 v230, v230
  v_add_f32 v236, v236, v226
  v_exp_f32 v231, v231
  v_mfma_f32_32x32x16_bf16 v[112:127], a[172:175], v[216:219], v[112:127]
  ds_read_b128 a[152:155], v244 offset:0
  v_add_f32 v236, v236, v227
  v_cvt_pk_bf16_f32 v192, v224, v225
  v_fma_f32 v224, v136, s28, -v232
  v_add_f32 v236, v236, v228
  v_fma_f32 v225, v137, s28, -v232
  v_mfma_f32_32x32x16_bf16 v[0:15], a[176:179], v[212:215], v[0:15]
  ds_read_b128 a[156:159], v245 offset:0
  v_exp_f32 v224, v224
  v_add_f32 v236, v236, v229
  v_exp_f32 v225, v225
  v_mfma_f32_32x32x16_bf16 v[64:79], a[176:179], v[220:223], v[64:79]
  buffer_load_dwordx4 v250, s[8:11], s21 offen offset:0 nt lds
  v_add_f32 v236, v236, v230
  v_cvt_pk_bf16_f32 v193, v226, v227
  v_fma_f32 v226, v138, s28, -v232
  v_add_f32 v236, v236, v231
  v_fma_f32 v227, v139, s28, -v232
  v_mfma_f32_32x32x16_bf16 v[16:31], a[180:183], v[212:215], v[16:31]
  buffer_load_dwordx4 v251, s[8:11], s21 offen offset:1024 nt lds
  v_exp_f32 v226, v226
  v_add_f32 v236, v236, v224
  v_exp_f32 v227, v227
  v_mfma_f32_32x32x16_bf16 v[80:95], a[180:183], v[220:223], v[80:95]
  v_add_f32 v236, v236, v225
  v_cvt_pk_bf16_f32 v194, v228, v229
  v_fma_f32 v228, v140, s28, -v232
  v_add_f32 v236, v236, v226
  v_fma_f32 v229, v141, s28, -v232
  v_add_f32 v236, v236, v227
  v_mfma_f32_32x32x16_bf16 v[32:47], a[184:187], v[212:215], v[32:47]
  buffer_load_dwordx4 v252, s[8:11], s21 offen offset:2048 nt lds
  v_exp_f32 v228, v228
  v_cvt_pk_bf16_f32 v195, v230, v231
  v_exp_f32 v229, v229
  v_mfma_f32_32x32x16_bf16 v[96:111], a[184:187], v[220:223], v[96:111]
  buffer_load_dwordx4 v253, s[8:11], s21 offen offset:3072 nt lds
  v_fma_f32 v230, v142, s28, -v232
  v_add_f32 v236, v236, v228
  v_fma_f32 v231, v143, s28, -v232
  v_exp_f32 v230, v230
  v_mfma_f32_32x32x16_bf16 v[48:63], a[188:191], v[212:215], v[48:63]
  v_exp_f32 v231, v231
  v_add_f32 v236, v236, v229
  v_cvt_pk_bf16_f32 v196, v224, v225
  v_fma_f32 v224, v144, s28, -v233
  v_add_f32 v236, v236, v230
  v_mfma_f32_32x32x16_bf16 v[112:127], a[188:191], v[220:223], v[112:127]
  v_exp_f32 v224, v224
  v_fma_f32 v225, v145, s28, -v233
  v_add_f32 v236, v236, v231
  v_cvt_pk_bf16_f32 v197, v226, v227
  s_waitcnt lgkmcnt(0)
  v_mfma_f32_32x32x16_bf16 v[160:175], a[128:131], a[0:3], 0
  ds_read_b64_tr_b16 a[160:161], v246 offset:49152
  ds_read_b64_tr_b16 a[162:163], v246 offset:51200
  v_exp_f32 v225, v225
  v_fma_f32 v226, v146, s28, -v233
  v_cvt_pk_bf16_f32 v198, v228, v229
  v_mfma_f32_32x32x16_bf16 v[176:191], a[128:131], a[32:35], 0
  ds_read_b64_tr_b16 a[164:165], v247 offset:49152
  v_exp_f32 v226, v226
  v_fma_f32 v227, v147, s28, -v233
  v_add_f32 v237, v224, v225
  v_fma_f32 v228, v148, s28, -v233
  v_mfma_f32_32x32x16_bf16 v[160:175], a[132:135], a[4:7], v[160:175]
  ds_read_b64_tr_b16 a[166:167], v247 offset:51200
  v_exp_f32 v227, v227
  v_fma_f32 v229, v149, s28, -v233
  v_exp_f32 v228, v228
  v_mfma_f32_32x32x16_bf16 v[176:191], a[132:135], a[36:39], v[176:191]
  ds_read_b64_tr_b16 a[168:169], v248 offset:49152
  ds_read_b64_tr_b16 a[170:171], v248 offset:51200
  v_exp_f32 v229, v229
  v_add_f32 v237, v237, v226
  v_cvt_pk_bf16_f32 v199, v230, v231
  v_mfma_f32_32x32x16_bf16 v[160:175], a[136:139], a[8:11], v[160:175]
  ds_read_b64_tr_b16 a[172:173], v249 offset:49152
  v_fma_f32 v230, v150, s28, -v233
  v_add_f32 v237, v237, v227
  v_fma_f32 v231, v151, s28, -v233
  v_exp_f32 v230, v230
  v_mfma_f32_32x32x16_bf16 v[176:191], a[136:139], a[40:43], v[176:191]
  ds_read_b64_tr_b16 a[174:175], v249 offset:51200
  v_exp_f32 v231, v231
  v_add_f32 v237, v237, v228
  v_cvt_pk_bf16_f32 v200, v224, v225
  v_fma_f32 v224, v152, s28, -v233
  v_mfma_f32_32x32x16_bf16 v[160:175], a[140:143], a[12:15], v[160:175]
  ds_read_b64_tr_b16 a[176:177], v246 offset:53248
  ds_read_b64_tr_b16 a[178:179], v246 offset:55296
  v_exp_f32 v224, v224
  v_fma_f32 v225, v153, s28, -v233
  v_add_f32 v237, v237, v229
  v_mfma_f32_32x32x16_bf16 v[176:191], a[140:143], a[44:47], v[176:191]
  ds_read_b64_tr_b16 a[180:181], v247 offset:53248
  v_exp_f32 v225, v225
  v_add_f32 v237, v237, v230
  v_cvt_pk_bf16_f32 v201, v226, v227
  v_fma_f32 v226, v154, s28, -v233
  v_mfma_f32_32x32x16_bf16 v[160:175], a[144:147], a[16:19], v[160:175]
  ds_read_b64_tr_b16 a[182:183], v247 offset:55296
  v_exp_f32 v226, v226
  v_fma_f32 v227, v155, s28, -v233
  v_add_f32 v237, v237, v231
  v_cvt_pk_bf16_f32 v202, v228, v229
  v_mfma_f32_32x32x16_bf16 v[176:191], a[144:147], a[48:51], v[176:191]
  ds_read_b64_tr_b16 a[184:185], v248 offset:53248
  ds_read_b64_tr_b16 a[186:187], v248 offset:55296
  v_exp_f32 v227, v227
  v_fma_f32 v228, v156, s28, -v233
  v_add_f32 v237, v237, v224
  v_mfma_f32_32x32x16_bf16 v[160:175], a[148:151], a[20:23], v[160:175]
  ds_read_b64_tr_b16 a[188:189], v249 offset:53248
  v_exp_f32 v228, v228
  v_fma_f32 v229, v157, s28, -v233
  v_add_f32 v237, v237, v225
  v_cvt_pk_bf16_f32 v203, v230, v231
  v_mfma_f32_32x32x16_bf16 v[176:191], a[148:151], a[52:55], v[176:191]
  ds_read_b64_tr_b16 a[190:191], v249 offset:55296
  v_exp_f32 v229, v229
  v_fma_f32 v230, v158, s28, -v233
  v_add_f32 v237, v237, v226
  v_fma_f32 v231, v159, s28, -v233
  v_mfma_f32_32x32x16_bf16 v[160:175], a[152:155], a[24:27], v[160:175]
  buffer_store_dwordx4 a[200:203], v255, s[16:19], s81 offen offset:0 nt
  buffer_store_dwordx4 a[216:219], v255, s[16:19], s81 offen offset:128 nt
  v_exp_f32 v230, v230
  v_add_f32 v237, v237, v227
  v_cvt_pk_bf16_f32 v204, v224, v225
  v_mfma_f32_32x32x16_bf16 v[176:191], a[152:155], a[56:59], v[176:191]
  v_exp_f32 v231, v231
  v_add_f32 v237, v237, v228
  v_cvt_pk_bf16_f32 v205, v226, v227
  v_add_f32 v237, v237, v229
  v_cvt_pk_bf16_f32 v206, v228, v229
  v_mfma_f32_32x32x16_bf16 v[160:175], a[156:159], a[28:31], v[160:175]
  v_add_f32 v237, v237, v230
  v_cvt_pk_bf16_f32 v207, v230, v231
  v_add_f32 v237, v237, v231
  s_nop 0
  v_max_f32 v224, v236, v237
  v_cmp_lt_f32 vcc, s29, v224
  v_mfma_f32_32x32x16_bf16 v[176:191], a[156:159], a[60:63], v[176:191]
  s_cbranch_vccnz RARE_6
RET_6:
  s_waitcnt lgkmcnt(0)
  v_mfma_f32_32x32x16_bf16 v[0:15], a[160:163], v[192:195], v[0:15]
  s_add_u32 s22, s22, 0x4000
  s_add_u32 m0, s20, 98304
  v_add_f32 v234, v234, v236
  v_add_f32 v235, v235, v237
  v_mfma_f32_32x32x16_bf16 v[64:79], a[160:163], v[200:203], v[64:79]
  ds_read_b128 a[128:131], v238 offset:8192
  v_fma_f32 v224, v160, s28, -v232
  v_fma_f32 v225, v161, s28, -v232
  v_fma_f32 v226, v162, s28, -v232
  v_exp_f32 v224, v224
  v_mfma_f32_32x32x16_bf16 v[16:31], a[164:167], v[192:195], v[16:31]
  ds_read_b128 a[132:135], v239 offset:8192
  v_exp_f32 v225, v225
  v_fma_f32 v227, v163, s28, -v232
  v_exp_f32 v226, v226
  v_mfma_f32_32x32x16_bf16 v[80:95], a[164:167], v[200:203], v[80:95]
  ds_read_b128 a[136:139], v240 offset:8192
  v_exp_f32 v227, v227
  v_fma_f32 v228, v164, s28, -v232
  v_add_f32 v236, v224, v225
  v_fma_f32 v229, v165, s28, -v232
  v_mfma_f32_32x32x16_bf16 v[32:47], a[168:171], v[192:195], v[32:47]
  ds_read_b128 a[140:143], v241 offset:8192
  v_exp_f32 v228, v228
  v_fma_f32 v230, v166, s28, -v232
  v_exp_f32 v229, v229
  v_mfma_f32_32x32x16_bf16 v[96:111], a[168:171], v[200:203], v[96:111]
  ds_read_b128 a[144:147], v242 offset:8192
  v_exp_f32 v230, v230
  v_fma_f32 v231, v167, s28, -v232
  v_add_f32 v236, v236, v226
  v_cvt_pk_bf16_f32 v208, v224, v225
  v_mfma_f32_32x32x16_bf16 v[48:63], a[172:175], v[192:195], v[48:63]
  ds_read_b128 a[148:151], v243 offset:8192
  v_exp_f32 v231, v231
  v_fma_f32 v224, v168, s28, -v232
  v_add_f32 v236, v236, v227
  v_fma_f32 v225, v169, s28, -v232
  v_mfma_f32_32x32x16_bf16 v[112:127], a[172:175], v[200:203], v[112:127]
  ds_read_b128 a[152:155], v244 offset:8192
  v_exp_f32 v224, v224
  v_add_f32 v236, v236, v228
  v_exp_f32 v225, v225
  v_mfma_f32_32x32x16_bf16 v[0:15], a[176:179], v[196:199], v[0:15]
  ds_read_b128 a[156:159], v245 offset:8192
  v_add_f32 v236, v236, v229
  v_cvt_pk_bf16_f32 v209, v226, v227
  v_fma_f32 v226, v170, s28, -v232
  v_add_f32 v236, v236, v230
  v_fma_f32 v227, v171, s28, -v232
  v_mfma_f32_32x32x16_bf16 v[64:79], a[176:179], v[204:207], v[64:79]
  buffer_load_dwordx4 v254, s[12:15], s22 offen offset:0 nt lds
  v_exp_f32 v226, v226
  v_add_f32 v236, v236, v231
  v_exp_f32 v227, v227
  v_mfma_f32_32x32x16_bf16 v[16:31], a[180:183], v[196:199], v[16:31]
  buffer_load_dwordx4 v254, s[12:15], s22 offen offset:1024 nt lds
  v_add_f32 v236, v236, v224
  v_cvt_pk_bf16_f32 v210, v228, v229
  v_fma_f32 v228, v172, s28, -v232
  v_add_f32 v236, v236, v225
  v_fma_f32 v229, v173, s28, -v232
  v_mfma_f32_32x32x16_bf16 v[80:95], a[180:183], v[204:207], v[80:95]
  v_exp_f32 v228, v228
  v_add_f32 v236, v236, v226
  v_exp_f32 v229, v229
  v_add_f32 v236, v236, v227
  v_mfma_f32_32x32x16_bf16 v[32:47], a[184:187], v[196:199], v[32:47]
  buffer_load_dwordx4 v254, s[12:15], s22 offen offset:2048 nt lds
  v_add_f32 v236, v236, v228
  v_cvt_pk_bf16_f32 v211, v230, v231
  v_fma_f32 v230, v174, s28, -v232
  v_add_f32 v236, v236, v229
  v_fma_f32 v231, v175, s28, -v232
  v_mfma_f32_32x32x16_bf16 v[96:111], a[184:187], v[204:207], v[96:111]
  buffer_load_dwordx4 v254, s[12:15], s22 offen offset:3072 nt lds
  v_exp_f32 v230, v230
  v_cvt_pk_bf16_f32 v212, v224, v225
  v_exp_f32 v231, v231
  v_mfma_f32_32x32x16_bf16 v[48:63], a[188:191], v[196:199], v[48:63]
  v_fma_f32 v224, v176, s28, -v233
  v_add_f32 v236, v236, v230
  v_fma_f32 v225, v177, s28, -v233
  v_exp_f32 v224, v224
  v_add_f32 v236, v236, v231
  v_mfma_f32_32x32x16_bf16 v[112:127], a[188:191], v[204:207], v[112:127]
  v_exp_f32 v225, v225
  v_cvt_pk_bf16_f32 v213, v226, v227
  v_fma_f32 v226, v178, s28, -v233
  v_add_f32 v237, v224, v225
  s_waitcnt lgkmcnt(0)
  v_mfma_f32_32x32x16_bf16 v[128:143], a[128:131], a[0:3], 0
  ds_read_b64_tr_b16 a[160:161], v246 offset:57344
  ds_read_b64_tr_b16 a[162:163], v246 offset:59392
  v_exp_f32 v226, v226
  v_fma_f32 v227, v179, s28, -v233
  v_cvt_pk_bf16_f32 v214, v228, v229
  v_mfma_f32_32x32x16_bf16 v[144:159], a[128:131], a[32:35], 0
  ds_read_b64_tr_b16 a[164:165], v247 offset:57344
  v_exp_f32 v227, v227
  v_fma_f32 v228, v180, s28, -v233
  v_add_f32 v237, v237, v226
  v_fma_f32 v229, v181, s28, -v233
  v_mfma_f32_32x32x16_bf16 v[128:143], a[132:135], a[4:7], v[128:143]
  ds_read_b64_tr_b16 a[166:167], v247 offset:59392
  v_exp_f32 v228, v228
  v_add_f32 v237, v237, v227
  v_exp_f32 v229, v229
  v_mfma_f32_32x32x16_bf16 v[144:159], a[132:135], a[36:39], v[144:159]
  ds_read_b64_tr_b16 a[168:169], v248 offset:57344
  ds_read_b64_tr_b16 a[170:171], v248 offset:59392
  v_add_f32 v237, v237, v228
  v_cvt_pk_bf16_f32 v215, v230, v231
  v_fma_f32 v230, v182, s28, -v233
  v_add_f32 v237, v237, v229
  v_mfma_f32_32x32x16_bf16 v[128:143], a[136:139], a[8:11], v[128:143]
  ds_read_b64_tr_b16 a[172:173], v249 offset:57344
  v_exp_f32 v230, v230
  v_fma_f32 v231, v183, s28, -v233
  v_cvt_pk_bf16_f32 v216, v224, v225
  v_fma_f32 v224, v184, s28, -v233
  v_mfma_f32_32x32x16_bf16 v[144:159], a[136:139], a[40:43], v[144:159]
  ds_read_b64_tr_b16 a[174:175], v249 offset:59392
  v_exp_f32 v231, v231
  v_fma_f32 v225, v185, s28, -v233
  v_exp_f32 v224, v224
  v_mfma_f32_32x32x16_bf16 v[128:143], a[140:143], a[12:15], v[128:143]
  ds_read_b64_tr_b16 a[176:177], v246 offset:61440
  ds_read_b64_tr_b16 a[178:179], v246 offset:63488
  v_exp_f32 v225, v225
  v_add_f32 v237, v237, v230
  v_cvt_pk_bf16_f32 v217, v226, v227
  v_mfma_f32_32x32x16_bf16 v[144:159], a[140:143], a[44:47], v[144:159]
  ds_read_b64_tr_b16 a[180:181], v247 offset:61440
  v_fma_f32 v226, v186, s28, -v233
  v_add_f32 v237, v237, v231
  v_fma_f32 v227, v187, s28, -v233
  v_exp_f32 v226, v226
  v_mfma_f32_32x32x16_bf16 v[128:143], a[144:147], a[16:19], v[128:143]
  ds_read_b64_tr_b16 a[182:183], v247 offset:63488
  v_exp_f32 v227, v227
  v_add_f32 v237, v237, v224
  v_cvt_pk_bf16_f32 v218, v228, v229
  v_fma_f32 v228, v188, s28, -v233
  v_mfma_f32_32x32x16_bf16 v[144:159], a[144:147], a[48:51], v[144:159]
  ds_read_b64_tr_b16 a[184:185], v248 offset:61440
  ds_read_b64_tr_b16 a[186:187], v248 offset:63488
  v_exp_f32 v228, v228
  v_fma_f32 v229, v189, s28, -v233
  v_add_f32 v237, v237, v225
  v_mfma_f32_32x32x16_bf16 v[128:143], a[148:151], a[20:23], v[128:143]
  ds_read_b64_tr_b16 a[188:189], v249 offset:61440
  v_exp_f32 v229, v229
  v_add_f32 v237, v237, v226
  v_cvt_pk_bf16_f32 v219, v230, v231
  v_fma_f32 v230, v190, s28, -v233
  v_mfma_f32_32x32x16_bf16 v[144:159], a[148:151], a[52:55], v[144:159]
  ds_read_b64_tr_b16 a[190:191], v249 offset:63488
  v_exp_f32 v230, v230
  v_fma_f32 v231, v191, s28, -v233
  v_add_f32 v237, v237, v227
  v_cvt_pk_bf16_f32 v220, v224, v225
  v_mfma_f32_32x32x16_bf16 v[128:143], a[152:155], a[24:27], v[128:143]
  buffer_store_dwordx4 a[204:207], v255, s[16:19], s81 offen offset:2048 nt
  buffer_store_dwordx4 a[220:223], v255, s[16:19], s81 offen offset:2176 nt
  v_exp_f32 v231, v231
  v_add_f32 v237, v237, v228
  v_cvt_pk_bf16_f32 v221, v226, v227
  v_mfma_f32_32x32x16_bf16 v[144:159], a[152:155], a[56:59], v[144:159]
  v_add_f32 v237, v237, v229
  v_cvt_pk_bf16_f32 v222, v228, v229
  v_add_f32 v237, v237, v230
  v_cvt_pk_bf16_f32 v223, v230, v231
  v_add_f32 v237, v237, v231
  v_mfma_f32_32x32x16_bf16 v[128:143], a[156:159], a[28:31], v[128:143]
  v_max_f32 v224, v236, v237
  v_cmp_lt_f32 vcc, s29, v224
  v_mfma_f32_32x32x16_bf16 v[144:159], a[156:159], a[60:63], v[144:159]
  s_cbranch_vccnz RARE_7
RET_7:
  s_waitcnt vmcnt(20) lgkmcnt(0)
  v_mfma_f32_32x32x16_bf16 v[0:15], a[160:163], v[208:211], v[0:15]
  s_barrier
  v_mfma_f32_32x32x16_bf16 v[64:79], a[160:163], v[216:219], v[64:79]
  ds_read_b128 a[128:131], v238 offset:16384
  s_add_u32 s21, s21, s25
  s_add_u32 m0, s20, 0
  s_nop 0
  v_fma_f32 v224, v128, s28, -v232
  v_add_f32 v234, v234, v236
  v_add_f32 v235, v235, v237
  v_mfma_f32_32x32x16_bf16 v[16:31], a[164:167], v[208:211], v[16:31]
  ds_read_b128 a[132:135], v239 offset:16384
  buffer_load_dwordx4 v250, s[8:11], s21 offen offset:0 nt lds
  v_exp_f32 v224, v224
  v_fma_f32 v225, v129, s28, -v232
  v_fma_f32 v226, v130, s28, -v232
  v_mfma_f32_32x32x16_bf16 v[80:95], a[164:167], v[216:219], v[80:95]
  ds_read_b128 a[136:139], v240 offset:16384
  buffer_load_dwordx4 v251, s[8:11], s21 offen offset:1024 nt lds
  v_exp_f32 v225, v225
  v_fma_f32 v227, v131, s28, -v232
  v_fma_f32 v228, v132, s28, -v232
  v_mfma_f32_32x32x16_bf16 v[32:47], a[168:171], v[208:211], v[32:47]
  ds_read_b128 a[140:143], v241 offset:16384
  v_exp_f32 v226, v226
  v_fma_f32 v229, v133, s28, -v232
  v_exp_f32 v227, v227
  v_mfma_f32_32x32x16_bf16 v[96:111], a[168:171], v[216:219], v[96:111]
  ds_read_b128 a[144:147], v242 offset:16384
  buffer_load_dwordx4 v252, s[8:11], s21 offen offset:2048 nt lds
  v_exp_f32 v228, v228
  v_fma_f32 v230, v134, s28, -v232
  v_add_f32 v236, v224, v225
  v_mfma_f32_32x32x16_bf16 v[48:63], a[172:175], v[208:211], v[48:63]
  ds_read_b128 a[148:151], v243 offset:16384
  v_exp_f32 v229, v229
  v_fma_f32 v231, v135, s28, -v232
  v_exp_f32 v230, v230
  v_mfma_f32_32x32x16_bf16 v[112:127], a[172:175], v[216:219], v[112:127]
  ds_read_b128 a[152:155], v244 offset:16384
  buffer_load_dwordx4 v253, s[8:11], s21 offen offset:3072 nt lds
  v_exp_f32 v231, v231
  v_add_f32 v236, v236, v226
  v_cvt_pk_bf16_f32 v192, v224, v225
  v_mfma_f32_32x32x16_bf16 v[0:15], a[176:179], v[212:215], v[0:15]
  ds_read_b128 a[156:159], v245 offset:16384
  v_fma_f32 v224, v136, s28, -v232
  v_add_f32 v236, v236, v227
  v_fma_f32 v225, v137, s28, -v232
  v_exp_f32 v224, v224
  v_mfma_f32_32x32x16_bf16 v[64:79], a[176:179], v[220:223], v[64:79]
  v_add_u32 v160, s30, v238
  ds_read_b128 a[64:67], v160 offset:0
  v_add_u32 v161, s30, v239
  ds_read_b128 a[68:71], v161 offset:0
  v_exp_f32 v225, v225
  v_mfma_f32_32x32x16_bf16 v[16:31], a[180:183], v[212:215], v[16:31]
  v_add_u32 v162, s30, v240
  ds_read_b128 a[72:75], v162 offset:0
  v_add_f32 v236, v236, v228
  v_cvt_pk_bf16_f32 v193, v226, v227
  v_fma_f32 v226, v138, s28, -v232
  v_add_f32 v236, v236, v229
  v_mfma_f32_32x32x16_bf16 v[80:95], a[180:183], v[220:223], v[80:95]
  v_add_u32 v163, s30, v241
  ds_read_b128 a[76:79], v163 offset:0
  v_exp_f32 v226, v226
  v_fma_f32 v227, v139, s28, -v232
  v_add_f32 v236, v236, v230
  v_mfma_f32_32x32x16_bf16 v[32:47], a[184:187], v[212:215], v[32:47]
  v_add_u32 v164, s30, v242
  ds_read_b128 a[80:83], v164 offset:0
  v_add_u32 v165, s30, v243
  ds_read_b128 a[84:87], v165 offset:0
  v_exp_f32 v227, v227
  v_mfma_f32_32x32x16_bf16 v[96:111], a[184:187], v[220:223], v[96:111]
  v_add_u32 v166, s30, v244
  ds_read_b128 a[88:91], v166 offset:0
  v_add_f32 v236, v236, v231
  v_cvt_pk_bf16_f32 v194, v228, v229
  v_fma_f32 v228, v140, s28, -v232
  v_add_f32 v236, v236, v224
  v_mfma_f32_32x32x16_bf16 v[48:63], a[188:191], v[212:215], v[48:63]
  v_add_u32 v167, s30, v245
  ds_read_b128 a[92:95], v167 offset:0
  v_exp_f32 v228, v228
  v_fma_f32 v229, v141, s28, -v232
  v_add_f32 v236, v236, v225
  v_mfma_f32_32x32x16_bf16 v[112:127], a[188:191], v[220:223], v[112:127]
  v_exp_f32 v229, v229
  v_add_f32 v236, v236, v226
  v_cvt_pk_bf16_f32 v195, v230, v231
  v_fma_f32 v230, v142, s28, -v232
  s_waitcnt lgkmcnt(8)
  v_mfma_f32_32x32x16_bf16 v[160:175], a[128:131], a[0:3], 0
  ds_read_b64_tr_b16 a[160:161], v246 offset:0
  ds_read_b64_tr_b16 a[162:163], v246 offset:2048
  v_exp_f32 v230, v230
  v_fma_f32 v231, v143, s28, -v232
  v_add_f32 v236, v236, v227
  v_mfma_f32_32x32x16_bf16 v[176:191], a[128:131], a[32:35], 0
  ds_read_b64_tr_b16 a[164:165], v247 offset:0
  v_exp_f32 v231, v231
  v_add_f32 v236, v236, v228
  v_cvt_pk_bf16_f32 v196, v224, v225
  v_fma_f32 v224, v144, s28, -v233
  v_mfma_f32_32x32x16_bf16 v[160:175], a[132:135], a[4:7], v[160:175]
  ds_read_b64_tr_b16 a[166:167], v247 offset:2048
  v_exp_f32 v224, v224
  v_fma_f32 v225, v145, s28, -v233
  v_add_f32 v236, v236, v229
  v_cvt_pk_bf16_f32 v197, v226, v227
  v_mfma_f32_32x32x16_bf16 v[176:191], a[132:135], a[36:39], v[176:191]
  ds_read_b64_tr_b16 a[168:169], v248 offset:0
  ds_read_b64_tr_b16 a[170:171], v248 offset:2048
  v_exp_f32 v225, v225
  v_fma_f32 v226, v146, s28, -v233
  v_add_f32 v236, v236, v230
  v_mfma_f32_32x32x16_bf16 v[160:175], a[136:139], a[8:11], v[160:175]
  ds_read_b64_tr_b16 a[172:173], v249 offset:0
  v_exp_f32 v226, v226
  v_fma_f32 v227, v147, s28, -v233
  v_add_f32 v236, v236, v231
  v_cvt_pk_bf16_f32 v198, v228, v229
  v_mfma_f32_32x32x16_bf16 v[176:191], a[136:139], a[40:43], v[176:191]
  ds_read_b64_tr_b16 a[174:175], v249 offset:2048
  v_exp_f32 v227, v227
  v_fma_f32 v228, v148, s28, -v233
  v_add_f32 v237, v224, v225
  v_fma_f32 v229, v149, s28, -v233
  v_mfma_f32_32x32x16_bf16 v[160:175], a[140:143], a[12:15], v[160:175]
  ds_read_b64_tr_b16 a[176:177], v246 offset:4096
  ds_read_b64_tr_b16 a[178:179], v246 offset:6144
  v_exp_f32 v228, v228
  v_add_f32 v237, v237, v226
  v_cvt_pk_bf16_f32 v199, v230, v231
  v_mfma_f32_32x32x16_bf16 v[176:191], a[140:143], a[44:47], v[176:191]
  ds_read_b64_tr_b16 a[180:181], v247 offset:4096
  v_exp_f32 v229, v229
  v_fma_f32 v230, v150, s28, -v233
  v_add_f32 v237, v237, v227
  v_fma_f32 v231, v151, s28, -v233
  v_mfma_f32_32x32x16_bf16 v[160:175], a[144:147], a[16:19], v[160:175]
  ds_read_b64_tr_b16 a[182:183], v247 offset:6144
  v_exp_f32 v230, v230
  v_add_f32 v237, v237, v228
  v_exp_f32 v231, v231
  v_mfma_f32_32x32x16_bf16 v[176:191], a[144:147], a[48:51], v[176:191]
  ds_read_b64_tr_b16 a[184:185], v248 offset:4096
  ds_read_b64_tr_b16 a[186:187], v248 offset:6144
  v_add_f32 v237, v237, v229
  v_cvt_pk_bf16_f32 v200, v224, v225
  v_fma_f32 v224, v152, s28, -v233
  v_add_f32 v237, v237, v230
  v_mfma_f32_32x32x16_bf16 v[160:175], a[148:151], a[20:23], v[160:175]
  ds_read_b64_tr_b16 a[188:189], v249 offset:4096
  v_exp_f32 v224, v224
  v_fma_f32 v225, v153, s28, -v233
  v_add_f32 v237, v237, v231
  v_cvt_pk_bf16_f32 v201, v226, v227
  v_mfma_f32_32x32x16_bf16 v[176:191], a[148:151], a[52:55], v[176:191]
  ds_read_b64_tr_b16 a[190:191], v249 offset:6144
  v_exp_f32 v225, v225
  v_fma_f32 v226, v154, s28, -v233
  v_add_f32 v237, v237, v224
  v_fma_f32 v227, v155, s28, -v233
  v_mfma_f32_32x32x16_bf16 v[160:175], a[152:155], a[24:27], v[160:175]
  v_exp_f32 v226, v226
  v_add_f32 v237, v237, v225
  v_exp_f32 v227, v227
  v_add_f32 v237, v237, v226
  v_mfma_f32_32x32x16_bf16 v[176:191], a[152:155], a[56:59], v[176:191]
  v_add_f32 v237, v237, v227
  v_cvt_pk_bf16_f32 v202, v228, v229
  v_fma_f32 v228, v156, s28, -v233
  v_cvt_pk_bf16_f32 v203, v230, v231
  v_fma_f32 v229, v157, s28, -v233
  v_cvt_pk_bf16_f32 v204, v224, v225
  v_mfma_f32_32x32x16_bf16 v[160:175], a[156:159], a[28:31], v[160:175]
  v_exp_f32 v228, v228
  v_fma_f32 v230, v158, s28, -v233
  v_exp_f32 v229, v229
  v_fma_f32 v231, v159, s28, -v233
  v_exp_f32 v230, v230
  v_add_f32 v237, v237, v228
  v_exp_f32 v231, v231
  v_add_f32 v237, v237, v229
  s_nop 0
  v_add_f32 v237, v237, v230
  s_nop 0
  v_add_f32 v237, v237, v231
  s_nop 0
  v_max_f32 v224, v236, v237
  v_cmp_lt_f32 vcc, s29, v224
  v_mfma_f32_32x32x16_bf16 v[176:191], a[156:159], a[60:63], v[176:191]
  v_cvt_pk_bf16_f32 v205, v226, v227
  v_cvt_pk_bf16_f32 v206, v228, v229
  v_cvt_pk_bf16_f32 v207, v230, v231
  s_cbranch_vccnz RARE_8
RET_8:
  s_waitcnt lgkmcnt(0)
  v_mfma_f32_32x32x16_bf16 v[0:15], a[160:163], v[192:195], v[0:15]
  s_add_u32 s22, s22, 0x4000
  s_add_u32 m0, s20, 114688
  v_add_f32 v234, v234, v236
  v_add_f32 v235, v235, v237
  v_mfma_f32_32x32x16_bf16 v[64:79], a[160:163], v[200:203], v[64:79]
  ds_read_b128 a[128:131], v238 offset:24576
  v_fma_f32 v224, v160, s28, -v232
  v_fma_f32 v225, v161, s28, -v232
  v_fma_f32 v226, v162, s28, -v232
  v_exp_f32 v224, v224
  v_mfma_f32_32x32x16_bf16 v[16:31], a[164:167], v[192:195], v[16:31]
  ds_read_b128 a[132:135], v239 offset:24576
  buffer_load_dwordx4 v254, s[12:15], s22 offen offset:0 nt lds
  v_exp_f32 v225, v225
  v_fma_f32 v227, v163, s28, -v232
  v_fma_f32 v228, v164, s28, -v232
  v_mfma_f32_32x32x16_bf16 v[80:95], a[164:167], v[200:203], v[80:95]
  ds_read_b128 a[136:139], v240 offset:24576
  buffer_load_dwordx4 v254, s[12:15], s22 offen offset:1024 nt lds
  v_exp_f32 v226, v226
  v_fma_f32 v229, v165, s28, -v232
  v_add_f32 v236, v224, v225
  v_mfma_f32_32x32x16_bf16 v[32:47], a[168:171], v[192:195], v[32:47]
  ds_read_b128 a[140:143], v241 offset:24576
  v_exp_f32 v227, v227
  v_fma_f32 v230, v166, s28, -v232
  v_exp_f32 v228, v228
  v_mfma_f32_32x32x16_bf16 v[96:111], a[168:171], v[200:203], v[96:111]
  ds_read_b128 a[144:147], v242 offset:24576
  buffer_load_dwordx4 v254, s[12:15], s22 offen offset:2048 nt lds
  v_exp_f32 v229, v229
  v_fma_f32 v231, v167, s28, -v232
  v_add_f32 v236, v236, v226
  v_mfma_f32_32x32x16_bf16 v[48:63], a[172:175], v[192:195], v[48:63]
  ds_read_b128 a[148:151], v243 offset:24576
  v_exp_f32 v230, v230
  v_add_f32 v236, v236, v227
  v_exp_f32 v231, v231
  v_mfma_f32_32x32x16_bf16 v[112:127], a[172:175], v[200:203], v[112:127]
  ds_read_b128 a[152:155], v244 offset:24576
  buffer_load_dwordx4 v254, s[12:15], s22 offen offset:3072 nt lds
  v_add_f32 v236, v236, v228
  v_cvt_pk_bf16_f32 v208, v224, v225
  v_fma_f32 v224, v168, s28, -v232
  v_add_f32 v236, v236, v229
  v_mfma_f32_32x32x16_bf16 v[0:15], a[176:179], v[196:199], v[0:15]
  ds_read_b128 a[156:159], v245 offset:24576
  v_exp_f32 v224, v224
  v_fma_f32 v225, v169, s28, -v232
  v_add_f32 v236, v236, v230
  v_cvt_pk_bf16_f32 v209, v226, v227
  v_mfma_f32_32x32x16_bf16 v[64:79], a[176:179], v[204:207], v[64:79]
  s_add_u32 s31, s23, 8192
  s_add_u32 m0, s30, 0
  v_exp_f32 v225, v225
  v_fma_f32 v226, v170, s28, -v232
  v_add_f32 v236, v236, v231
  v_mfma_f32_32x32x16_bf16 v[16:31], a[180:183], v[196:199], v[16:31]
  buffer_load_dwordx4 v250, s[4:7], s31 offen offset:0 nt lds
  v_exp_f32 v226, v226
  v_fma_f32 v227, v171, s28, -v232
  v_add_f32 v236, v236, v224
  v_cvt_pk_bf16_f32 v210, v228, v229
  v_mfma_f32_32x32x16_bf16 v[80:95], a[180:183], v[204:207], v[80:95]
  buffer_load_dwordx4 v251, s[4:7], s31 offen offset:1024 nt lds
  v_exp_f32 v227, v227
  v_fma_f32 v228, v172, s28, -v232
  v_add_f32 v236, v236, v225
  v_fma_f32 v229, v173, s28, -v232
  v_mfma_f32_32x32x16_bf16 v[32:47], a[184:187], v[196:199], v[32:47]
  buffer_load_dwordx4 v252, s[4:7], s31 offen offset:2048 nt lds
  v_exp_f32 v228, v228
  v_add_f32 v236, v236, v226
  v_exp_f32 v229, v229
  v_mfma_f32_32x32x16_bf16 v[96:111], a[184:187], v[204:207], v[96:111]
  buffer_load_dwordx4 v253, s[4:7], s31 offen offset:3072 nt lds
  v_add_f32 v236, v236, v227
  v_cvt_pk_bf16_f32 v211, v230, v231
  v_fma_f32 v230, v174, s28, -v232
  v_add_f32 v236, v236, v228
  v_fma_f32 v231, v175, s28, -v232
  v_mfma_f32_32x32x16_bf16 v[48:63], a[188:191], v[196:199], v[48:63]
  v_exp_f32 v230, v230
  v_add_f32 v236, v236, v229
  v_exp_f32 v231, v231
  v_add_f32 v236, v236, v230
  v_mfma_f32_32x32x16_bf16 v[112:127], a[188:191], v[204:207], v[112:127]
  v_add_f32 v236, v236, v231
  v_cvt_pk_bf16_f32 v212, v224, v225
  v_fma_f32 v224, v176, s28, -v233
  v_cvt_pk_bf16_f32 v213, v226, v227
  v_fma_f32 v225, v177, s28, -v233
  s_waitcnt lgkmcnt(0)
  v_mfma_f32_32x32x16_bf16 v[128:143], a[128:131], a[0:3], 0
  ds_read_b64_tr_b16 a[160:161], v246 offset:8192
  ds_read_b64_tr_b16 a[162:163], v246 offset:10240
  v_exp_f32 v224, v224
  v_fma_f32 v226, v178, s28, -v233
  v_cvt_pk_bf16_f32 v214, v228, v229
  v_mfma_f32_32x32x16_bf16 v[144:159], a[128:131], a[32:35], 0
  ds_read_b64_tr_b16 a[164:165], v247 offset:8192
  v_exp_f32 v225, v225
  v_fma_f32 v227, v179, s28, -v233
  v_exp_f32 v226, v226
  v_mfma_f32_32x32x16_bf16 v[128:143], a[132:135], a[4:7], v[128:143]
  ds_read_b64_tr_b16 a[166:167], v247 offset:10240
  v_exp_f32 v227, v227
  v_fma_f32 v228, v180, s28, -v233
  v_add_f32 v237, v224, v225
  v_fma_f32 v229, v181, s28, -v233
  v_mfma_f32_32x32x16_bf16 v[144:159], a[132:135], a[36:39], v[144:159]
  ds_read_b64_tr_b16 a[168:169], v248 offset:8192
  ds_read_b64_tr_b16 a[170:171], v248 offset:10240
  v_exp_f32 v228, v228
  v_add_f32 v237, v237, v226
  v_cvt_pk_bf16_f32 v215, v230, v231
  v_mfma_f32_32x32x16_bf16 v[128:143], a[136:139], a[8:11], v[128:143]
  ds_read_b64_tr_b16 a[172:173], v249 offset:8192
  v_exp_f32 v229, v229
  v_fma_f32 v230, v182, s28, -v233
  v_add_f32 v237, v237, v227
  v_fma_f32 v231, v183, s28, -v233
  v_mfma_f32_32x32x16_bf16 v[144:159], a[136:139], a[40:43], v[144:159]
  ds_read_b64_tr_b16 a[174:175], v249 offset:10240
  v_exp_f32 v230, v230
  v_add_f32 v237, v237, v228
  v_exp_f32 v231, v231
  v_mfma_f32_32x32x16_bf16 v[128:143], a[140:143], a[12:15], v[128:143]
  ds_read_b64_tr_b16 a[176:177], v246 offset:12288
  ds_read_b64_tr_b16 a[178:179], v246 offset:14336
  v_add_f32 v237, v237, v229
  v_cvt_pk_bf16_f32 v216, v224, v225
  v_fma_f32 v224, v184, s28, -v233
  v_add_f32 v237, v237, v230
  v_mfma_f32_32x32x16_bf16 v[144:159], a[140:143], a[44:47], v[144:159]
  ds_read_b64_tr_b16 a[180:181], v247 offset:12288
  v_exp_f32 v224, v224
  v_fma_f32 v225, v185, s28, -v233
  v_add_f32 v237, v237, v231
  v_cvt_pk_bf16_f32 v217, v226, v227
  v_mfma_f32_32x32x16_bf16 v[128:143], a[144:147], a[16:19], v[128:143]
  ds_read_b64_tr_b16 a[182:183], v247 offset:14336
  s_add_u32 s31, s23, 12288
  s_add_u32 m0, s30, 4096
  v_exp_f32 v225, v225
  v_fma_f32 v226, v186, s28, -v233
  v_mfma_f32_32x32x16_bf16 v[144:159], a[144:147], a[48:51], v[144:159]
  ds_read_b64_tr_b16 a[184:185], v248 offset:12288
  ds_read_b64_tr_b16 a[186:187], v248 offset:14336
  buffer_load_dwordx4 v250, s[4:7], s31 offen offset:0 nt lds
  v_exp_f32 v226, v226
  v_fma_f32 v227, v187, s28, -v233
  v_mfma_f32_32x32x16_bf16 v[128:143], a[148:151], a[20:23], v[128:143]
  ds_read_b64_tr_b16 a[188:189], v249 offset:12288
  buffer_load_dwordx4 v251, s[4:7], s31 offen offset:1024 nt lds
  v_exp_f32 v227, v227
  v_add_f32 v237, v237, v224
  v_cvt_pk_bf16_f32 v218, v228, v229
  v_mfma_f32_32x32x16_bf16 v[144:159], a[148:151], a[52:55], v[144:159]
  ds_read_b64_tr_b16 a[190:191], v249 offset:14336
  buffer_load_dwordx4 v252, s[4:7], s31 offen offset:2048 nt lds
  v_fma_f32 v228, v188, s28, -v233
  v_add_f32 v237, v237, v225
  v_fma_f32 v229, v189, s28, -v233
  v_add_f32 v237, v237, v226
  v_mfma_f32_32x32x16_bf16 v[128:143], a[152:155], a[24:27], v[128:143]
  buffer_load_dwordx4 v253, s[4:7], s31 offen offset:3072 nt lds
  buffer_store_dwordx4 a[224:227], v255, s[16:19], s82 offen offset:0 nt
  buffer_store_dwordx4 a[240:243], v255, s[16:19], s82 offen offset:128 nt
  v_exp_f32 v228, v228
  v_add_f32 v237, v237, v227
  v_mfma_f32_32x32x16_bf16 v[144:159], a[152:155], a[56:59], v[144:159]
  v_exp_f32 v229, v229
  v_add_f32 v237, v237, v228
  v_cvt_pk_bf16_f32 v219, v230, v231
  v_fma_f32 v230, v190, s28, -v233
  v_add_f32 v237, v237, v229
  v_mfma_f32_32x32x16_bf16 v[128:143], a[156:159], a[28:31], v[128:143]
  v_exp_f32 v230, v230
  v_fma_f32 v231, v191, s28, -v233
  v_cvt_pk_bf16_f32 v220, v224, v225
  v_add_f32 v237, v237, v230
  v_exp_f32 v231, v231
  s_nop 0
  s_nop 0
  v_add_f32 v237, v237, v231
  s_nop 0
  v_max_f32 v224, v236, v237
  v_cmp_lt_f32 vcc, s29, v224
  v_mfma_f32_32x32x16_bf16 v[144:159], a[156:159], a[60:63], v[144:159]
  v_cvt_pk_bf16_f32 v221, v226, v227
  v_cvt_pk_bf16_f32 v222, v228, v229
  v_cvt_pk_bf16_f32 v223, v230, v231
  s_cbranch_vccnz RARE_9
RET_9:
  s_waitcnt vmcnt(32) lgkmcnt(0)
  v_mfma_f32_32x32x16_bf16 v[0:15], a[160:163], v[208:211], v[0:15]
  s_barrier
  v_mfma_f32_32x32x16_bf16 v[64:79], a[160:163], v[216:219], v[64:79]
  ds_read_b128 a[128:131], v238 offset:32768
  s_add_u32 s21, s21, s26
  s_add_u32 m0, s20, 16384
  v_fma_f32 v224, v128, s28, -v232
  v_add_f32 v234, v234, v236
  v_add_f32 v235, v235, v237
  v_mfma_f32_32x32x16_bf16 v[16:31], a[164:167], v[208:211], v[16:31]
  ds_read_b128 a[132:135], v239 offset:32768
  v_exp_f32 v224, v224
  v_fma_f32 v225, v129, s28, -v232
  v_fma_f32 v226, v130, s28, -v232
  v_fma_f32 v227, v131, s28, -v232
  v_mfma_f32_32x32x16_bf16 v[80:95], a[164:167], v[216:219], v[80:95]
  ds_read_b128 a[136:139], v240 offset:32768
  v_exp_f32 v225, v225
  v_fma_f32 v228, v132, s28, -v232
  v_exp_f32 v226, v226
  v_mfma_f32_32x32x16_bf16 v[32:47], a[168:171], v[208:211], v[32:47]
  ds_read_b128 a[140:143], v241 offset:32768
  v_exp_f32 v227, v227
  v_fma_f32 v229, v133, s28, -v232
  v_exp_f32 v228, v228
  v_mfma_f32_32x32x16_bf16 v[96:111], a[168:171], v[216:219], v[96:111]
  ds_read_b128 a[144:147], v242 offset:32768
  v_exp_f32 v229, v229
  v_fma_f32 v230, v134, s28, -v232
  v_add_f32 v236, v224, v225
  v_fma_f32 v231, v135, s28, -v232
  v_mfma_f32_32x32x16_bf16 v[48:63], a[172:175], v[208:211], v[48:63]
  ds_read_b128 a[148:151], v243 offset:32768
  v_exp_f32 v230, v230
  v_add_f32 v236, v236, v226
  v_exp_f32 v231, v231
  v_mfma_f32_32x32x16_bf16 v[112:127], a[172:175], v[216:219], v[112:127]
  ds_read_b128 a[152:155], v244 offset:32768
  v_add_f32 v236, v236, v227
  v_cvt_pk_bf16_f32 v192, v224, v225
  v_fma_f32 v224, v136, s28, -v232
  v_add_f32 v236, v236, v228
  v_fma_f32 v225, v137, s28, -v232
  v_mfma_f32_32x32x16_bf16 v[0:15], a[176:179], v[212:215], v[0:15]
  ds_read_b128 a[156:159], v245 offset:32768
  v_exp_f32 v224, v224
  v_add_f32 v236, v236, v229
  v_exp_f32 v225, v225
  v_mfma_f32_32x32x16_bf16 v[64:79], a[176:179], v[220:223], v[64:79]
  buffer_load_dwordx4 v250, s[8:11], s21 offen offset:0 nt lds
  v_add_f32 v236, v236, v230
  v_cvt_pk_bf16_f32 v193, v226, v227
  v_fma_f32 v226, v138, s28, -v232
  v_add_f32 v236, v236, v231
  v_fma_f32 v227, v139, s28, -v232
  v_mfma_f32_32x32x16_bf16 v[16:31], a[180:183], v[212:215], v[16:31]
  buffer_load_dwordx4 v251, s[8:11], s21 offen offset:1024 nt lds
  v_exp_f32 v226, v226
  v_add_f32 v236, v236, v224
  v_exp_f32 v227, v227
  v_mfma_f32_32x32x16_bf16 v[80:95], a[180:183], v[220:223], v[80:95]
  v_add_f32 v236, v236, v225
  v_cvt_pk_bf16_f32 v194, v228, v229
  v_fma_f32 v228, v140, s28, -v232
  v_add_f32 v236, v236, v226
  v_fma_f32 v229, v141, s28, -v232
  v_add_f32 v236, v236, v227
  v_mfma_f32_32x32x16_bf16 v[32:47], a[184:187], v[212:215], v[32:47]
  buffer_load_dwordx4 v252, s[8:11], s21 offen offset:2048 nt lds
  v_exp_f32 v228, v228
  v_cvt_pk_bf16_f32 v195, v230, v231
  v_exp_f32 v229, v229
  v_mfma_f32_32x32x16_bf16 v[96:111], a[184:187], v[220:223], v[96:111]
  buffer_load_dwordx4 v253, s[8:11], s21 offen offset:3072 nt lds
  v_fma_f32 v230, v142, s28, -v232
  v_add_f32 v236, v236, v228
  v_fma_f32 v231, v143, s28, -v232
  v_exp_f32 v230, v230
  v_mfma_f32_32x32x16_bf16 v[48:63], a[188:191], v[212:215], v[48:63]
  v_exp_f32 v231, v231
  v_add_f32 v236, v236, v229
  v_cvt_pk_bf16_f32 v196, v224, v225
  v_fma_f32 v224, v144, s28, -v233
  v_add_f32 v236, v236, v230
  v_mfma_f32_32x32x16_bf16 v[112:127], a[188:191], v[220:223], v[112:127]
  v_exp_f32 v224, v224
  v_fma_f32 v225, v145, s28, -v233
  v_add_f32 v236, v236, v231
  v_cvt_pk_bf16_f32 v197, v226, v227
  s_waitcnt lgkmcnt(0)
  v_mfma_f32_32x32x16_bf16 v[160:175], a[128:131], a[0:3], 0
  ds_read_b64_tr_b16 a[160:161], v246 offset:16384
  ds_read_b64_tr_b16 a[162:163], v246 offset:18432
  v_exp_f32 v225, v225
  v_fma_f32 v226, v146, s28, -v233
  v_cvt_pk_bf16_f32 v198, v228, v229
  v_mfma_f32_32x32x16_bf16 v[176:191], a[128:131], a[32:35], 0
  ds_read_b64_tr_b16 a[164:165], v247 offset:16384
  v_exp_f32 v226, v226
  v_fma_f32 v227, v147, s28, -v233
  v_add_f32 v237, v224, v225
  v_fma_f32 v228, v148, s28, -v233
  v_mfma_f32_32x32x16_bf16 v[160:175], a[132:135], a[4:7], v[160:175]
  ds_read_b64_tr_b16 a[166:167], v247 offset:18432
  v_exp_f32 v227, v227
  v_fma_f32 v229, v149, s28, -v233
  v_exp_f32 v228, v228
  v_mfma_f32_32x32x16_bf16 v[176:191], a[132:135], a[36:39], v[176:191]
  ds_read_b64_tr_b16 a[168:169], v248 offset:16384
  ds_read_b64_tr_b16 a[170:171], v248 offset:18432
  v_exp_f32 v229, v229
  v_add_f32 v237, v237, v226
  v_cvt_pk_bf16_f32 v199, v230, v231
  v_mfma_f32_32x32x16_bf16 v[160:175], a[136:139], a[8:11], v[160:175]
  ds_read_b64_tr_b16 a[172:173], v249 offset:16384
  v_fma_f32 v230, v150, s28, -v233
  v_add_f32 v237, v237, v227
  v_fma_f32 v231, v151, s28, -v233
  v_exp_f32 v230, v230
  v_mfma_f32_32x32x16_bf16 v[176:191], a[136:139], a[40:43], v[176:191]
  ds_read_b64_tr_b16 a[174:175], v249 offset:18432
  v_exp_f32 v231, v231
  v_add_f32 v237, v237, v228
  v_cvt_pk_bf16_f32 v200, v224, v225
  v_fma_f32 v224, v152, s28, -v233
  v_mfma_f32_32x32x16_bf16 v[160:175], a[140:143], a[12:15], v[160:175]
  ds_read_b64_tr_b16 a[176:177], v246 offset:20480
  ds_read_b64_tr_b16 a[178:179], v246 offset:22528
  v_exp_f32 v224, v224
  v_fma_f32 v225, v153, s28, -v233
  v_add_f32 v237, v237, v229
  v_mfma_f32_32x32x16_bf16 v[176:191], a[140:143], a[44:47], v[176:191]
  ds_read_b64_tr_b16 a[180:181], v247 offset:20480
  v_exp_f32 v225, v225
  v_add_f32 v237, v237, v230
  v_cvt_pk_bf16_f32 v201, v226, v227
  v_fma_f32 v226, v154, s28, -v233
  v_mfma_f32_32x32x16_bf16 v[160:175], a[144:147], a[16:19], v[160:175]
  ds_read_b64_tr_b16 a[182:183], v247 offset:22528
  v_exp_f32 v226, v226
  v_fma_f32 v227, v155, s28, -v233
  v_add_f32 v237, v237, v231
  v_cvt_pk_bf16_f32 v202, v228, v229
  v_mfma_f32_32x32x16_bf16 v[176:191], a[144:147], a[48:51], v[176:191]
  ds_read_b64_tr_b16 a[184:185], v248 offset:20480
  ds_read_b64_tr_b16 a[186:187], v248 offset:22528
  v_exp_f32 v227, v227
  v_fma_f32 v228, v156, s28, -v233
  v_add_f32 v237, v237, v224
  v_mfma_f32_32x32x16_bf16 v[160:175], a[148:151], a[20:23], v[160:175]
  ds_read_b64_tr_b16 a[188:189], v249 offset:20480
  v_exp_f32 v228, v228
  v_fma_f32 v229, v157, s28, -v233
  v_add_f32 v237, v237, v225
  v_cvt_pk_bf16_f32 v203, v230, v231
  v_mfma_f32_32x32x16_bf16 v[176:191], a[148:151], a[52:55], v[176:191]
  ds_read_b64_tr_b16 a[190:191], v249 offset:22528
  v_exp_f32 v229, v229
  v_fma_f32 v230, v158, s28, -v233
  v_add_f32 v237, v237, v226
  v_fma_f32 v231, v159, s28, -v233
  v_mfma_f32_32x32x16_bf16 v[160:175], a[152:155], a[24:27], v[160:175]
  buffer_store_dwordx4 a[228:231], v255, s[16:19], s82 offen offset:2048 nt
  buffer_store_dwordx4 a[244:247], v255, s[16:19], s82 offen offset:2176 nt
  v_exp_f32 v230, v230
  v_add_f32 v237, v237, v227
  v_cvt_pk_bf16_f32 v204, v224, v225
  v_mfma_f32_32x32x16_bf16 v[176:191], a[152:155], a[56:59], v[176:191]
  v_exp_f32 v231, v231
  v_add_f32 v237, v237, v228
  v_cvt_pk_bf16_f32 v205, v226, v227
  v_add_f32 v237, v237, v229
  v_cvt_pk_bf16_f32 v206, v228, v229
  v_mfma_f32_32x32x16_bf16 v[160:175], a[156:159], a[28:31], v[160:175]
  v_add_f32 v237, v237, v230
  v_cvt_pk_bf16_f32 v207, v230, v231
  v_add_f32 v237, v237, v231
  s_nop 0
  v_max_f32 v224, v236, v237
  v_cmp_lt_f32 vcc, s29, v224
  v_mfma_f32_32x32x16_bf16 v[176:191], a[156:159], a[60:63], v[176:191]
  s_cbranch_vccnz RARE_10
RET_10:
  s_waitcnt lgkmcnt(0)
  v_mfma_f32_32x32x16_bf16 v[0:15], a[160:163], v[192:195], v[0:15]
  s_add_u32 s22, s22, 0xfe4000
  s_add_u32 m0, s20, 65536
  v_add_f32 v234, v234, v236
  v_add_f32 v235, v235, v237
  v_mfma_f32_32x32x16_bf16 v[64:79], a[160:163], v[200:203], v[64:79]
  ds_read_b128 a[128:131], v238 offset:40960
  v_fma_f32 v224, v160, s28, -v232
  v_fma_f32 v225, v161, s28, -v232
  v_fma_f32 v226, v162, s28, -v232
  v_exp_f32 v224, v224
  v_mfma_f32_32x32x16_bf16 v[16:31], a[164:167], v[192:195], v[16:31]
  ds_read_b128 a[132:135], v239 offset:40960
  v_exp_f32 v225, v225
  v_fma_f32 v227, v163, s28, -v232
  v_exp_f32 v226, v226
  v_mfma_f32_32x32x16_bf16 v[80:95], a[164:167], v[200:203], v[80:95]
  ds_read_b128 a[136:139], v240 offset:40960
  v_exp_f32 v227, v227
  v_fma_f32 v228, v164, s28, -v232
  v_add_f32 v236, v224, v225
  v_fma_f32 v229, v165, s28, -v232
  v_mfma_f32_32x32x16_bf16 v[32:47], a[168:171], v[192:195], v[32:47]
  ds_read_b128 a[140:143], v241 offset:40960
  v_exp_f32 v228, v228
  v_fma_f32 v230, v166, s28, -v232
  v_exp_f32 v229, v229
  v_mfma_f32_32x32x16_bf16 v[96:111], a[168:171], v[200:203], v[96:111]
  ds_read_b128 a[144:147], v242 offset:40960
  v_exp_f32 v230, v230
  v_fma_f32 v231, v167, s28, -v232
  v_add_f32 v236, v236, v226
  v_cvt_pk_bf16_f32 v208, v224, v225
  v_mfma_f32_32x32x16_bf16 v[48:63], a[172:175], v[192:195], v[48:63]
  ds_read_b128 a[148:151], v243 offset:40960
  v_exp_f32 v231, v231
  v_fma_f32 v224, v168, s28, -v232
  v_add_f32 v236, v236, v227
  v_fma_f32 v225, v169, s28, -v232
  v_mfma_f32_32x32x16_bf16 v[112:127], a[172:175], v[200:203], v[112:127]
  ds_read_b128 a[152:155], v244 offset:40960
  v_exp_f32 v224, v224
  v_add_f32 v236, v236, v228
  v_exp_f32 v225, v225
  v_mfma_f32_32x32x16_bf16 v[0:15], a[176:179], v[196:199], v[0:15]
  ds_read_b128 a[156:159], v245 offset:40960
  v_add_f32 v236, v236, v229
  v_cvt_pk_bf16_f32 v209, v226, v227
  v_fma_f32 v226, v170, s28, -v232
  v_add_f32 v236, v236, v230
  v_fma_f32 v227, v171, s28, -v232
  v_mfma_f32_32x32x16_bf16 v[64:79], a[176:179], v[204:207], v[64:79]
  buffer_load_dwordx4 v254, s[12:15], s22 offen offset:0 nt lds
  v_exp_f32 v226, v226
  v_add_f32 v236, v236, v231
  v_exp_f32 v227, v227
  v_mfma_f32_32x32x16_bf16 v[16:31], a[180:183], v[196:199], v[16:31]
  buffer_load_dwordx4 v254, s[12:15], s22 offen offset:1024 nt lds
  v_add_f32 v236, v236, v224
  v_cvt_pk_bf16_f32 v210, v228, v229
  v_fma_f32 v228, v172, s28, -v232
  v_add_f32 v236, v236, v225
  v_fma_f32 v229, v173, s28, -v232
  v_mfma_f32_32x32x16_bf16 v[80:95], a[180:183], v[204:207], v[80:95]
  v_exp_f32 v228, v228
  v_add_f32 v236, v236, v226
  v_exp_f32 v229, v229
  v_add_f32 v236, v236, v227
  v_mfma_f32_32x32x16_bf16 v[32:47], a[184:187], v[196:199], v[32:47]
  buffer_load_dwordx4 v254, s[12:15], s22 offen offset:2048 nt lds
  v_add_f32 v236, v236, v228
  v_cvt_pk_bf16_f32 v211, v230, v231
  v_fma_f32 v230, v174, s28, -v232
  v_add_f32 v236, v236, v229
  v_fma_f32 v231, v175, s28, -v232
  v_mfma_f32_32x32x16_bf16 v[96:111], a[184:187], v[204:207], v[96:111]
  buffer_load_dwordx4 v254, s[12:15], s22 offen offset:3072 nt lds
  v_exp_f32 v230, v230
  v_cvt_pk_bf16_f32 v212, v224, v225
  v_exp_f32 v231, v231
  v_mfma_f32_32x32x16_bf16 v[48:63], a[188:191], v[196:199], v[48:63]
  v_fma_f32 v224, v176, s28, -v233
  v_add_f32 v236, v236, v230
  v_fma_f32 v225, v177, s28, -v233
  v_exp_f32 v224, v224
  v_add_f32 v236, v236, v231
  v_mfma_f32_32x32x16_bf16 v[112:127], a[188:191], v[204:207], v[112:127]
  v_exp_f32 v225, v225
  v_cvt_pk_bf16_f32 v213, v226, v227
  v_fma_f32 v226, v178, s28, -v233
  v_add_f32 v237, v224, v225
  s_waitcnt lgkmcnt(0)
  v_mfma_f32_32x32x16_bf16 v[128:143], a[128:131], a[0:3], 0
  ds_read_b64_tr_b16 a[160:161], v246 offset:24576
  ds_read_b64_tr_b16 a[162:163], v246 offset:26624
  v_exp_f32 v226, v226
  v_fma_f32 v227, v179, s28, -v233
  v_cvt_pk_bf16_f32 v214, v228, v229
  v_mfma_f32_32x32x16_bf16 v[144:159], a[128:131], a[32:35], 0
  ds_read_b64_tr_b16 a[164:165], v247 offset:24576
  v_exp_f32 v227, v227
  v_fma_f32 v228, v180, s28, -v233
  v_add_f32 v237, v237, v226
  v_fma_f32 v229, v181, s28, -v233
  v_mfma_f32_32x32x16_bf16 v[128:143], a[132:135], a[4:7], v[128:143]
  ds_read_b64_tr_b16 a[166:167], v247 offset:26624
  v_exp_f32 v228, v228
  v_add_f32 v237, v237, v227
  v_exp_f32 v229, v229
  v_mfma_f32_32x32x16_bf16 v[144:159], a[132:135], a[36:39], v[144:159]
  ds_read_b64_tr_b16 a[168:169], v248 offset:24576
  ds_read_b64_tr_b16 a[170:171], v248 offset:26624
  v_add_f32 v237, v237, v228
  v_cvt_pk_bf16_f32 v215, v230, v231
  v_fma_f32 v230, v182, s28, -v233
  v_add_f32 v237, v237, v229
  v_mfma_f32_32x32x16_bf16 v[128:143], a[136:139], a[8:11], v[128:143]
  ds_read_b64_tr_b16 a[172:173], v249 offset:24576
  v_exp_f32 v230, v230
  v_fma_f32 v231, v183, s28, -v233
  v_cvt_pk_bf16_f32 v216, v224, v225
  v_fma_f32 v224, v184, s28, -v233
  v_mfma_f32_32x32x16_bf16 v[144:159], a[136:139], a[40:43], v[144:159]
  ds_read_b64_tr_b16 a[174:175], v249 offset:26624
  v_exp_f32 v231, v231
  v_fma_f32 v225, v185, s28, -v233
  v_exp_f32 v224, v224
  v_mfma_f32_32x32x16_bf16 v[128:143], a[140:143], a[12:15], v[128:143]
  ds_read_b64_tr_b16 a[176:177], v246 offset:28672
  ds_read_b64_tr_b16 a[178:179], v246 offset:30720
  v_exp_f32 v225, v225
  v_add_f32 v237, v237, v230
  v_cvt_pk_bf16_f32 v217, v226, v227
  v_mfma_f32_32x32x16_bf16 v[144:159], a[140:143], a[44:47], v[144:159]
  ds_read_b64_tr_b16 a[180:181], v247 offset:28672
  v_fma_f32 v226, v186, s28, -v233
  v_add_f32 v237, v237, v231
  v_fma_f32 v227, v187, s28, -v233
  v_exp_f32 v226, v226
  v_mfma_f32_32x32x16_bf16 v[128:143], a[144:147], a[16:19], v[128:143]
  ds_read_b64_tr_b16 a[182:183], v247 offset:30720
  v_exp_f32 v227, v227
  v_add_f32 v237, v237, v224
  v_cvt_pk_bf16_f32 v218, v228, v229
  v_fma_f32 v228, v188, s28, -v233
  v_mfma_f32_32x32x16_bf16 v[144:159], a[144:147], a[48:51], v[144:159]
  ds_read_b64_tr_b16 a[184:185], v248 offset:28672
  ds_read_b64_tr_b16 a[186:187], v248 offset:30720
  v_exp_f32 v228, v228
  v_fma_f32 v229, v189, s28, -v233
  v_add_f32 v237, v237, v225
  v_mfma_f32_32x32x16_bf16 v[128:143], a[148:151], a[20:23], v[128:143]
  ds_read_b64_tr_b16 a[188:189], v249 offset:28672
  v_exp_f32 v229, v229
  v_add_f32 v237, v237, v226
  v_cvt_pk_bf16_f32 v219, v230, v231
  v_fma_f32 v230, v190, s28, -v233
  v_mfma_f32_32x32x16_bf16 v[144:159], a[148:151], a[52:55], v[144:159]
  ds_read_b64_tr_b16 a[190:191], v249 offset:30720
  v_exp_f32 v230, v230
  v_fma_f32 v231, v191, s28, -v233
  v_add_f32 v237, v237, v227
  v_cvt_pk_bf16_f32 v220, v224, v225
  v_mfma_f32_32x32x16_bf16 v[128:143], a[152:155], a[24:27], v[128:143]
  buffer_store_dwordx4 a[232:235], v255, s[16:19], s83 offen offset:0 nt
  buffer_store_dwordx4 a[248:251], v255, s[16:19], s83 offen offset:128 nt
  v_exp_f32 v231, v231
  v_add_f32 v237, v237, v228
  v_cvt_pk_bf16_f32 v221, v226, v227
  v_mfma_f32_32x32x16_bf16 v[144:159], a[152:155], a[56:59], v[144:159]
  v_add_f32 v237, v237, v229
  v_cvt_pk_bf16_f32 v222, v228, v229
  v_add_f32 v237, v237, v230
  v_cvt_pk_bf16_f32 v223, v230, v231
  v_add_f32 v237, v237, v231
  v_mfma_f32_32x32x16_bf16 v[128:143], a[156:159], a[28:31], v[128:143]
  v_max_f32 v224, v236, v237
  v_cmp_lt_f32 vcc, s29, v224
  v_mfma_f32_32x32x16_bf16 v[144:159], a[156:159], a[60:63], v[144:159]
  s_cbranch_vccnz RARE_11
RET_11:
  s_waitcnt vmcnt(32) lgkmcnt(0)
  v_mfma_f32_32x32x16_bf16 v[0:15], a[160:163], v[208:211], v[0:15]
  s_barrier
  v_mfma_f32_32x32x16_bf16 v[64:79], a[160:163], v[216:219], v[64:79]
  ds_read_b128 a[128:131], v238 offset:49152
  s_add_u32 s21, s21, 0x4000
  s_add_u32 m0, s20, 32768
  s_nop 0
  v_fma_f32 v224, v128, s28, -v232
  v_add_f32 v234, v234, v236
  v_add_f32 v235, v235, v237
  v_mfma_f32_32x32x16_bf16 v[16:31], a[164:167], v[208:211], v[16:31]
  ds_read_b128 a[132:135], v239 offset:49152
  v_exp_f32 v224, v224
  v_fma_f32 v225, v129, s28, -v232
  v_fma_f32 v226, v130, s28, -v232
  v_fma_f32 v227, v131, s28, -v232
  v_mfma_f32_32x32x16_bf16 v[80:95], a[164:167], v[216:219], v[80:95]
  ds_read_b128 a[136:139], v240 offset:49152
  v_exp_f32 v225, v225
  v_fma_f32 v228, v132, s28, -v232
  v_exp_f32 v226, v226
  v_mfma_f32_32x32x16_bf16 v[32:47], a[168:171], v[208:211], v[32:47]
  ds_read_b128 a[140:143], v241 offset:49152
  v_exp_f32 v227, v227
  v_fma_f32 v229, v133, s28, -v232
  v_exp_f32 v228, v228
  v_mfma_f32_32x32x16_bf16 v[96:111], a[168:171], v[216:219], v[96:111]
  ds_read_b128 a[144:147], v242 offset:49152
  v_exp_f32 v229, v229
  v_fma_f32 v230, v134, s28, -v232
  v_add_f32 v236, v224, v225
  v_fma_f32 v231, v135, s28, -v232
  v_mfma_f32_32x32x16_bf16 v[48:63], a[172:175], v[208:211], v[48:63]
  ds_read_b128 a[148:151], v243 offset:49152
  v_exp_f32 v230, v230
  v_add_f32 v236, v236, v226
  v_exp_f32 v231, v231
  v_mfma_f32_32x32x16_bf16 v[112:127], a[172:175], v[216:219], v[112:127]
  ds_read_b128 a[152:155], v244 offset:49152
  v_add_f32 v236, v236, v227
  v_cvt_pk_bf16_f32 v192, v224, v225
  v_fma_f32 v224, v136, s28, -v232
  v_add_f32 v236, v236, v228
  v_fma_f32 v225, v137, s28, -v232
  v_mfma_f32_32x32x16_bf16 v[0:15], a[176:179], v[212:215], v[0:15]
  ds_read_b128 a[156:159], v245 offset:49152
  v_exp_f32 v224, v224
  v_add_f32 v236, v236, v229
  v_exp_f32 v225, v225
  v_mfma_f32_32x32x16_bf16 v[64:79], a[176:179], v[220:223], v[64:79]
  buffer_load_dwordx4 v250, s[8:11], s21 offen offset:0 nt lds
  v_add_f32 v236, v236, v230
  v_cvt_pk_bf16_f32 v193, v226, v227
  v_fma_f32 v226, v138, s28, -v232
  v_add_f32 v236, v236, v231
  v_fma_f32 v227, v139, s28, -v232
  v_mfma_f32_32x32x16_bf16 v[16:31], a[180:183], v[212:215], v[16:31]
  buffer_load_dwordx4 v251, s[8:11], s21 offen offset:1024 nt lds
  v_exp_f32 v226, v226
  v_add_f32 v236, v236, v224
  v_exp_f32 v227, v227
  v_mfma_f32_32x32x16_bf16 v[80:95], a[180:183], v[220:223], v[80:95]
  v_add_f32 v236, v236, v225
  v_cvt_pk_bf16_f32 v194, v228, v229
  v_fma_f32 v228, v140, s28, -v232
  v_add_f32 v236, v236, v226
  v_fma_f32 v229, v141, s28, -v232
  v_add_f32 v236, v236, v227
  v_mfma_f32_32x32x16_bf16 v[32:47], a[184:187], v[212:215], v[32:47]
  buffer_load_dwordx4 v252, s[8:11], s21 offen offset:2048 nt lds
  v_exp_f32 v228, v228
  v_cvt_pk_bf16_f32 v195, v230, v231
  v_exp_f32 v229, v229
  v_mfma_f32_32x32x16_bf16 v[96:111], a[184:187], v[220:223], v[96:111]
  buffer_load_dwordx4 v253, s[8:11], s21 offen offset:3072 nt lds
  v_fma_f32 v230, v142, s28, -v232
  v_add_f32 v236, v236, v228
  v_fma_f32 v231, v143, s28, -v232
  v_exp_f32 v230, v230
  v_mfma_f32_32x32x16_bf16 v[48:63], a[188:191], v[212:215], v[48:63]
  v_exp_f32 v231, v231
  v_add_f32 v236, v236, v229
  v_cvt_pk_bf16_f32 v196, v224, v225
  v_fma_f32 v224, v144, s28, -v233
  v_add_f32 v236, v236, v230
  v_mfma_f32_32x32x16_bf16 v[112:127], a[188:191], v[220:223], v[112:127]
  v_exp_f32 v224, v224
  v_fma_f32 v225, v145, s28, -v233
  v_add_f32 v236, v236, v231
  v_cvt_pk_bf16_f32 v197, v226, v227
  s_waitcnt lgkmcnt(0)
  v_mfma_f32_32x32x16_bf16 v[160:175], a[128:131], a[0:3], 0
  ds_read_b64_tr_b16 a[160:161], v246 offset:32768
  ds_read_b64_tr_b16 a[162:163], v246 offset:34816
  v_exp_f32 v225, v225
  v_fma_f32 v226, v146, s28, -v233
  v_cvt_pk_bf16_f32 v198, v228, v229
  v_mfma_f32_32x32x16_bf16 v[176:191], a[128:131], a[32:35], 0
  ds_read_b64_tr_b16 a[164:165], v247 offset:32768
  v_exp_f32 v226, v226
  v_fma_f32 v227, v147, s28, -v233
  v_add_f32 v237, v224, v225
  v_fma_f32 v228, v148, s28, -v233
  v_mfma_f32_32x32x16_bf16 v[160:175], a[132:135], a[4:7], v[160:175]
  ds_read_b64_tr_b16 a[166:167], v247 offset:34816
  v_exp_f32 v227, v227
  v_fma_f32 v229, v149, s28, -v233
  v_exp_f32 v228, v228
  v_mfma_f32_32x32x16_bf16 v[176:191], a[132:135], a[36:39], v[176:191]
  ds_read_b64_tr_b16 a[168:169], v248 offset:32768
  ds_read_b64_tr_b16 a[170:171], v248 offset:34816
  v_exp_f32 v229, v229
  v_add_f32 v237, v237, v226
  v_cvt_pk_bf16_f32 v199, v230, v231
  v_mfma_f32_32x32x16_bf16 v[160:175], a[136:139], a[8:11], v[160:175]
  ds_read_b64_tr_b16 a[172:173], v249 offset:32768
  v_fma_f32 v230, v150, s28, -v233
  v_add_f32 v237, v237, v227
  v_fma_f32 v231, v151, s28, -v233
  v_exp_f32 v230, v230
  v_mfma_f32_32x32x16_bf16 v[176:191], a[136:139], a[40:43], v[176:191]
  ds_read_b64_tr_b16 a[174:175], v249 offset:34816
  v_exp_f32 v231, v231
  v_add_f32 v237, v237, v228
  v_cvt_pk_bf16_f32 v200, v224, v225
  v_fma_f32 v224, v152, s28, -v233
  v_mfma_f32_32x32x16_bf16 v[160:175], a[140:143], a[12:15], v[160:175]
  ds_read_b64_tr_b16 a[176:177], v246 offset:36864
  ds_read_b64_tr_b16 a[178:179], v246 offset:38912
  v_exp_f32 v224, v224
  v_fma_f32 v225, v153, s28, -v233
  v_add_f32 v237, v237, v229
  v_mfma_f32_32x32x16_bf16 v[176:191], a[140:143], a[44:47], v[176:191]
  ds_read_b64_tr_b16 a[180:181], v247 offset:36864
  v_exp_f32 v225, v225
  v_add_f32 v237, v237, v230
  v_cvt_pk_bf16_f32 v201, v226, v227
  v_fma_f32 v226, v154, s28, -v233
  v_mfma_f32_32x32x16_bf16 v[160:175], a[144:147], a[16:19], v[160:175]
  ds_read_b64_tr_b16 a[182:183], v247 offset:38912
  v_exp_f32 v226, v226
  v_fma_f32 v227, v155, s28, -v233
  v_add_f32 v237, v237, v231
  v_cvt_pk_bf16_f32 v202, v228, v229
  v_mfma_f32_32x32x16_bf16 v[176:191], a[144:147], a[48:51], v[176:191]
  ds_read_b64_tr_b16 a[184:185], v248 offset:36864
  ds_read_b64_tr_b16 a[186:187], v248 offset:38912
  v_exp_f32 v227, v227
  v_fma_f32 v228, v156, s28, -v233
  v_add_f32 v237, v237, v224
  v_mfma_f32_32x32x16_bf16 v[160:175], a[148:151], a[20:23], v[160:175]
  ds_read_b64_tr_b16 a[188:189], v249 offset:36864
  v_exp_f32 v228, v228
  v_fma_f32 v229, v157, s28, -v233
  v_add_f32 v237, v237, v225
  v_cvt_pk_bf16_f32 v203, v230, v231
  v_mfma_f32_32x32x16_bf16 v[176:191], a[148:151], a[52:55], v[176:191]
  ds_read_b64_tr_b16 a[190:191], v249 offset:38912
  v_exp_f32 v229, v229
  v_fma_f32 v230, v158, s28, -v233
  v_add_f32 v237, v237, v226
  v_fma_f32 v231, v159, s28, -v233
  v_mfma_f32_32x32x16_bf16 v[160:175], a[152:155], a[24:27], v[160:175]
  buffer_store_dwordx4 a[236:239], v255, s[16:19], s83 offen offset:2048 nt
  buffer_store_dwordx4 a[252:255], v255, s[16:19], s83 offen offset:2176 nt
  v_exp_f32 v230, v230
  v_add_f32 v237, v237, v227
  v_cvt_pk_bf16_f32 v204, v224, v225
  v_mfma_f32_32x32x16_bf16 v[176:191], a[152:155], a[56:59], v[176:191]
  v_exp_f32 v231, v231
  v_add_f32 v237, v237, v228
  v_cvt_pk_bf16_f32 v205, v226, v227
  v_add_f32 v237, v237, v229
  v_cvt_pk_bf16_f32 v206, v228, v229
  v_mfma_f32_32x32x16_bf16 v[160:175], a[156:159], a[28:31], v[160:175]
  v_add_f32 v237, v237, v230
  v_cvt_pk_bf16_f32 v207, v230, v231
  v_add_f32 v237, v237, v231
  s_nop 0
  v_max_f32 v224, v236, v237
  v_cmp_lt_f32 vcc, s29, v224
  v_mfma_f32_32x32x16_bf16 v[176:191], a[156:159], a[60:63], v[176:191]
  s_cbranch_vccnz RARE_12
RET_12:
  s_waitcnt lgkmcnt(0)
  v_mfma_f32_32x32x16_bf16 v[0:15], a[160:163], v[192:195], v[0:15]
  s_add_u32 s22, s22, 0x4000
  s_add_u32 m0, s20, 81920
  v_add_f32 v234, v234, v236
  v_add_f32 v235, v235, v237
  v_mfma_f32_32x32x16_bf16 v[64:79], a[160:163], v[200:203], v[64:79]
  ds_read_b128 a[128:131], v238 offset:57344
  v_fma_f32 v224, v160, s28, -v232
  v_fma_f32 v225, v161, s28, -v232
  v_fma_f32 v226, v162, s28, -v232
  v_exp_f32 v224, v224
  v_mfma_f32_32x32x16_bf16 v[16:31], a[164:167], v[192:195], v[16:31]
  ds_read_b128 a[132:135], v239 offset:57344
  v_exp_f32 v225, v225
  v_fma_f32 v227, v163, s28, -v232
  v_exp_f32 v226, v226
  v_mfma_f32_32x32x16_bf16 v[80:95], a[164:167], v[200:203], v[80:95]
  ds_read_b128 a[136:139], v240 offset:57344
  v_exp_f32 v227, v227
  v_fma_f32 v228, v164, s28, -v232
  v_add_f32 v236, v224, v225
  v_fma_f32 v229, v165, s28, -v232
  v_mfma_f32_32x32x16_bf16 v[32:47], a[168:171], v[192:195], v[32:47]
  ds_read_b128 a[140:143], v241 offset:57344
  v_exp_f32 v228, v228
  v_fma_f32 v230, v166, s28, -v232
  v_exp_f32 v229, v229
  v_mfma_f32_32x32x16_bf16 v[96:111], a[168:171], v[200:203], v[96:111]
  ds_read_b128 a[144:147], v242 offset:57344
  v_exp_f32 v230, v230
  v_fma_f32 v231, v167, s28, -v232
  v_add_f32 v236, v236, v226
  v_cvt_pk_bf16_f32 v208, v224, v225
  v_mfma_f32_32x32x16_bf16 v[48:63], a[172:175], v[192:195], v[48:63]
  ds_read_b128 a[148:151], v243 offset:57344
  v_exp_f32 v231, v231
  v_fma_f32 v224, v168, s28, -v232
  v_add_f32 v236, v236, v227
  v_fma_f32 v225, v169, s28, -v232
  v_mfma_f32_32x32x16_bf16 v[112:127], a[172:175], v[200:203], v[112:127]
  ds_read_b128 a[152:155], v244 offset:57344
  v_exp_f32 v224, v224
  v_add_f32 v236, v236, v228
  v_exp_f32 v225, v225
  v_mfma_f32_32x32x16_bf16 v[0:15], a[176:179], v[196:199], v[0:15]
  ds_read_b128 a[156:159], v245 offset:57344
  v_add_f32 v236, v236, v229
  v_cvt_pk_bf16_f32 v209, v226, v227
  v_fma_f32 v226, v170, s28, -v232
  v_add_f32 v236, v236, v230
  v_fma_f32 v227, v171, s28, -v232
  v_mfma_f32_32x32x16_bf16 v[64:79], a[176:179], v[204:207], v[64:79]
  buffer_load_dwordx4 v254, s[12:15], s22 offen offset:0 nt lds
  v_exp_f32 v226, v226
  v_add_f32 v236, v236, v231
  v_exp_f32 v227, v227
  v_mfma_f32_32x32x16_bf16 v[16:31], a[180:183], v[196:199], v[16:31]
  buffer_load_dwordx4 v254, s[12:15], s22 offen offset:1024 nt lds
  v_add_f32 v236, v236, v224
  v_cvt_pk_bf16_f32 v210, v228, v229
  v_fma_f32 v228, v172, s28, -v232
  v_add_f32 v236, v236, v225
  v_fma_f32 v229, v173, s28, -v232
  v_mfma_f32_32x32x16_bf16 v[80:95], a[180:183], v[204:207], v[80:95]
  v_exp_f32 v228, v228
  v_add_f32 v236, v236, v226
  v_exp_f32 v229, v229
  v_add_f32 v236, v236, v227
  v_mfma_f32_32x32x16_bf16 v[32:47], a[184:187], v[196:199], v[32:47]
  buffer_load_dwordx4 v254, s[12:15], s22 offen offset:2048 nt lds
  v_add_f32 v236, v236, v228
  v_cvt_pk_bf16_f32 v211, v230, v231
  v_fma_f32 v230, v174, s28, -v232
  v_add_f32 v236, v236, v229
  v_fma_f32 v231, v175, s28, -v232
  v_mfma_f32_32x32x16_bf16 v[96:111], a[184:187], v[204:207], v[96:111]
  buffer_load_dwordx4 v254, s[12:15], s22 offen offset:3072 nt lds
  v_exp_f32 v230, v230
  v_cvt_pk_bf16_f32 v212, v224, v225
  v_exp_f32 v231, v231
  v_mfma_f32_32x32x16_bf16 v[48:63], a[188:191], v[196:199], v[48:63]
  v_fma_f32 v224, v176, s28, -v233
  v_add_f32 v236, v236, v230
  v_fma_f32 v225, v177, s28, -v233
  v_exp_f32 v224, v224
  v_add_f32 v236, v236, v231
  v_mfma_f32_32x32x16_bf16 v[112:127], a[188:191], v[204:207], v[112:127]
  v_exp_f32 v225, v225
  v_cvt_pk_bf16_f32 v213, v226, v227
  v_fma_f32 v226, v178, s28, -v233
  v_add_f32 v237, v224, v225
  s_waitcnt lgkmcnt(0)
  v_mfma_f32_32x32x16_bf16 v[128:143], a[128:131], a[0:3], 0
  ds_read_b64_tr_b16 a[160:161], v246 offset:40960
  ds_read_b64_tr_b16 a[162:163], v246 offset:43008
  v_exp_f32 v226, v226
  v_fma_f32 v227, v179, s28, -v233
  v_cvt_pk_bf16_f32 v214, v228, v229
  v_mfma_f32_32x32x16_bf16 v[144:159], a[128:131], a[32:35], 0
  ds_read_b64_tr_b16 a[164:165], v247 offset:40960
  v_exp_f32 v227, v227
  v_fma_f32 v228, v180, s28, -v233
  v_add_f32 v237, v237, v226
  v_fma_f32 v229, v181, s28, -v233
  v_mfma_f32_32x32x16_bf16 v[128:143], a[132:135], a[4:7], v[128:143]
  ds_read_b64_tr_b16 a[166:167], v247 offset:43008
  v_exp_f32 v228, v228
  v_add_f32 v237, v237, v227
  v_exp_f32 v229, v229
  v_mfma_f32_32x32x16_bf16 v[144:159], a[132:135], a[36:39], v[144:159]
  ds_read_b64_tr_b16 a[168:169], v248 offset:40960
  ds_read_b64_tr_b16 a[170:171], v248 offset:43008
  v_add_f32 v237, v237, v228
  v_cvt_pk_bf16_f32 v215, v230, v231
  v_fma_f32 v230, v182, s28, -v233
  v_add_f32 v237, v237, v229
  v_mfma_f32_32x32x16_bf16 v[128:143], a[136:139], a[8:11], v[128:143]
  ds_read_b64_tr_b16 a[172:173], v249 offset:40960
  v_exp_f32 v230, v230
  v_fma_f32 v231, v183, s28, -v233
  v_cvt_pk_bf16_f32 v216, v224, v225
  v_fma_f32 v224, v184, s28, -v233
  v_mfma_f32_32x32x16_bf16 v[144:159], a[136:139], a[40:43], v[144:159]
  ds_read_b64_tr_b16 a[174:175], v249 offset:43008
  v_exp_f32 v231, v231
  v_fma_f32 v225, v185, s28, -v233
  v_exp_f32 v224, v224
  v_mfma_f32_32x32x16_bf16 v[128:143], a[140:143], a[12:15], v[128:143]
  ds_read_b64_tr_b16 a[176:177], v246 offset:45056
  ds_read_b64_tr_b16 a[178:179], v246 offset:47104
  v_exp_f32 v225, v225
  v_add_f32 v237, v237, v230
  v_cvt_pk_bf16_f32 v217, v226, v227
  v_mfma_f32_32x32x16_bf16 v[144:159], a[140:143], a[44:47], v[144:159]
  ds_read_b64_tr_b16 a[180:181], v247 offset:45056
  v_fma_f32 v226, v186, s28, -v233
  v_add_f32 v237, v237, v231
  v_fma_f32 v227, v187, s28, -v233
  v_exp_f32 v226, v226
  v_mfma_f32_32x32x16_bf16 v[128:143], a[144:147], a[16:19], v[128:143]
  ds_read_b64_tr_b16 a[182:183], v247 offset:47104
  v_exp_f32 v227, v227
  v_add_f32 v237, v237, v224
  v_cvt_pk_bf16_f32 v218, v228, v229
  v_fma_f32 v228, v188, s28, -v233
  v_mfma_f32_32x32x16_bf16 v[144:159], a[144:147], a[48:51], v[144:159]
  ds_read_b64_tr_b16 a[184:185], v248 offset:45056
  ds_read_b64_tr_b16 a[186:187], v248 offset:47104
  v_exp_f32 v228, v228
  v_fma_f32 v229, v189, s28, -v233
  v_add_f32 v237, v237, v225
  v_mfma_f32_32x32x16_bf16 v[128:143], a[148:151], a[20:23], v[128:143]
  ds_read_b64_tr_b16 a[188:189], v249 offset:45056
  v_exp_f32 v229, v229
  v_add_f32 v237, v237, v226
  v_cvt_pk_bf16_f32 v219, v230, v231
  v_fma_f32 v230, v190, s28, -v233
  v_mfma_f32_32x32x16_bf16 v[144:159], a[148:151], a[52:55], v[144:159]
  ds_read_b64_tr_b16 a[190:191], v249 offset:47104
  v_exp_f32 v230, v230
  v_fma_f32 v231, v191, s28, -v233
  v_add_f32 v237, v237, v227
  v_cvt_pk_bf16_f32 v220, v224, v225
  v_mfma_f32_32x32x16_bf16 v[128:143], a[152:155], a[24:27], v[128:143]
  v_exp_f32 v231, v231
  v_add_f32 v237, v237, v228
  v_cvt_pk_bf16_f32 v221, v226, v227
  v_add_f32 v237, v237, v229
  v_cvt_pk_bf16_f32 v222, v228, v229
  v_mfma_f32_32x32x16_bf16 v[144:159], a[152:155], a[56:59], v[144:159]
  v_add_f32 v237, v237, v230
  v_cvt_pk_bf16_f32 v223, v230, v231
  v_add_f32 v237, v237, v231
  v_mfma_f32_32x32x16_bf16 v[128:143], a[156:159], a[28:31], v[128:143]
  v_max_f32 v224, v236, v237
  v_cmp_lt_f32 vcc, s29, v224
  v_mfma_f32_32x32x16_bf16 v[144:159], a[156:159], a[60:63], v[144:159]
  s_cbranch_vccnz RARE_13
RET_13:
  s_waitcnt vmcnt(24) lgkmcnt(0)
  v_mfma_f32_32x32x16_bf16 v[0:15], a[160:163], v[208:211], v[0:15]
  s_barrier
  v_mfma_f32_32x32x16_bf16 v[64:79], a[160:163], v[216:219], v[64:79]
  ds_read_b128 a[128:131], v238 offset:0
  s_add_u32 s21, s21, 0x4000
  s_add_u32 m0, s20, 49152
  s_nop 0
  v_fma_f32 v224, v128, s28, -v232
  v_add_f32 v234, v234, v236
  v_add_f32 v235, v235, v237
  v_mfma_f32_32x32x16_bf16 v[16:31], a[164:167], v[208:211], v[16:31]
  ds_read_b128 a[132:135], v239 offset:0
  buffer_load_dwordx4 v250, s[8:11], s21 offen offset:0 nt lds
  v_exp_f32 v224, v224
  v_fma_f32 v225, v129, s28, -v232
  v_fma_f32 v226, v130, s28, -v232
  v_mfma_f32_32x32x16_bf16 v[80:95], a[164:167], v[216:219], v[80:95]
  ds_read_b128 a[136:139], v240 offset:0
  buffer_load_dwordx4 v251, s[8:11], s21 offen offset:1024 nt lds
  v_exp_f32 v225, v225
  v_fma_f32 v227, v131, s28, -v232
  v_fma_f32 v228, v132, s28, -v232
  v_mfma_f32_32x32x16_bf16 v[32:47], a[168:171], v[208:211], v[32:47]
  ds_read_b128 a[140:143], v241 offset:0
  v_exp_f32 v226, v226
  v_fma_f32 v229, v133, s28, -v232
  v_exp_f32 v227, v227
  v_mfma_f32_32x32x16_bf16 v[96:111], a[168:171], v[216:219], v[96:111]
  ds_read_b128 a[144:147], v242 offset:0
  buffer_load_dwordx4 v252, s[8:11], s21 offen offset:2048 nt lds
  v_exp_f32 v228, v228
  v_fma_f32 v230, v134, s28, -v232
  v_add_f32 v236, v224, v225
  v_mfma_f32_32x32x16_bf16 v[48:63], a[172:175], v[208:211], v[48:63]
  ds_read_b128 a[148:151], v243 offset:0
  v_exp_f32 v229, v229
  v_fma_f32 v231, v135, s28, -v232
  v_exp_f32 v230, v230
  v_mfma_f32_32x32x16_bf16 v[112:127], a[172:175], v[216:219], v[112:127]
  ds_read_b128 a[152:155], v244 offset:0
  buffer_load_dwordx4 v253, s[8:11], s21 offen offset:3072 nt lds
  v_exp_f32 v231, v231
  v_add_f32 v236, v236, v226
  v_cvt_pk_bf16_f32 v192, v224, v225
  v_mfma_f32_32x32x16_bf16 v[0:15], a[176:179], v[212:215], v[0:15]
  ds_read_b128 a[156:159], v245 offset:0
  v_fma_f32 v224, v136, s28, -v232
  v_add_f32 v236, v236, v227
  v_fma_f32 v225, v137, s28, -v232
  v_exp_f32 v224, v224
  v_mfma_f32_32x32x16_bf16 v[64:79], a[176:179], v[220:223], v[64:79]
  v_add_u32 v160, s30, v238
  ds_read_b128 a[96:99], v160 offset:0
  v_add_u32 v161, s30, v239
  ds_read_b128 a[100:103], v161 offset:0
  v_exp_f32 v225, v225
  v_mfma_f32_32x32x16_bf16 v[16:31], a[180:183], v[212:215], v[16:31]
  v_add_u32 v162, s30, v240
  ds_read_b128 a[104:107], v162 offset:0
  v_add_f32 v236, v236, v228
  v_cvt_pk_bf16_f32 v193, v226, v227
  v_fma_f32 v226, v138, s28, -v232
  v_add_f32 v236, v236, v229
  v_mfma_f32_32x32x16_bf16 v[80:95], a[180:183], v[220:223], v[80:95]
  v_add_u32 v163, s30, v241
  ds_read_b128 a[108:111], v163 offset:0
  v_exp_f32 v226, v226
  v_fma_f32 v227, v139, s28, -v232
  v_add_f32 v236, v236, v230
  v_mfma_f32_32x32x16_bf16 v[32:47], a[184:187], v[212:215], v[32:47]
  v_add_u32 v164, s30, v242
  ds_read_b128 a[112:115], v164 offset:0
  v_add_u32 v165, s30, v243
  ds_read_b128 a[116:119], v165 offset:0
  v_exp_f32 v227, v227
  v_mfma_f32_32x32x16_bf16 v[96:111], a[184:187], v[220:223], v[96:111]
  v_add_u32 v166, s30, v244
  ds_read_b128 a[120:123], v166 offset:0
  v_add_f32 v236, v236, v231
  v_cvt_pk_bf16_f32 v194, v228, v229
  v_fma_f32 v228, v140, s28, -v232
  v_add_f32 v236, v236, v224
  v_mfma_f32_32x32x16_bf16 v[48:63], a[188:191], v[212:215], v[48:63]
  v_add_u32 v167, s30, v245
  ds_read_b128 a[124:127], v167 offset:0
  v_exp_f32 v228, v228
  v_fma_f32 v229, v141, s28, -v232
  v_add_f32 v236, v236, v225
  v_mfma_f32_32x32x16_bf16 v[112:127], a[188:191], v[220:223], v[112:127]
  v_exp_f32 v229, v229
  v_add_f32 v236, v236, v226
  v_cvt_pk_bf16_f32 v195, v230, v231
  v_fma_f32 v230, v142, s28, -v232
  s_waitcnt lgkmcnt(8)
  v_mfma_f32_32x32x16_bf16 v[160:175], a[128:131], a[0:3], 0
  ds_read_b64_tr_b16 a[160:161], v246 offset:49152
  ds_read_b64_tr_b16 a[162:163], v246 offset:51200
  v_exp_f32 v230, v230
  v_fma_f32 v231, v143, s28, -v232
  v_add_f32 v236, v236, v227
  v_mfma_f32_32x32x16_bf16 v[176:191], a[128:131], a[32:35], 0
  ds_read_b64_tr_b16 a[164:165], v247 offset:49152
  v_exp_f32 v231, v231
  v_add_f32 v236, v236, v228
  v_cvt_pk_bf16_f32 v196, v224, v225
  v_fma_f32 v224, v144, s28, -v233
  v_mfma_f32_32x32x16_bf16 v[160:175], a[132:135], a[4:7], v[160:175]
  ds_read_b64_tr_b16 a[166:167], v247 offset:51200
  v_exp_f32 v224, v224
  v_fma_f32 v225, v145, s28, -v233
  v_add_f32 v236, v236, v229
  v_cvt_pk_bf16_f32 v197, v226, v227
  v_mfma_f32_32x32x16_bf16 v[176:191], a[132:135], a[36:39], v[176:191]
  ds_read_b64_tr_b16 a[168:169], v248 offset:49152
  ds_read_b64_tr_b16 a[170:171], v248 offset:51200
  v_exp_f32 v225, v225
  v_fma_f32 v226, v146, s28, -v233
  v_add_f32 v236, v236, v230
  v_mfma_f32_32x32x16_bf16 v[160:175], a[136:139], a[8:11], v[160:175]
  ds_read_b64_tr_b16 a[172:173], v249 offset:49152
  v_exp_f32 v226, v226
  v_fma_f32 v227, v147, s28, -v233
  v_add_f32 v236, v236, v231
  v_cvt_pk_bf16_f32 v198, v228, v229
  v_mfma_f32_32x32x16_bf16 v[176:191], a[136:139], a[40:43], v[176:191]
  ds_read_b64_tr_b16 a[174:175], v249 offset:51200
  v_exp_f32 v227, v227
  v_fma_f32 v228, v148, s28, -v233
  v_add_f32 v237, v224, v225
  v_fma_f32 v229, v149, s28, -v233
  v_mfma_f32_32x32x16_bf16 v[160:175], a[140:143], a[12:15], v[160:175]
  ds_read_b64_tr_b16 a[176:177], v246 offset:53248
  ds_read_b64_tr_b16 a[178:179], v246 offset:55296
  v_exp_f32 v228, v228
  v_add_f32 v237, v237, v226
  v_cvt_pk_bf16_f32 v199, v230, v231
  v_mfma_f32_32x32x16_bf16 v[176:191], a[140:143], a[44:47], v[176:191]
  ds_read_b64_tr_b16 a[180:181], v247 offset:53248
  v_exp_f32 v229, v229
  v_fma_f32 v230, v150, s28, -v233
  v_add_f32 v237, v237, v227
  v_fma_f32 v231, v151, s28, -v233
  v_mfma_f32_32x32x16_bf16 v[160:175], a[144:147], a[16:19], v[160:175]
  ds_read_b64_tr_b16 a[182:183], v247 offset:55296
  v_exp_f32 v230, v230
  v_add_f32 v237, v237, v228
  v_exp_f32 v231, v231
  v_mfma_f32_32x32x16_bf16 v[176:191], a[144:147], a[48:51], v[176:191]
  ds_read_b64_tr_b16 a[184:185], v248 offset:53248
  ds_read_b64_tr_b16 a[186:187], v248 offset:55296
  v_add_f32 v237, v237, v229
  v_cvt_pk_bf16_f32 v200, v224, v225
  v_fma_f32 v224, v152, s28, -v233
  v_add_f32 v237, v237, v230
  v_mfma_f32_32x32x16_bf16 v[160:175], a[148:151], a[20:23], v[160:175]
  ds_read_b64_tr_b16 a[188:189], v249 offset:53248
  v_exp_f32 v224, v224
  v_fma_f32 v225, v153, s28, -v233
  v_add_f32 v237, v237, v231
  v_cvt_pk_bf16_f32 v201, v226, v227
  v_mfma_f32_32x32x16_bf16 v[176:191], a[148:151], a[52:55], v[176:191]
  ds_read_b64_tr_b16 a[190:191], v249 offset:55296
  v_exp_f32 v225, v225
  v_fma_f32 v226, v154, s28, -v233
  v_add_f32 v237, v237, v224
  v_fma_f32 v227, v155, s28, -v233
  v_mfma_f32_32x32x16_bf16 v[160:175], a[152:155], a[24:27], v[160:175]
  v_exp_f32 v226, v226
  v_add_f32 v237, v237, v225
  v_exp_f32 v227, v227
  v_add_f32 v237, v237, v226
  v_mfma_f32_32x32x16_bf16 v[176:191], a[152:155], a[56:59], v[176:191]
  v_add_f32 v237, v237, v227
  v_cvt_pk_bf16_f32 v202, v228, v229
  v_fma_f32 v228, v156, s28, -v233
  v_cvt_pk_bf16_f32 v203, v230, v231
  v_fma_f32 v229, v157, s28, -v233
  v_cvt_pk_bf16_f32 v204, v224, v225
  v_mfma_f32_32x32x16_bf16 v[160:175], a[156:159], a[28:31], v[160:175]
  v_exp_f32 v228, v228
  v_fma_f32 v230, v158, s28, -v233
  v_exp_f32 v229, v229
  v_fma_f32 v231, v159, s28, -v233
  v_exp_f32 v230, v230
  v_add_f32 v237, v237, v228
  v_exp_f32 v231, v231
  v_add_f32 v237, v237, v229
  s_nop 0
  v_add_f32 v237, v237, v230
  s_nop 0
  v_add_f32 v237, v237, v231
  s_nop 0
  v_max_f32 v224, v236, v237
  v_cmp_lt_f32 vcc, s29, v224
  v_mfma_f32_32x32x16_bf16 v[176:191], a[156:159], a[60:63], v[176:191]
  v_cvt_pk_bf16_f32 v205, v226, v227
  v_cvt_pk_bf16_f32 v206, v228, v229
  v_cvt_pk_bf16_f32 v207, v230, v231
  s_cbranch_vccnz RARE_14
RET_14:
  s_waitcnt lgkmcnt(0)
  v_mfma_f32_32x32x16_bf16 v[0:15], a[160:163], v[192:195], v[0:15]
  s_add_u32 s22, s22, 0x4000
  s_add_u32 m0, s20, 98304
  v_add_f32 v234, v234, v236
  v_add_f32 v235, v235, v237
  v_mfma_f32_32x32x16_bf16 v[64:79], a[160:163], v[200:203], v[64:79]
  ds_read_b128 a[128:131], v238 offset:8192
  v_fma_f32 v224, v160, s28, -v232
  v_fma_f32 v225, v161, s28, -v232
  v_fma_f32 v226, v162, s28, -v232
  v_exp_f32 v224, v224
  v_mfma_f32_32x32x16_bf16 v[16:31], a[164:167], v[192:195], v[16:31]
  ds_read_b128 a[132:135], v239 offset:8192
  v_exp_f32 v225, v225
  v_fma_f32 v227, v163, s28, -v232
  v_exp_f32 v226, v226
  v_mfma_f32_32x32x16_bf16 v[80:95], a[164:167], v[200:203], v[80:95]
  ds_read_b128 a[136:139], v240 offset:8192
  v_exp_f32 v227, v227
  v_fma_f32 v228, v164, s28, -v232
  v_add_f32 v236, v224, v225
  v_fma_f32 v229, v165, s28, -v232
  v_mfma_f32_32x32x16_bf16 v[32:47], a[168:171], v[192:195], v[32:47]
  ds_read_b128 a[140:143], v241 offset:8192
  v_exp_f32 v228, v228
  v_fma_f32 v230, v166, s28, -v232
  v_exp_f32 v229, v229
  v_mfma_f32_32x32x16_bf16 v[96:111], a[168:171], v[200:203], v[96:111]
  ds_read_b128 a[144:147], v242 offset:8192
  v_exp_f32 v230, v230
  v_fma_f32 v231, v167, s28, -v232
  v_add_f32 v236, v236, v226
  v_cvt_pk_bf16_f32 v208, v224, v225
  v_mfma_f32_32x32x16_bf16 v[48:63], a[172:175], v[192:195], v[48:63]
  ds_read_b128 a[148:151], v243 offset:8192
  v_exp_f32 v231, v231
  v_fma_f32 v224, v168, s28, -v232
  v_add_f32 v236, v236, v227
  v_fma_f32 v225, v169, s28, -v232
  v_mfma_f32_32x32x16_bf16 v[112:127], a[172:175], v[200:203], v[112:127]
  ds_read_b128 a[152:155], v244 offset:8192
  v_exp_f32 v224, v224
  v_add_f32 v236, v236, v228
  v_exp_f32 v225, v225
  v_mfma_f32_32x32x16_bf16 v[0:15], a[176:179], v[196:199], v[0:15]
  ds_read_b128 a[156:159], v245 offset:8192
  v_add_f32 v236, v236, v229
  v_cvt_pk_bf16_f32 v209, v226, v227
  v_fma_f32 v226, v170, s28, -v232
  v_add_f32 v236, v236, v230
  v_fma_f32 v227, v171, s28, -v232
  v_mfma_f32_32x32x16_bf16 v[64:79], a[176:179], v[204:207], v[64:79]
  buffer_load_dwordx4 v254, s[12:15], s22 offen offset:0 nt lds
  v_exp_f32 v226, v226
  v_add_f32 v236, v236, v231
  v_exp_f32 v227, v227
  v_mfma_f32_32x32x16_bf16 v[16:31], a[180:183], v[196:199], v[16:31]
  buffer_load_dwordx4 v254, s[12:15], s22 offen offset:1024 nt lds
  v_add_f32 v236, v236, v224
  v_cvt_pk_bf16_f32 v210, v228, v229
  v_fma_f32 v228, v172, s28, -v232
  v_add_f32 v236, v236, v225
  v_fma_f32 v229, v173, s28, -v232
  v_mfma_f32_32x32x16_bf16 v[80:95], a[180:183], v[204:207], v[80:95]
  v_exp_f32 v228, v228
  v_add_f32 v236, v236, v226
  v_exp_f32 v229, v229
  v_add_f32 v236, v236, v227
  v_mfma_f32_32x32x16_bf16 v[32:47], a[184:187], v[196:199], v[32:47]
  buffer_load_dwordx4 v254, s[12:15], s22 offen offset:2048 nt lds
  v_add_f32 v236, v236, v228
  v_cvt_pk_bf16_f32 v211, v230, v231
  v_fma_f32 v230, v174, s28, -v232
  v_add_f32 v236, v236, v229
  v_fma_f32 v231, v175, s28, -v232
  v_mfma_f32_32x32x16_bf16 v[96:111], a[184:187], v[204:207], v[96:111]
  buffer_load_dwordx4 v254, s[12:15], s22 offen offset:3072 nt lds
  v_exp_f32 v230, v230
  v_cvt_pk_bf16_f32 v212, v224, v225
  v_exp_f32 v231, v231
  v_mfma_f32_32x32x16_bf16 v[48:63], a[188:191], v[196:199], v[48:63]
  v_fma_f32 v224, v176, s28, -v233
  v_add_f32 v236, v236, v230
  v_fma_f32 v225, v177, s28, -v233
  v_exp_f32 v224, v224
  v_add_f32 v236, v236, v231
  v_mfma_f32_32x32x16_bf16 v[112:127], a[188:191], v[204:207], v[112:127]
  v_exp_f32 v225, v225
  v_cvt_pk_bf16_f32 v213, v226, v227
  v_fma_f32 v226, v178, s28, -v233
  v_add_f32 v237, v224, v225
  s_waitcnt lgkmcnt(0)
  v_mfma_f32_32x32x16_bf16 v[128:143], a[128:131], a[64:67], 0
  ds_read_b64_tr_b16 a[160:161], v246 offset:57344
  ds_read_b64_tr_b16 a[162:163], v246 offset:59392
  v_exp_f32 v226, v226
  v_fma_f32 v227, v179, s28, -v233
  v_cvt_pk_bf16_f32 v214, v228, v229
  v_mfma_f32_32x32x16_bf16 v[144:159], a[128:131], a[96:99], 0
  ds_read_b64_tr_b16 a[164:165], v247 offset:57344
  v_exp_f32 v227, v227
  v_fma_f32 v228, v180, s28, -v233
  v_add_f32 v237, v237, v226
  v_fma_f32 v229, v181, s28, -v233
  v_mfma_f32_32x32x16_bf16 v[128:143], a[132:135], a[68:71], v[128:143]
  ds_read_b64_tr_b16 a[166:167], v247 offset:59392
  v_exp_f32 v228, v228
  v_add_f32 v237, v237, v227
  v_exp_f32 v229, v229
  v_mfma_f32_32x32x16_bf16 v[144:159], a[132:135], a[100:103], v[144:159]
  ds_read_b64_tr_b16 a[168:169], v248 offset:57344
  ds_read_b64_tr_b16 a[170:171], v248 offset:59392
  v_add_f32 v237, v237, v228
  v_cvt_pk_bf16_f32 v215, v230, v231
  v_fma_f32 v230, v182, s28, -v233
  v_add_f32 v237, v237, v229
  v_mfma_f32_32x32x16_bf16 v[128:143], a[136:139], a[72:75], v[128:143]
  ds_read_b64_tr_b16 a[172:173], v249 offset:57344
  v_exp_f32 v230, v230
  v_fma_f32 v231, v183, s28, -v233
  v_cvt_pk_bf16_f32 v216, v224, v225
  v_fma_f32 v224, v184, s28, -v233
  v_mfma_f32_32x32x16_bf16 v[144:159], a[136:139], a[104:107], v[144:159]
  ds_read_b64_tr_b16 a[174:175], v249 offset:59392
  v_exp_f32 v231, v231
  v_fma_f32 v225, v185, s28, -v233
  v_exp_f32 v224, v224
  v_mfma_f32_32x32x16_bf16 v[128:143], a[140:143], a[76:79], v[128:143]
  ds_read_b64_tr_b16 a[176:177], v246 offset:61440
  ds_read_b64_tr_b16 a[178:179], v246 offset:63488
  v_exp_f32 v225, v225
  v_add_f32 v237, v237, v230
  v_cvt_pk_bf16_f32 v217, v226, v227
  v_mfma_f32_32x32x16_bf16 v[144:159], a[140:143], a[108:111], v[144:159]
  ds_read_b64_tr_b16 a[180:181], v247 offset:61440
  v_fma_f32 v226, v186, s28, -v233
  v_add_f32 v237, v237, v231
  v_fma_f32 v227, v187, s28, -v233
  v_exp_f32 v226, v226
  v_mfma_f32_32x32x16_bf16 v[128:143], a[144:147], a[80:83], v[128:143]
  ds_read_b64_tr_b16 a[182:183], v247 offset:63488
  v_exp_f32 v227, v227
  v_add_f32 v237, v237, v224
  v_cvt_pk_bf16_f32 v218, v228, v229
  v_fma_f32 v228, v188, s28, -v233
  v_mfma_f32_32x32x16_bf16 v[144:159], a[144:147], a[112:115], v[144:159]
  ds_read_b64_tr_b16 a[184:185], v248 offset:61440
  ds_read_b64_tr_b16 a[186:187], v248 offset:63488
  v_exp_f32 v228, v228
  v_fma_f32 v229, v189, s28, -v233
  v_add_f32 v237, v237, v225
  v_mfma_f32_32x32x16_bf16 v[128:143], a[148:151], a[84:87], v[128:143]
  ds_read_b64_tr_b16 a[188:189], v249 offset:61440
  v_exp_f32 v229, v229
  v_add_f32 v237, v237, v226
  v_cvt_pk_bf16_f32 v219, v230, v231
  v_fma_f32 v230, v190, s28, -v233
  v_mfma_f32_32x32x16_bf16 v[144:159], a[148:151], a[116:119], v[144:159]
  ds_read_b64_tr_b16 a[190:191], v249 offset:63488
  v_exp_f32 v230, v230
  v_fma_f32 v231, v191, s28, -v233
  v_add_f32 v237, v237, v227
  v_cvt_pk_bf16_f32 v220, v224, v225
  v_mfma_f32_32x32x16_bf16 v[128:143], a[152:155], a[88:91], v[128:143]
  v_exp_f32 v231, v231
  v_add_f32 v237, v237, v228
  v_cvt_pk_bf16_f32 v221, v226, v227
  v_add_f32 v237, v237, v229
  v_cvt_pk_bf16_f32 v222, v228, v229
  v_mfma_f32_32x32x16_bf16 v[144:159], a[152:155], a[120:123], v[144:159]
  v_add_f32 v237, v237, v230
  v_cvt_pk_bf16_f32 v223, v230, v231
  v_add_f32 v237, v237, v231
  v_mfma_f32_32x32x16_bf16 v[128:143], a[156:159], a[92:95], v[128:143]
  v_max_f32 v224, v236, v237
  v_cmp_lt_f32 vcc, s29, v224
  v_mfma_f32_32x32x16_bf16 v[144:159], a[156:159], a[124:127], v[144:159]
  s_cbranch_vccnz RARE_15
RET_15:
  s_waitcnt vmcnt(20) lgkmcnt(0)
  v_mfma_f32_32x32x16_bf16 v[0:15], a[160:163], v[208:211], v[0:15]
  s_barrier
  v_mfma_f32_32x32x16_bf16 v[64:79], a[160:163], v[216:219], v[64:79]
  ds_read_b128 a[128:131], v238 offset:16384
  s_add_u32 s21, s21, 0x4000
  s_add_u32 m0, s20, 0
  s_nop 0
  v_max3_f32 v224, v128, v129, v130
  v_add_f32 v234, v234, v236
  v_add_f32 v235, v235, v237
  v_mfma_f32_32x32x16_bf16 v[16:31], a[164:167], v[208:211], v[16:31]
  ds_read_b128 a[132:135], v239 offset:16384
  v_max3_f32 v224, v224, v131, v132
  v_mov_b32 v160, v234
  v_max3_f32 v224, v224, v133, v134
  v_max3_f32 v225, v144, v145, v146
  v_max3_f32 v224, v224, v135, v136
  v_mfma_f32_32x32x16_bf16 v[80:95], a[164:167], v[216:219], v[80:95]
  ds_read_b128 a[136:139], v240 offset:16384
  v_max3_f32 v225, v225, v147, v148
  v_mov_b32 v161, v235
  v_max3_f32 v224, v224, v137, v138
  v_max3_f32 v225, v225, v149, v150
  v_max3_f32 v224, v224, v139, v140
  v_mfma_f32_32x32x16_bf16 v[32:47], a[168:171], v[208:211], v[32:47]
  ds_read_b128 a[140:143], v241 offset:16384
  v_max3_f32 v225, v225, v151, v152
  s_nop 1
  v_max3_f32 v224, v224, v141, v142
  v_max3_f32 v225, v225, v153, v154
  v_mfma_f32_32x32x16_bf16 v[96:111], a[168:171], v[216:219], v[96:111]
  ds_read_b128 a[144:147], v242 offset:16384
  v_max_f32 v224, v224, v143
  v_max3_f32 v225, v225, v155, v156
  v_mov_b32 v226, v224
  v_max3_f32 v225, v225, v157, v158
  v_max_f32 v225, v225, v159
  v_mfma_f32_32x32x16_bf16 v[48:63], a[172:175], v[208:211], v[48:63]
  ds_read_b128 a[148:151], v243 offset:16384
  v_mov_b32 v227, v225
  v_permlane32_swap_b32 v234, v160
  v_permlane32_swap_b32 v224, v226
  s_nop 0
  v_permlane32_swap_b32 v225, v227
  v_mfma_f32_32x32x16_bf16 v[112:127], a[172:175], v[216:219], v[112:127]
  ds_read_b128 a[152:155], v244 offset:16384
  v_max_f32 v224, v224, v226
  v_permlane32_swap_b32 v235, v161
  v_max_f32 v225, v225, v227
  v_mul_f32 v232, s28, v224
  v_mul_f32 v233, s28, v225
  v_mfma_f32_32x32x16_bf16 v[0:15], a[176:179], v[212:215], v[0:15]
  ds_read_b128 a[156:159], v245 offset:16384
  v_fma_f32 v224, v128, s28, -v232
  v_add_f32 v234, v234, v160
  v_fma_f32 v225, v129, s28, -v232
  v_exp_f32 v224, v224
  v_mfma_f32_32x32x16_bf16 v[64:79], a[176:179], v[220:223], v[64:79]
  buffer_load_dwordx4 v250, s[8:11], s21 offen offset:0 nt lds
  v_exp_f32 v225, v225
  v_fma_f32 v226, v130, s28, -v232
  v_fma_f32 v227, v131, s28, -v232
  v_add_f32 v236, v224, v225
  v_mfma_f32_32x32x16_bf16 v[16:31], a[180:183], v[212:215], v[16:31]
  buffer_load_dwordx4 v251, s[8:11], s21 offen offset:1024 nt lds
  v_exp_f32 v226, v226
  v_fma_f32 v228, v132, s28, -v232
  v_cvt_pk_bf16_f32 v192, v224, v225
  v_add_f32 v235, v235, v161
  v_mfma_f32_32x32x16_bf16 v[80:95], a[180:183], v[220:223], v[80:95]
  v_exp_f32 v227, v227
  v_fma_f32 v229, v133, s28, -v232
  v_add_f32 v236, v236, v226
  v_rcp_f32 v234, v234
  v_mfma_f32_32x32x16_bf16 v[32:47], a[184:187], v[212:215], v[32:47]
  buffer_load_dwordx4 v252, s[8:11], s21 offen offset:2048 nt lds
  v_exp_f32 v228, v228
  v_fma_f32 v230, v134, s28, -v232
  v_rcp_f32 v235, v235
  v_mfma_f32_32x32x16_bf16 v[96:111], a[184:187], v[220:223], v[96:111]
  buffer_load_dwordx4 v253, s[8:11], s21 offen offset:3072 nt lds
  v_exp_f32 v229, v229
  v_fma_f32 v231, v135, s28, -v232
  v_exp_f32 v230, v230
  v_mfma_f32_32x32x16_bf16 v[48:63], a[188:191], v[212:215], v[48:63]
  v_exp_f32 v231, v231
  v_fma_f32 v224, v136, s28, -v232
  v_add_f32 v236, v236, v227
  v_fma_f32 v225, v137, s28, -v232
  v_add_f32 v236, v236, v228
  v_mfma_f32_32x32x16_bf16 v[112:127], a[188:191], v[220:223], v[112:127]
  v_exp_f32 v224, v224
  v_add_f32 v236, v236, v229
  v_exp_f32 v225, v225
  s_waitcnt lgkmcnt(0)
  s_branch LOOP
RARE_1:
  s_nop 7
  s_nop 7
  v_max3_f32 v224, v160, v161, v162
  v_max3_f32 v224, v224, v163, v164
  v_max3_f32 v224, v224, v165, v166
  v_max3_f32 v224, v224, v167, v168
  v_max3_f32 v224, v224, v169, v170
  v_max3_f32 v224, v224, v171, v172
  v_max3_f32 v224, v224, v173, v174
  v_max_f32 v224, v224, v175
  v_mov_b32 v225, v224
  s_nop 1
  v_permlane32_swap_b32 v224, v225
  v_max_f32 v224, v224, v225
  v_mul_f32 v224, s28, v224
  v_max_f32 v224, v224, v232
  v_sub_f32 v226, v232, v224
  v_exp_f32 v226, v226
  v_mov_b32 v232, v224
  s_nop 0
  v_mul_f32 v234, v234, v226
  v_mul_f32 v0, v0, v226
  v_mul_f32 v1, v1, v226
  v_mul_f32 v2, v2, v226
  v_mul_f32 v3, v3, v226
  v_mul_f32 v4, v4, v226
  v_mul_f32 v5, v5, v226
  v_mul_f32 v6, v6, v226
  v_mul_f32 v7, v7, v226
  v_mul_f32 v8, v8, v226
  v_mul_f32 v9, v9, v226
  v_mul_f32 v10, v10, v226
  v_mul_f32 v11, v11, v226
  v_mul_f32 v12, v12, v226
  v_mul_f32 v13, v13, v226
  v_mul_f32 v14, v14, v226
  v_mul_f32 v15, v15, v226
  v_mul_f32 v16, v16, v226
  v_mul_f32 v17, v17, v226
  v_mul_f32 v18, v18, v226
  v_mul_f32 v19, v19, v226
  v_mul_f32 v20, v20, v226
  v_mul_f32 v21, v21, v226
  v_mul_f32 v22, v22, v226
  v_mul_f32 v23, v23, v226
  v_mul_f32 v24, v24, v226
  v_mul_f32 v25, v25, v226
  v_mul_f32 v26, v26, v226
  v_mul_f32 v27, v27, v226
  v_mul_f32 v28, v28, v226
  v_mul_f32 v29, v29, v226
  v_mul_f32 v30, v30, v226
  v_mul_f32 v31, v31, v226
  v_mul_f32 v32, v32, v226
  v_mul_f32 v33, v33, v226
  v_mul_f32 v34, v34, v226
  v_mul_f32 v35, v35, v226
  v_mul_f32 v36, v36, v226
  v_mul_f32 v37, v37, v226
  v_mul_f32 v38, v38, v226
  v_mul_f32 v39, v39, v226
  v_mul_f32 v40, v40, v226
  v_mul_f32 v41, v41, v226
  v_mul_f32 v42, v42, v226
  v_mul_f32 v43, v43, v226
  v_mul_f32 v44, v44, v226
  v_mul_f32 v45, v45, v226
  v_mul_f32 v46, v46, v226
  v_mul_f32 v47, v47, v226
  v_mul_f32 v48, v48, v226
  v_mul_f32 v49, v49, v226
  v_mul_f32 v50, v50, v226
  v_mul_f32 v51, v51, v226
  v_mul_f32 v52, v52, v226
  v_mul_f32 v53, v53, v226
  v_mul_f32 v54, v54, v226
  v_mul_f32 v55, v55, v226
  v_mul_f32 v56, v56, v226
  v_mul_f32 v57, v57, v226
  v_mul_f32 v58, v58, v226
  v_mul_f32 v59, v59, v226
  v_mul_f32 v60, v60, v226
  v_mul_f32 v61, v61, v226
  v_mul_f32 v62, v62, v226
  v_mul_f32 v63, v63, v226
  v_fma_f32 v224, v160, s28, -v232
  v_fma_f32 v225, v161, s28, -v232
  v_exp_f32 v224, v224
  v_exp_f32 v225, v225
  s_nop 0
  v_add_f32 v236, v224, v225
  v_cvt_pk_bf16_f32 v208, v224, v225
  v_fma_f32 v226, v162, s28, -v232
  v_fma_f32 v227, v163, s28, -v232
  v_exp_f32 v226, v226
  v_exp_f32 v227, v227
  s_nop 0
  v_add_f32 v236, v236, v226
  v_add_f32 v236, v236, v227
  v_cvt_pk_bf16_f32 v209, v226, v227
  v_fma_f32 v228, v164, s28, -v232
  v_fma_f32 v229, v165, s28, -v232
  v_exp_f32 v228, v228
  v_exp_f32 v229, v229
  s_nop 0
  v_add_f32 v236, v236, v228
  v_add_f32 v236, v236, v229
  v_cvt_pk_bf16_f32 v210, v228, v229
  v_fma_f32 v230, v166, s28, -v232
  v_fma_f32 v231, v167, s28, -v232
  v_exp_f32 v230, v230
  v_exp_f32 v231, v231
  s_nop 0
  v_add_f32 v236, v236, v230
  v_add_f32 v236, v236, v231
  v_cvt_pk_bf16_f32 v211, v230, v231
  v_fma_f32 v224, v168, s28, -v232
  v_fma_f32 v225, v169, s28, -v232
  v_exp_f32 v224, v224
  v_exp_f32 v225, v225
  s_nop 0
  v_add_f32 v236, v236, v224
  v_add_f32 v236, v236, v225
  v_cvt_pk_bf16_f32 v212, v224, v225
  v_fma_f32 v226, v170, s28, -v232
  v_fma_f32 v227, v171, s28, -v232
  v_exp_f32 v226, v226
  v_exp_f32 v227, v227
  s_nop 0
  v_add_f32 v236, v236, v226
  v_add_f32 v236, v236, v227
  v_cvt_pk_bf16_f32 v213, v226, v227
  v_fma_f32 v228, v172, s28, -v232
  v_fma_f32 v229, v173, s28, -v232
  v_exp_f32 v228, v228
  v_exp_f32 v229, v229
  s_nop 0
  v_add_f32 v236, v236, v228
  v_add_f32 v236, v236, v229
  v_cvt_pk_bf16_f32 v214, v228, v229
  v_fma_f32 v230, v174, s28, -v232
  v_fma_f32 v231, v175, s28, -v232
  v_exp_f32 v230, v230
  v_exp_f32 v231, v231
  s_nop 0
  v_add_f32 v236, v236, v230
  v_add_f32 v236, v236, v231
  v_cvt_pk_bf16_f32 v215, v230, v231
  v_max3_f32 v224, v176, v177, v178
  v_max3_f32 v224, v224, v179, v180
  v_max3_f32 v224, v224, v181, v182
  v_max3_f32 v224, v224, v183, v184
  v_max3_f32 v224, v224, v185, v186
  v_max3_f32 v224, v224, v187, v188
  v_max3_f32 v224, v224, v189, v190
  v_max_f32 v224, v224, v191
  v_mov_b32 v225, v224
  s_nop 1
  v_permlane32_swap_b32 v224, v225
  v_max_f32 v224, v224, v225
  v_mul_f32 v224, s28, v224
  v_max_f32 v224, v224, v233
  v_sub_f32 v226, v233, v224
  v_exp_f32 v226, v226
  v_mov_b32 v233, v224
  s_nop 0
  v_mul_f32 v235, v235, v226
  v_mul_f32 v64, v64, v226
  v_mul_f32 v65, v65, v226
  v_mul_f32 v66, v66, v226
  v_mul_f32 v67, v67, v226
  v_mul_f32 v68, v68, v226
  v_mul_f32 v69, v69, v226
  v_mul_f32 v70, v70, v226
  v_mul_f32 v71, v71, v226
  v_mul_f32 v72, v72, v226
  v_mul_f32 v73, v73, v226
  v_mul_f32 v74, v74, v226
  v_mul_f32 v75, v75, v226
  v_mul_f32 v76, v76, v226
  v_mul_f32 v77, v77, v226
  v_mul_f32 v78, v78, v226
  v_mul_f32 v79, v79, v226
  v_mul_f32 v80, v80, v226
  v_mul_f32 v81, v81, v226
  v_mul_f32 v82, v82, v226
  v_mul_f32 v83, v83, v226
  v_mul_f32 v84, v84, v226
  v_mul_f32 v85, v85, v226
  v_mul_f32 v86, v86, v226
  v_mul_f32 v87, v87, v226
  v_mul_f32 v88, v88, v226
  v_mul_f32 v89, v89, v226
  v_mul_f32 v90, v90, v226
  v_mul_f32 v91, v91, v226
  v_mul_f32 v92, v92, v226
  v_mul_f32 v93, v93, v226
  v_mul_f32 v94, v94, v226
  v_mul_f32 v95, v95, v226
  v_mul_f32 v96, v96, v226
  v_mul_f32 v97, v97, v226
  v_mul_f32 v98, v98, v226
  v_mul_f32 v99, v99, v226
  v_mul_f32 v100, v100, v226
  v_mul_f32 v101, v101, v226
  v_mul_f32 v102, v102, v226
  v_mul_f32 v103, v103, v226
  v_mul_f32 v104, v104, v226
  v_mul_f32 v105, v105, v226
  v_mul_f32 v106, v106, v226
  v_mul_f32 v107, v107, v226
  v_mul_f32 v108, v108, v226
  v_mul_f32 v109, v109, v226
  v_mul_f32 v110, v110, v226
  v_mul_f32 v111, v111, v226
  v_mul_f32 v112, v112, v226
  v_mul_f32 v113, v113, v226
  v_mul_f32 v114, v114, v226
  v_mul_f32 v115, v115, v226
  v_mul_f32 v116, v116, v226
  v_mul_f32 v117, v117, v226
  v_mul_f32 v118, v118, v226
  v_mul_f32 v119, v119, v226
  v_mul_f32 v120, v120, v226
  v_mul_f32 v121, v121, v226
  v_mul_f32 v122, v122, v226
  v_mul_f32 v123, v123, v226
  v_mul_f32 v124, v124, v226
  v_mul_f32 v125, v125, v226
  v_mul_f32 v126, v126, v226
  v_mul_f32 v127, v127, v226
  v_fma_f32 v224, v176, s28, -v233
  v_fma_f32 v225, v177, s28, -v233
  v_exp_f32 v224, v224
  v_exp_f32 v225, v225
  s_nop 0
  v_add_f32 v237, v224, v225
  v_cvt_pk_bf16_f32 v216, v224, v225
  v_fma_f32 v226, v178, s28, -v233
  v_fma_f32 v227, v179, s28, -v233
  v_exp_f32 v226, v226
  v_exp_f32 v227, v227
  s_nop 0
  v_add_f32 v237, v237, v226
  v_add_f32 v237, v237, v227
  v_cvt_pk_bf16_f32 v217, v226, v227
  v_fma_f32 v228, v180, s28, -v233
  v_fma_f32 v229, v181, s28, -v233
  v_exp_f32 v228, v228
  v_exp_f32 v229, v229
  s_nop 0
  v_add_f32 v237, v237, v228
  v_add_f32 v237, v237, v229
  v_cvt_pk_bf16_f32 v218, v228, v229
  v_fma_f32 v230, v182, s28, -v233
  v_fma_f32 v231, v183, s28, -v233
  v_exp_f32 v230, v230
  v_exp_f32 v231, v231
  s_nop 0
  v_add_f32 v237, v237, v230
  v_add_f32 v237, v237, v231
  v_cvt_pk_bf16_f32 v219, v230, v231
  v_fma_f32 v224, v184, s28, -v233
  v_fma_f32 v225, v185, s28, -v233
  v_exp_f32 v224, v224
  v_exp_f32 v225, v225
  s_nop 0
  v_add_f32 v237, v237, v224
  v_add_f32 v237, v237, v225
  v_cvt_pk_bf16_f32 v220, v224, v225
  v_fma_f32 v226, v186, s28, -v233
  v_fma_f32 v227, v187, s28, -v233
  v_exp_f32 v226, v226
  v_exp_f32 v227, v227
  s_nop 0
  v_add_f32 v237, v237, v226
  v_add_f32 v237, v237, v227
  v_cvt_pk_bf16_f32 v221, v226, v227
  v_fma_f32 v228, v188, s28, -v233
  v_fma_f32 v229, v189, s28, -v233
  v_exp_f32 v228, v228
  v_exp_f32 v229, v229
  s_nop 0
  v_add_f32 v237, v237, v228
  v_add_f32 v237, v237, v229
  v_cvt_pk_bf16_f32 v222, v228, v229
  v_fma_f32 v230, v190, s28, -v233
  v_fma_f32 v231, v191, s28, -v233
  v_exp_f32 v230, v230
  v_exp_f32 v231, v231
  s_nop 0
  v_add_f32 v237, v237, v230
  v_add_f32 v237, v237, v231
  v_cvt_pk_bf16_f32 v223, v230, v231
  s_nop 1
  s_branch RET_1
RARE_2:
  s_nop 7
  s_nop 7
  v_max3_f32 v224, v128, v129, v130
  v_max3_f32 v224, v224, v131, v132
  v_max3_f32 v224, v224, v133, v134
  v_max3_f32 v224, v224, v135, v136
  v_max3_f32 v224, v224, v137, v138
  v_max3_f32 v224, v224, v139, v140
  v_max3_f32 v224, v224, v141, v142
  v_max_f32 v224, v224, v143
  v_mov_b32 v225, v224
  s_nop 1
  v_permlane32_swap_b32 v224, v225
  v_max_f32 v224, v224, v225
  v_mul_f32 v224, s28, v224
  v_max_f32 v224, v224, v232
  v_sub_f32 v226, v232, v224
  v_exp_f32 v226, v226
  v_mov_b32 v232, v224
  s_nop 0
  v_mul_f32 v234, v234, v226
  v_mul_f32 v0, v0, v226
  v_mul_f32 v1, v1, v226
  v_mul_f32 v2, v2, v226
  v_mul_f32 v3, v3, v226
  v_mul_f32 v4, v4, v226
  v_mul_f32 v5, v5, v226
  v_mul_f32 v6, v6, v226
  v_mul_f32 v7, v7, v226
  v_mul_f32 v8, v8, v226
  v_mul_f32 v9, v9, v226
  v_mul_f32 v10, v10, v226
  v_mul_f32 v11, v11, v226
  v_mul_f32 v12, v12, v226
  v_mul_f32 v13, v13, v226
  v_mul_f32 v14, v14, v226
  v_mul_f32 v15, v15, v226
  v_mul_f32 v16, v16, v226
  v_mul_f32 v17, v17, v226
  v_mul_f32 v18, v18, v226
  v_mul_f32 v19, v19, v226
  v_mul_f32 v20, v20, v226
  v_mul_f32 v21, v21, v226
  v_mul_f32 v22, v22, v226
  v_mul_f32 v23, v23, v226
  v_mul_f32 v24, v24, v226
  v_mul_f32 v25, v25, v226
  v_mul_f32 v26, v26, v226
  v_mul_f32 v27, v27, v226
  v_mul_f32 v28, v28, v226
  v_mul_f32 v29, v29, v226
  v_mul_f32 v30, v30, v226
  v_mul_f32 v31, v31, v226
  v_mul_f32 v32, v32, v226
  v_mul_f32 v33, v33, v226
  v_mul_f32 v34, v34, v226
  v_mul_f32 v35, v35, v226
  v_mul_f32 v36, v36, v226
  v_mul_f32 v37, v37, v226
  v_mul_f32 v38, v38, v226
  v_mul_f32 v39, v39, v226
  v_mul_f32 v40, v40, v226
  v_mul_f32 v41, v41, v226
  v_mul_f32 v42, v42, v226
  v_mul_f32 v43, v43, v226
  v_mul_f32 v44, v44, v226
  v_mul_f32 v45, v45, v226
  v_mul_f32 v46, v46, v226
  v_mul_f32 v47, v47, v226
  v_mul_f32 v48, v48, v226
  v_mul_f32 v49, v49, v226
  v_mul_f32 v50, v50, v226
  v_mul_f32 v51, v51, v226
  v_mul_f32 v52, v52, v226
  v_mul_f32 v53, v53, v226
  v_mul_f32 v54, v54, v226
  v_mul_f32 v55, v55, v226
  v_mul_f32 v56, v56, v226
  v_mul_f32 v57, v57, v226
  v_mul_f32 v58, v58, v226
  v_mul_f32 v59, v59, v226
  v_mul_f32 v60, v60, v226
  v_mul_f32 v61, v61, v226
  v_mul_f32 v62, v62, v226
  v_mul_f32 v63, v63, v226
  v_fma_f32 v224, v128, s28, -v232
  v_fma_f32 v225, v129, s28, -v232
  v_exp_f32 v224, v224
  v_exp_f32 v225, v225
  s_nop 0
  v_add_f32 v236, v224, v225
  v_cvt_pk_bf16_f32 v192, v224, v225
  v_fma_f32 v226, v130, s28, -v232
  v_fma_f32 v227, v131, s28, -v232
  v_exp_f32 v226, v226
  v_exp_f32 v227, v227
  s_nop 0
  v_add_f32 v236, v236, v226
  v_add_f32 v236, v236, v227
  v_cvt_pk_bf16_f32 v193, v226, v227
  v_fma_f32 v228, v132, s28, -v232
  v_fma_f32 v229, v133, s28, -v232
  v_exp_f32 v228, v228
  v_exp_f32 v229, v229
  s_nop 0
  v_add_f32 v236, v236, v228
  v_add_f32 v236, v236, v229
  v_cvt_pk_bf16_f32 v194, v228, v229
  v_fma_f32 v230, v134, s28, -v232
  v_fma_f32 v231, v135, s28, -v232
  v_exp_f32 v230, v230
  v_exp_f32 v231, v231
  s_nop 0
  v_add_f32 v236, v236, v230
  v_add_f32 v236, v236, v231
  v_cvt_pk_bf16_f32 v195, v230, v231
  v_fma_f32 v224, v136, s28, -v232
  v_fma_f32 v225, v137, s28, -v232
  v_exp_f32 v224, v224
  v_exp_f32 v225, v225
  s_nop 0
  v_add_f32 v236, v236, v224
  v_add_f32 v236, v236, v225
  v_cvt_pk_bf16_f32 v196, v224, v225
  v_fma_f32 v226, v138, s28, -v232
  v_fma_f32 v227, v139, s28, -v232
  v_exp_f32 v226, v226
  v_exp_f32 v227, v227
  s_nop 0
  v_add_f32 v236, v236, v226
  v_add_f32 v236, v236, v227
  v_cvt_pk_bf16_f32 v197, v226, v227
  v_fma_f32 v228, v140, s28, -v232
  v_fma_f32 v229, v141, s28, -v232
  v_exp_f32 v228, v228
  v_exp_f32 v229, v229
  s_nop 0
  v_add_f32 v236, v236, v228
  v_add_f32 v236, v236, v229
  v_cvt_pk_bf16_f32 v198, v228, v229
  v_fma_f32 v230, v142, s28, -v232
  v_fma_f32 v231, v143, s28, -v232
  v_exp_f32 v230, v230
  v_exp_f32 v231, v231
  s_nop 0
  v_add_f32 v236, v236, v230
  v_add_f32 v236, v236, v231
  v_cvt_pk_bf16_f32 v199, v230, v231
  v_max3_f32 v224, v144, v145, v146
  v_max3_f32 v224, v224, v147, v148
  v_max3_f32 v224, v224, v149, v150
  v_max3_f32 v224, v224, v151, v152
  v_max3_f32 v224, v224, v153, v154
  v_max3_f32 v224, v224, v155, v156
  v_max3_f32 v224, v224, v157, v158
  v_max_f32 v224, v224, v159
  v_mov_b32 v225, v224
  s_nop 1
  v_permlane32_swap_b32 v224, v225
  v_max_f32 v224, v224, v225
  v_mul_f32 v224, s28, v224
  v_max_f32 v224, v224, v233
  v_sub_f32 v226, v233, v224
  v_exp_f32 v226, v226
  v_mov_b32 v233, v224
  s_nop 0
  v_mul_f32 v235, v235, v226
  v_mul_f32 v64, v64, v226
  v_mul_f32 v65, v65, v226
  v_mul_f32 v66, v66, v226
  v_mul_f32 v67, v67, v226
  v_mul_f32 v68, v68, v226
  v_mul_f32 v69, v69, v226
  v_mul_f32 v70, v70, v226
  v_mul_f32 v71, v71, v226
  v_mul_f32 v72, v72, v226
  v_mul_f32 v73, v73, v226
  v_mul_f32 v74, v74, v226
  v_mul_f32 v75, v75, v226
  v_mul_f32 v76, v76, v226
  v_mul_f32 v77, v77, v226
  v_mul_f32 v78, v78, v226
  v_mul_f32 v79, v79, v226
  v_mul_f32 v80, v80, v226
  v_mul_f32 v81, v81, v226
  v_mul_f32 v82, v82, v226
  v_mul_f32 v83, v83, v226
  v_mul_f32 v84, v84, v226
  v_mul_f32 v85, v85, v226
  v_mul_f32 v86, v86, v226
  v_mul_f32 v87, v87, v226
  v_mul_f32 v88, v88, v226
  v_mul_f32 v89, v89, v226
  v_mul_f32 v90, v90, v226
  v_mul_f32 v91, v91, v226
  v_mul_f32 v92, v92, v226
  v_mul_f32 v93, v93, v226
  v_mul_f32 v94, v94, v226
  v_mul_f32 v95, v95, v226
  v_mul_f32 v96, v96, v226
  v_mul_f32 v97, v97, v226
  v_mul_f32 v98, v98, v226
  v_mul_f32 v99, v99, v226
  v_mul_f32 v100, v100, v226
  v_mul_f32 v101, v101, v226
  v_mul_f32 v102, v102, v226
  v_mul_f32 v103, v103, v226
  v_mul_f32 v104, v104, v226
  v_mul_f32 v105, v105, v226
  v_mul_f32 v106, v106, v226
  v_mul_f32 v107, v107, v226
  v_mul_f32 v108, v108, v226
  v_mul_f32 v109, v109, v226
  v_mul_f32 v110, v110, v226
  v_mul_f32 v111, v111, v226
  v_mul_f32 v112, v112, v226
  v_mul_f32 v113, v113, v226
  v_mul_f32 v114, v114, v226
  v_mul_f32 v115, v115, v226
  v_mul_f32 v116, v116, v226
  v_mul_f32 v117, v117, v226
  v_mul_f32 v118, v118, v226
  v_mul_f32 v119, v119, v226
  v_mul_f32 v120, v120, v226
  v_mul_f32 v121, v121, v226
  v_mul_f32 v122, v122, v226
  v_mul_f32 v123, v123, v226
  v_mul_f32 v124, v124, v226
  v_mul_f32 v125, v125, v226
  v_mul_f32 v126, v126, v226
  v_mul_f32 v127, v127, v226
  v_fma_f32 v224, v144, s28, -v233
  v_fma_f32 v225, v145, s28, -v233
  v_exp_f32 v224, v224
  v_exp_f32 v225, v225
  s_nop 0
  v_add_f32 v237, v224, v225
  v_cvt_pk_bf16_f32 v200, v224, v225
  v_fma_f32 v226, v146, s28, -v233
  v_fma_f32 v227, v147, s28, -v233
  v_exp_f32 v226, v226
  v_exp_f32 v227, v227
  s_nop 0
  v_add_f32 v237, v237, v226
  v_add_f32 v237, v237, v227
  v_cvt_pk_bf16_f32 v201, v226, v227
  v_fma_f32 v228, v148, s28, -v233
  v_fma_f32 v229, v149, s28, -v233
  v_exp_f32 v228, v228
  v_exp_f32 v229, v229
  s_nop 0
  v_add_f32 v237, v237, v228
  v_add_f32 v237, v237, v229
  v_cvt_pk_bf16_f32 v202, v228, v229
  v_fma_f32 v230, v150, s28, -v233
  v_fma_f32 v231, v151, s28, -v233
  v_exp_f32 v230, v230
  v_exp_f32 v231, v231
  s_nop 0
  v_add_f32 v237, v237, v230
  v_add_f32 v237, v237, v231
  v_cvt_pk_bf16_f32 v203, v230, v231
  v_fma_f32 v224, v152, s28, -v233
  v_fma_f32 v225, v153, s28, -v233
  v_exp_f32 v224, v224
  v_exp_f32 v225, v225
  s_nop 0
  v_add_f32 v237, v237, v224
  v_add_f32 v237, v237, v225
  v_cvt_pk_bf16_f32 v204, v224, v225
  v_fma_f32 v226, v154, s28, -v233
  v_fma_f32 v227, v155, s28, -v233
  v_exp_f32 v226, v226
  v_exp_f32 v227, v227
  s_nop 0
  v_add_f32 v237, v237, v226
  v_add_f32 v237, v237, v227
  v_cvt_pk_bf16_f32 v205, v226, v227
  v_fma_f32 v228, v156, s28, -v233
  v_fma_f32 v229, v157, s28, -v233
  v_exp_f32 v228, v228
  v_exp_f32 v229, v229
  s_nop 0
  v_add_f32 v237, v237, v228
  v_add_f32 v237, v237, v229
  v_cvt_pk_bf16_f32 v206, v228, v229
  v_fma_f32 v230, v158, s28, -v233
  v_fma_f32 v231, v159, s28, -v233
  v_exp_f32 v230, v230
  v_exp_f32 v231, v231
  s_nop 0
  v_add_f32 v237, v237, v230
  v_add_f32 v237, v237, v231
  v_cvt_pk_bf16_f32 v207, v230, v231
  s_nop 1
  s_branch RET_2
RARE_3:
  s_nop 7
  s_nop 7
  v_max3_f32 v224, v160, v161, v162
  v_max3_f32 v224, v224, v163, v164
  v_max3_f32 v224, v224, v165, v166
  v_max3_f32 v224, v224, v167, v168
  v_max3_f32 v224, v224, v169, v170
  v_max3_f32 v224, v224, v171, v172
  v_max3_f32 v224, v224, v173, v174
  v_max_f32 v224, v224, v175
  v_mov_b32 v225, v224
  s_nop 1
  v_permlane32_swap_b32 v224, v225
  v_max_f32 v224, v224, v225
  v_mul_f32 v224, s28, v224
  v_max_f32 v224, v224, v232
  v_sub_f32 v226, v232, v224
  v_exp_f32 v226, v226
  v_mov_b32 v232, v224
  s_nop 0
  v_mul_f32 v234, v234, v226
  v_mul_f32 v0, v0, v226
  v_mul_f32 v1, v1, v226
  v_mul_f32 v2, v2, v226
  v_mul_f32 v3, v3, v226
  v_mul_f32 v4, v4, v226
  v_mul_f32 v5, v5, v226
  v_mul_f32 v6, v6, v226
  v_mul_f32 v7, v7, v226
  v_mul_f32 v8, v8, v226
  v_mul_f32 v9, v9, v226
  v_mul_f32 v10, v10, v226
  v_mul_f32 v11, v11, v226
  v_mul_f32 v12, v12, v226
  v_mul_f32 v13, v13, v226
  v_mul_f32 v14, v14, v226
  v_mul_f32 v15, v15, v226
  v_mul_f32 v16, v16, v226
  v_mul_f32 v17, v17, v226
  v_mul_f32 v18, v18, v226
  v_mul_f32 v19, v19, v226
  v_mul_f32 v20, v20, v226
  v_mul_f32 v21, v21, v226
  v_mul_f32 v22, v22, v226
  v_mul_f32 v23, v23, v226
  v_mul_f32 v24, v24, v226
  v_mul_f32 v25, v25, v226
  v_mul_f32 v26, v26, v226
  v_mul_f32 v27, v27, v226
  v_mul_f32 v28, v28, v226
  v_mul_f32 v29, v29, v226
  v_mul_f32 v30, v30, v226
  v_mul_f32 v31, v31, v226
  v_mul_f32 v32, v32, v226
  v_mul_f32 v33, v33, v226
  v_mul_f32 v34, v34, v226
  v_mul_f32 v35, v35, v226
  v_mul_f32 v36, v36, v226
  v_mul_f32 v37, v37, v226
  v_mul_f32 v38, v38, v226
  v_mul_f32 v39, v39, v226
  v_mul_f32 v40, v40, v226
  v_mul_f32 v41, v41, v226
  v_mul_f32 v42, v42, v226
  v_mul_f32 v43, v43, v226
  v_mul_f32 v44, v44, v226
  v_mul_f32 v45, v45, v226
  v_mul_f32 v46, v46, v226
  v_mul_f32 v47, v47, v226
  v_mul_f32 v48, v48, v226
  v_mul_f32 v49, v49, v226
  v_mul_f32 v50, v50, v226
  v_mul_f32 v51, v51, v226
  v_mul_f32 v52, v52, v226
  v_mul_f32 v53, v53, v226
  v_mul_f32 v54, v54, v226
  v_mul_f32 v55, v55, v226
  v_mul_f32 v56, v56, v226
  v_mul_f32 v57, v57, v226
  v_mul_f32 v58, v58, v226
  v_mul_f32 v59, v59, v226
  v_mul_f32 v60, v60, v226
  v_mul_f32 v61, v61, v226
  v_mul_f32 v62, v62, v226
  v_mul_f32 v63, v63, v226
  v_fma_f32 v224, v160, s28, -v232
  v_fma_f32 v225, v161, s28, -v232
  v_exp_f32 v224, v224
  v_exp_f32 v225, v225
  s_nop 0
  v_add_f32 v236, v224, v225
  v_cvt_pk_bf16_f32 v208, v224, v225
  v_fma_f32 v226, v162, s28, -v232
  v_fma_f32 v227, v163, s28, -v232
  v_exp_f32 v226, v226
  v_exp_f32 v227, v227
  s_nop 0
  v_add_f32 v236, v236, v226
  v_add_f32 v236, v236, v227
  v_cvt_pk_bf16_f32 v209, v226, v227
  v_fma_f32 v228, v164, s28, -v232
  v_fma_f32 v229, v165, s28, -v232
  v_exp_f32 v228, v228
  v_exp_f32 v229, v229
  s_nop 0
  v_add_f32 v236, v236, v228
  v_add_f32 v236, v236, v229
  v_cvt_pk_bf16_f32 v210, v228, v229
  v_fma_f32 v230, v166, s28, -v232
  v_fma_f32 v231, v167, s28, -v232
  v_exp_f32 v230, v230
  v_exp_f32 v231, v231
  s_nop 0
  v_add_f32 v236, v236, v230
  v_add_f32 v236, v236, v231
  v_cvt_pk_bf16_f32 v211, v230, v231
  v_fma_f32 v224, v168, s28, -v232
  v_fma_f32 v225, v169, s28, -v232
  v_exp_f32 v224, v224
  v_exp_f32 v225, v225
  s_nop 0
  v_add_f32 v236, v236, v224
  v_add_f32 v236, v236, v225
  v_cvt_pk_bf16_f32 v212, v224, v225
  v_fma_f32 v226, v170, s28, -v232
  v_fma_f32 v227, v171, s28, -v232
  v_exp_f32 v226, v226
  v_exp_f32 v227, v227
  s_nop 0
  v_add_f32 v236, v236, v226
  v_add_f32 v236, v236, v227
  v_cvt_pk_bf16_f32 v213, v226, v227
  v_fma_f32 v228, v172, s28, -v232
  v_fma_f32 v229, v173, s28, -v232
  v_exp_f32 v228, v228
  v_exp_f32 v229, v229
  s_nop 0
  v_add_f32 v236, v236, v228
  v_add_f32 v236, v236, v229
  v_cvt_pk_bf16_f32 v214, v228, v229
  v_fma_f32 v230, v174, s28, -v232
  v_fma_f32 v231, v175, s28, -v232
  v_exp_f32 v230, v230
  v_exp_f32 v231, v231
  s_nop 0
  v_add_f32 v236, v236, v230
  v_add_f32 v236, v236, v231
  v_cvt_pk_bf16_f32 v215, v230, v231
  v_max3_f32 v224, v176, v177, v178
  v_max3_f32 v224, v224, v179, v180
  v_max3_f32 v224, v224, v181, v182
  v_max3_f32 v224, v224, v183, v184
  v_max3_f32 v224, v224, v185, v186
  v_max3_f32 v224, v224, v187, v188
  v_max3_f32 v224, v224, v189, v190
  v_max_f32 v224, v224, v191
  v_mov_b32 v225, v224
  s_nop 1
  v_permlane32_swap_b32 v224, v225
  v_max_f32 v224, v224, v225
  v_mul_f32 v224, s28, v224
  v_max_f32 v224, v224, v233
  v_sub_f32 v226, v233, v224
  v_exp_f32 v226, v226
  v_mov_b32 v233, v224
  s_nop 0
  v_mul_f32 v235, v235, v226
  v_mul_f32 v64, v64, v226
  v_mul_f32 v65, v65, v226
  v_mul_f32 v66, v66, v226
  v_mul_f32 v67, v67, v226
  v_mul_f32 v68, v68, v226
  v_mul_f32 v69, v69, v226
  v_mul_f32 v70, v70, v226
  v_mul_f32 v71, v71, v226
  v_mul_f32 v72, v72, v226
  v_mul_f32 v73, v73, v226
  v_mul_f32 v74, v74, v226
  v_mul_f32 v75, v75, v226
  v_mul_f32 v76, v76, v226
  v_mul_f32 v77, v77, v226
  v_mul_f32 v78, v78, v226
  v_mul_f32 v79, v79, v226
  v_mul_f32 v80, v80, v226
  v_mul_f32 v81, v81, v226
  v_mul_f32 v82, v82, v226
  v_mul_f32 v83, v83, v226
  v_mul_f32 v84, v84, v226
  v_mul_f32 v85, v85, v226
  v_mul_f32 v86, v86, v226
  v_mul_f32 v87, v87, v226
  v_mul_f32 v88, v88, v226
  v_mul_f32 v89, v89, v226
  v_mul_f32 v90, v90, v226
  v_mul_f32 v91, v91, v226
  v_mul_f32 v92, v92, v226
  v_mul_f32 v93, v93, v226
  v_mul_f32 v94, v94, v226
  v_mul_f32 v95, v95, v226
  v_mul_f32 v96, v96, v226
  v_mul_f32 v97, v97, v226
  v_mul_f32 v98, v98, v226
  v_mul_f32 v99, v99, v226
  v_mul_f32 v100, v100, v226
  v_mul_f32 v101, v101, v226
  v_mul_f32 v102, v102, v226
  v_mul_f32 v103, v103, v226
  v_mul_f32 v104, v104, v226
  v_mul_f32 v105, v105, v226
  v_mul_f32 v106, v106, v226
  v_mul_f32 v107, v107, v226
  v_mul_f32 v108, v108, v226
  v_mul_f32 v109, v109, v226
  v_mul_f32 v110, v110, v226
  v_mul_f32 v111, v111, v226
  v_mul_f32 v112, v112, v226
  v_mul_f32 v113, v113, v226
  v_mul_f32 v114, v114, v226
  v_mul_f32 v115, v115, v226
  v_mul_f32 v116, v116, v226
  v_mul_f32 v117, v117, v226
  v_mul_f32 v118, v118, v226
  v_mul_f32 v119, v119, v226
  v_mul_f32 v120, v120, v226
  v_mul_f32 v121, v121, v226
  v_mul_f32 v122, v122, v226
  v_mul_f32 v123, v123, v226
  v_mul_f32 v124, v124, v226
  v_mul_f32 v125, v125, v226
  v_mul_f32 v126, v126, v226
  v_mul_f32 v127, v127, v226
  v_fma_f32 v224, v176, s28, -v233
  v_fma_f32 v225, v177, s28, -v233
  v_exp_f32 v224, v224
  v_exp_f32 v225, v225
  s_nop 0
  v_add_f32 v237, v224, v225
  v_cvt_pk_bf16_f32 v216, v224, v225
  v_fma_f32 v226, v178, s28, -v233
  v_fma_f32 v227, v179, s28, -v233
  v_exp_f32 v226, v226
  v_exp_f32 v227, v227
  s_nop 0
  v_add_f32 v237, v237, v226
  v_add_f32 v237, v237, v227
  v_cvt_pk_bf16_f32 v217, v226, v227
  v_fma_f32 v228, v180, s28, -v233
  v_fma_f32 v229, v181, s28, -v233
  v_exp_f32 v228, v228
  v_exp_f32 v229, v229
  s_nop 0
  v_add_f32 v237, v237, v228
  v_add_f32 v237, v237, v229
  v_cvt_pk_bf16_f32 v218, v228, v229
  v_fma_f32 v230, v182, s28, -v233
  v_fma_f32 v231, v183, s28, -v233
  v_exp_f32 v230, v230
  v_exp_f32 v231, v231
  s_nop 0
  v_add_f32 v237, v237, v230
  v_add_f32 v237, v237, v231
  v_cvt_pk_bf16_f32 v219, v230, v231
  v_fma_f32 v224, v184, s28, -v233
  v_fma_f32 v225, v185, s28, -v233
  v_exp_f32 v224, v224
  v_exp_f32 v225, v225
  s_nop 0
  v_add_f32 v237, v237, v224
  v_add_f32 v237, v237, v225
  v_cvt_pk_bf16_f32 v220, v224, v225
  v_fma_f32 v226, v186, s28, -v233
  v_fma_f32 v227, v187, s28, -v233
  v_exp_f32 v226, v226
  v_exp_f32 v227, v227
  s_nop 0
  v_add_f32 v237, v237, v226
  v_add_f32 v237, v237, v227
  v_cvt_pk_bf16_f32 v221, v226, v227
  v_fma_f32 v228, v188, s28, -v233
  v_fma_f32 v229, v189, s28, -v233
  v_exp_f32 v228, v228
  v_exp_f32 v229, v229
  s_nop 0
  v_add_f32 v237, v237, v228
  v_add_f32 v237, v237, v229
  v_cvt_pk_bf16_f32 v222, v228, v229
  v_fma_f32 v230, v190, s28, -v233
  v_fma_f32 v231, v191, s28, -v233
  v_exp_f32 v230, v230
  v_exp_f32 v231, v231
  s_nop 0
  v_add_f32 v237, v237, v230
  v_add_f32 v237, v237, v231
  v_cvt_pk_bf16_f32 v223, v230, v231
  s_nop 1
  s_branch RET_3
RARE_4:
  s_nop 7
  s_nop 7
  v_max3_f32 v224, v128, v129, v130
  v_max3_f32 v224, v224, v131, v132
  v_max3_f32 v224, v224, v133, v134
  v_max3_f32 v224, v224, v135, v136
  v_max3_f32 v224, v224, v137, v138
  v_max3_f32 v224, v224, v139, v140
  v_max3_f32 v224, v224, v141, v142
  v_max_f32 v224, v224, v143
  v_mov_b32 v225, v224
  s_nop 1
  v_permlane32_swap_b32 v224, v225
  v_max_f32 v224, v224, v225
  v_mul_f32 v224, s28, v224
  v_max_f32 v224, v224, v232
  v_sub_f32 v226, v232, v224
  v_exp_f32 v226, v226
  v_mov_b32 v232, v224
  s_nop 0
  v_mul_f32 v234, v234, v226
  v_mul_f32 v0, v0, v226
  v_mul_f32 v1, v1, v226
  v_mul_f32 v2, v2, v226
  v_mul_f32 v3, v3, v226
  v_mul_f32 v4, v4, v226
  v_mul_f32 v5, v5, v226
  v_mul_f32 v6, v6, v226
  v_mul_f32 v7, v7, v226
  v_mul_f32 v8, v8, v226
  v_mul_f32 v9, v9, v226
  v_mul_f32 v10, v10, v226
  v_mul_f32 v11, v11, v226
  v_mul_f32 v12, v12, v226
  v_mul_f32 v13, v13, v226
  v_mul_f32 v14, v14, v226
  v_mul_f32 v15, v15, v226
  v_mul_f32 v16, v16, v226
  v_mul_f32 v17, v17, v226
  v_mul_f32 v18, v18, v226
  v_mul_f32 v19, v19, v226
  v_mul_f32 v20, v20, v226
  v_mul_f32 v21, v21, v226
  v_mul_f32 v22, v22, v226
  v_mul_f32 v23, v23, v226
  v_mul_f32 v24, v24, v226
  v_mul_f32 v25, v25, v226
  v_mul_f32 v26, v26, v226
  v_mul_f32 v27, v27, v226
  v_mul_f32 v28, v28, v226
  v_mul_f32 v29, v29, v226
  v_mul_f32 v30, v30, v226
  v_mul_f32 v31, v31, v226
  v_mul_f32 v32, v32, v226
  v_mul_f32 v33, v33, v226
  v_mul_f32 v34, v34, v226
  v_mul_f32 v35, v35, v226
  v_mul_f32 v36, v36, v226
  v_mul_f32 v37, v37, v226
  v_mul_f32 v38, v38, v226
  v_mul_f32 v39, v39, v226
  v_mul_f32 v40, v40, v226
  v_mul_f32 v41, v41, v226
  v_mul_f32 v42, v42, v226
  v_mul_f32 v43, v43, v226
  v_mul_f32 v44, v44, v226
  v_mul_f32 v45, v45, v226
  v_mul_f32 v46, v46, v226
  v_mul_f32 v47, v47, v226
  v_mul_f32 v48, v48, v226
  v_mul_f32 v49, v49, v226
  v_mul_f32 v50, v50, v226
  v_mul_f32 v51, v51, v226
  v_mul_f32 v52, v52, v226
  v_mul_f32 v53, v53, v226
  v_mul_f32 v54, v54, v226
  v_mul_f32 v55, v55, v226
  v_mul_f32 v56, v56, v226
  v_mul_f32 v57, v57, v226
  v_mul_f32 v58, v58, v226
  v_mul_f32 v59, v59, v226
  v_mul_f32 v60, v60, v226
  v_mul_f32 v61, v61, v226
  v_mul_f32 v62, v62, v226
  v_mul_f32 v63, v63, v226
  v_fma_f32 v224, v128, s28, -v232
  v_fma_f32 v225, v129, s28, -v232
  v_exp_f32 v224, v224
  v_exp_f32 v225, v225
  s_nop 0
  v_add_f32 v236, v224, v225
  v_cvt_pk_bf16_f32 v192, v224, v225
  v_fma_f32 v226, v130, s28, -v232
  v_fma_f32 v227, v131, s28, -v232
  v_exp_f32 v226, v226
  v_exp_f32 v227, v227
  s_nop 0
  v_add_f32 v236, v236, v226
  v_add_f32 v236, v236, v227
  v_cvt_pk_bf16_f32 v193, v226, v227
  v_fma_f32 v228, v132, s28, -v232
  v_fma_f32 v229, v133, s28, -v232
  v_exp_f32 v228, v228
  v_exp_f32 v229, v229
  s_nop 0
  v_add_f32 v236, v236, v228
  v_add_f32 v236, v236, v229
  v_cvt_pk_bf16_f32 v194, v228, v229
  v_fma_f32 v230, v134, s28, -v232
  v_fma_f32 v231, v135, s28, -v232
  v_exp_f32 v230, v230
  v_exp_f32 v231, v231
  s_nop 0
  v_add_f32 v236, v236, v230
  v_add_f32 v236, v236, v231
  v_cvt_pk_bf16_f32 v195, v230, v231
  v_fma_f32 v224, v136, s28, -v232
  v_fma_f32 v225, v137, s28, -v232
  v_exp_f32 v224, v224
  v_exp_f32 v225, v225
  s_nop 0
  v_add_f32 v236, v236, v224
  v_add_f32 v236, v236, v225
  v_cvt_pk_bf16_f32 v196, v224, v225
  v_fma_f32 v226, v138, s28, -v232
  v_fma_f32 v227, v139, s28, -v232
  v_exp_f32 v226, v226
  v_exp_f32 v227, v227
  s_nop 0
  v_add_f32 v236, v236, v226
  v_add_f32 v236, v236, v227
  v_cvt_pk_bf16_f32 v197, v226, v227
  v_fma_f32 v228, v140, s28, -v232
  v_fma_f32 v229, v141, s28, -v232
  v_exp_f32 v228, v228
  v_exp_f32 v229, v229
  s_nop 0
  v_add_f32 v236, v236, v228
  v_add_f32 v236, v236, v229
  v_cvt_pk_bf16_f32 v198, v228, v229
  v_fma_f32 v230, v142, s28, -v232
  v_fma_f32 v231, v143, s28, -v232
  v_exp_f32 v230, v230
  v_exp_f32 v231, v231
  s_nop 0
  v_add_f32 v236, v236, v230
  v_add_f32 v236, v236, v231
  v_cvt_pk_bf16_f32 v199, v230, v231
  v_max3_f32 v224, v144, v145, v146
  v_max3_f32 v224, v224, v147, v148
  v_max3_f32 v224, v224, v149, v150
  v_max3_f32 v224, v224, v151, v152
  v_max3_f32 v224, v224, v153, v154
  v_max3_f32 v224, v224, v155, v156
  v_max3_f32 v224, v224, v157, v158
  v_max_f32 v224, v224, v159
  v_mov_b32 v225, v224
  s_nop 1
  v_permlane32_swap_b32 v224, v225
  v_max_f32 v224, v224, v225
  v_mul_f32 v224, s28, v224
  v_max_f32 v224, v224, v233
  v_sub_f32 v226, v233, v224
  v_exp_f32 v226, v226
  v_mov_b32 v233, v224
  s_nop 0
  v_mul_f32 v235, v235, v226
  v_mul_f32 v64, v64, v226
  v_mul_f32 v65, v65, v226
  v_mul_f32 v66, v66, v226
  v_mul_f32 v67, v67, v226
  v_mul_f32 v68, v68, v226
  v_mul_f32 v69, v69, v226
  v_mul_f32 v70, v70, v226
  v_mul_f32 v71, v71, v226
  v_mul_f32 v72, v72, v226
  v_mul_f32 v73, v73, v226
  v_mul_f32 v74, v74, v226
  v_mul_f32 v75, v75, v226
  v_mul_f32 v76, v76, v226
  v_mul_f32 v77, v77, v226
  v_mul_f32 v78, v78, v226
  v_mul_f32 v79, v79, v226
  v_mul_f32 v80, v80, v226
  v_mul_f32 v81, v81, v226
  v_mul_f32 v82, v82, v226
  v_mul_f32 v83, v83, v226
  v_mul_f32 v84, v84, v226
  v_mul_f32 v85, v85, v226
  v_mul_f32 v86, v86, v226
  v_mul_f32 v87, v87, v226
  v_mul_f32 v88, v88, v226
  v_mul_f32 v89, v89, v226
  v_mul_f32 v90, v90, v226
  v_mul_f32 v91, v91, v226
  v_mul_f32 v92, v92, v226
  v_mul_f32 v93, v93, v226
  v_mul_f32 v94, v94, v226
  v_mul_f32 v95, v95, v226
  v_mul_f32 v96, v96, v226
  v_mul_f32 v97, v97, v226
  v_mul_f32 v98, v98, v226
  v_mul_f32 v99, v99, v226
  v_mul_f32 v100, v100, v226
  v_mul_f32 v101, v101, v226
  v_mul_f32 v102, v102, v226
  v_mul_f32 v103, v103, v226
  v_mul_f32 v104, v104, v226
  v_mul_f32 v105, v105, v226
  v_mul_f32 v106, v106, v226
  v_mul_f32 v107, v107, v226
  v_mul_f32 v108, v108, v226
  v_mul_f32 v109, v109, v226
  v_mul_f32 v110, v110, v226
  v_mul_f32 v111, v111, v226
  v_mul_f32 v112, v112, v226
  v_mul_f32 v113, v113, v226
  v_mul_f32 v114, v114, v226
  v_mul_f32 v115, v115, v226
  v_mul_f32 v116, v116, v226
  v_mul_f32 v117, v117, v226
  v_mul_f32 v118, v118, v226
  v_mul_f32 v119, v119, v226
  v_mul_f32 v120, v120, v226
  v_mul_f32 v121, v121, v226
  v_mul_f32 v122, v122, v226
  v_mul_f32 v123, v123, v226
  v_mul_f32 v124, v124, v226
  v_mul_f32 v125, v125, v226
  v_mul_f32 v126, v126, v226
  v_mul_f32 v127, v127, v226
  v_fma_f32 v224, v144, s28, -v233
  v_fma_f32 v225, v145, s28, -v233
  v_exp_f32 v224, v224
  v_exp_f32 v225, v225
  s_nop 0
  v_add_f32 v237, v224, v225
  v_cvt_pk_bf16_f32 v200, v224, v225
  v_fma_f32 v226, v146, s28, -v233
  v_fma_f32 v227, v147, s28, -v233
  v_exp_f32 v226, v226
  v_exp_f32 v227, v227
  s_nop 0
  v_add_f32 v237, v237, v226
  v_add_f32 v237, v237, v227
  v_cvt_pk_bf16_f32 v201, v226, v227
  v_fma_f32 v228, v148, s28, -v233
  v_fma_f32 v229, v149, s28, -v233
  v_exp_f32 v228, v228
  v_exp_f32 v229, v229
  s_nop 0
  v_add_f32 v237, v237, v228
  v_add_f32 v237, v237, v229
  v_cvt_pk_bf16_f32 v202, v228, v229
  v_fma_f32 v230, v150, s28, -v233
  v_fma_f32 v231, v151, s28, -v233
  v_exp_f32 v230, v230
  v_exp_f32 v231, v231
  s_nop 0
  v_add_f32 v237, v237, v230
  v_add_f32 v237, v237, v231
  v_cvt_pk_bf16_f32 v203, v230, v231
  v_fma_f32 v224, v152, s28, -v233
  v_fma_f32 v225, v153, s28, -v233
  v_exp_f32 v224, v224
  v_exp_f32 v225, v225
  s_nop 0
  v_add_f32 v237, v237, v224
  v_add_f32 v237, v237, v225
  v_cvt_pk_bf16_f32 v204, v224, v225
  v_fma_f32 v226, v154, s28, -v233
  v_fma_f32 v227, v155, s28, -v233
  v_exp_f32 v226, v226
  v_exp_f32 v227, v227
  s_nop 0
  v_add_f32 v237, v237, v226
  v_add_f32 v237, v237, v227
  v_cvt_pk_bf16_f32 v205, v226, v227
  v_fma_f32 v228, v156, s28, -v233
  v_fma_f32 v229, v157, s28, -v233
  v_exp_f32 v228, v228
  v_exp_f32 v229, v229
  s_nop 0
  v_add_f32 v237, v237, v228
  v_add_f32 v237, v237, v229
  v_cvt_pk_bf16_f32 v206, v228, v229
  v_fma_f32 v230, v158, s28, -v233
  v_fma_f32 v231, v159, s28, -v233
  v_exp_f32 v230, v230
  v_exp_f32 v231, v231
  s_nop 0
  v_add_f32 v237, v237, v230
  v_add_f32 v237, v237, v231
  v_cvt_pk_bf16_f32 v207, v230, v231
  s_nop 1
  s_branch RET_4
RARE_5:
  s_nop 7
  s_nop 7
  v_max3_f32 v224, v160, v161, v162
  v_max3_f32 v224, v224, v163, v164
  v_max3_f32 v224, v224, v165, v166
  v_max3_f32 v224, v224, v167, v168
  v_max3_f32 v224, v224, v169, v170
  v_max3_f32 v224, v224, v171, v172
  v_max3_f32 v224, v224, v173, v174
  v_max_f32 v224, v224, v175
  v_mov_b32 v225, v224
  s_nop 1
  v_permlane32_swap_b32 v224, v225
  v_max_f32 v224, v224, v225
  v_mul_f32 v224, s28, v224
  v_max_f32 v224, v224, v232
  v_sub_f32 v226, v232, v224
  v_exp_f32 v226, v226
  v_mov_b32 v232, v224
  s_nop 0
  v_mul_f32 v234, v234, v226
  v_mul_f32 v0, v0, v226
  v_mul_f32 v1, v1, v226
  v_mul_f32 v2, v2, v226
  v_mul_f32 v3, v3, v226
  v_mul_f32 v4, v4, v226
  v_mul_f32 v5, v5, v226
  v_mul_f32 v6, v6, v226
  v_mul_f32 v7, v7, v226
  v_mul_f32 v8, v8, v226
  v_mul_f32 v9, v9, v226
  v_mul_f32 v10, v10, v226
  v_mul_f32 v11, v11, v226
  v_mul_f32 v12, v12, v226
  v_mul_f32 v13, v13, v226
  v_mul_f32 v14, v14, v226
  v_mul_f32 v15, v15, v226
  v_mul_f32 v16, v16, v226
  v_mul_f32 v17, v17, v226
  v_mul_f32 v18, v18, v226
  v_mul_f32 v19, v19, v226
  v_mul_f32 v20, v20, v226
  v_mul_f32 v21, v21, v226
  v_mul_f32 v22, v22, v226
  v_mul_f32 v23, v23, v226
  v_mul_f32 v24, v24, v226
  v_mul_f32 v25, v25, v226
  v_mul_f32 v26, v26, v226
  v_mul_f32 v27, v27, v226
  v_mul_f32 v28, v28, v226
  v_mul_f32 v29, v29, v226
  v_mul_f32 v30, v30, v226
  v_mul_f32 v31, v31, v226
  v_mul_f32 v32, v32, v226
  v_mul_f32 v33, v33, v226
  v_mul_f32 v34, v34, v226
  v_mul_f32 v35, v35, v226
  v_mul_f32 v36, v36, v226
  v_mul_f32 v37, v37, v226
  v_mul_f32 v38, v38, v226
  v_mul_f32 v39, v39, v226
  v_mul_f32 v40, v40, v226
  v_mul_f32 v41, v41, v226
  v_mul_f32 v42, v42, v226
  v_mul_f32 v43, v43, v226
  v_mul_f32 v44, v44, v226
  v_mul_f32 v45, v45, v226
  v_mul_f32 v46, v46, v226
  v_mul_f32 v47, v47, v226
  v_mul_f32 v48, v48, v226
  v_mul_f32 v49, v49, v226
  v_mul_f32 v50, v50, v226
  v_mul_f32 v51, v51, v226
  v_mul_f32 v52, v52, v226
  v_mul_f32 v53, v53, v226
  v_mul_f32 v54, v54, v226
  v_mul_f32 v55, v55, v226
  v_mul_f32 v56, v56, v226
  v_mul_f32 v57, v57, v226
  v_mul_f32 v58, v58, v226
  v_mul_f32 v59, v59, v226
  v_mul_f32 v60, v60, v226
  v_mul_f32 v61, v61, v226
  v_mul_f32 v62, v62, v226
  v_mul_f32 v63, v63, v226
  v_fma_f32 v224, v160, s28, -v232
  v_fma_f32 v225, v161, s28, -v232
  v_exp_f32 v224, v224
  v_exp_f32 v225, v225
  s_nop 0
  v_add_f32 v236, v224, v225
  v_cvt_pk_bf16_f32 v208, v224, v225
  v_fma_f32 v226, v162, s28, -v232
  v_fma_f32 v227, v163, s28, -v232
  v_exp_f32 v226, v226
  v_exp_f32 v227, v227
  s_nop 0
  v_add_f32 v236, v236, v226
  v_add_f32 v236, v236, v227
  v_cvt_pk_bf16_f32 v209, v226, v227
  v_fma_f32 v228, v164, s28, -v232
  v_fma_f32 v229, v165, s28, -v232
  v_exp_f32 v228, v228
  v_exp_f32 v229, v229
  s_nop 0
  v_add_f32 v236, v236, v228
  v_add_f32 v236, v236, v229
  v_cvt_pk_bf16_f32 v210, v228, v229
  v_fma_f32 v230, v166, s28, -v232
  v_fma_f32 v231, v167, s28, -v232
  v_exp_f32 v230, v230
  v_exp_f32 v231, v231
  s_nop 0
  v_add_f32 v236, v236, v230
  v_add_f32 v236, v236, v231
  v_cvt_pk_bf16_f32 v211, v230, v231
  v_fma_f32 v224, v168, s28, -v232
  v_fma_f32 v225, v169, s28, -v232
  v_exp_f32 v224, v224
  v_exp_f32 v225, v225
  s_nop 0
  v_add_f32 v236, v236, v224
  v_add_f32 v236, v236, v225
  v_cvt_pk_bf16_f32 v212, v224, v225
  v_fma_f32 v226, v170, s28, -v232
  v_fma_f32 v227, v171, s28, -v232
  v_exp_f32 v226, v226
  v_exp_f32 v227, v227
  s_nop 0
  v_add_f32 v236, v236, v226
  v_add_f32 v236, v236, v227
  v_cvt_pk_bf16_f32 v213, v226, v227
  v_fma_f32 v228, v172, s28, -v232
  v_fma_f32 v229, v173, s28, -v232
  v_exp_f32 v228, v228
  v_exp_f32 v229, v229
  s_nop 0
  v_add_f32 v236, v236, v228
  v_add_f32 v236, v236, v229
  v_cvt_pk_bf16_f32 v214, v228, v229
  v_fma_f32 v230, v174, s28, -v232
  v_fma_f32 v231, v175, s28, -v232
  v_exp_f32 v230, v230
  v_exp_f32 v231, v231
  s_nop 0
  v_add_f32 v236, v236, v230
  v_add_f32 v236, v236, v231
  v_cvt_pk_bf16_f32 v215, v230, v231
  v_max3_f32 v224, v176, v177, v178
  v_max3_f32 v224, v224, v179, v180
  v_max3_f32 v224, v224, v181, v182
  v_max3_f32 v224, v224, v183, v184
  v_max3_f32 v224, v224, v185, v186
  v_max3_f32 v224, v224, v187, v188
  v_max3_f32 v224, v224, v189, v190
  v_max_f32 v224, v224, v191
  v_mov_b32 v225, v224
  s_nop 1
  v_permlane32_swap_b32 v224, v225
  v_max_f32 v224, v224, v225
  v_mul_f32 v224, s28, v224
  v_max_f32 v224, v224, v233
  v_sub_f32 v226, v233, v224
  v_exp_f32 v226, v226
  v_mov_b32 v233, v224
  s_nop 0
  v_mul_f32 v235, v235, v226
  v_mul_f32 v64, v64, v226
  v_mul_f32 v65, v65, v226
  v_mul_f32 v66, v66, v226
  v_mul_f32 v67, v67, v226
  v_mul_f32 v68, v68, v226
  v_mul_f32 v69, v69, v226
  v_mul_f32 v70, v70, v226
  v_mul_f32 v71, v71, v226
  v_mul_f32 v72, v72, v226
  v_mul_f32 v73, v73, v226
  v_mul_f32 v74, v74, v226
  v_mul_f32 v75, v75, v226
  v_mul_f32 v76, v76, v226
  v_mul_f32 v77, v77, v226
  v_mul_f32 v78, v78, v226
  v_mul_f32 v79, v79, v226
  v_mul_f32 v80, v80, v226
  v_mul_f32 v81, v81, v226
  v_mul_f32 v82, v82, v226
  v_mul_f32 v83, v83, v226
  v_mul_f32 v84, v84, v226
  v_mul_f32 v85, v85, v226
  v_mul_f32 v86, v86, v226
  v_mul_f32 v87, v87, v226
  v_mul_f32 v88, v88, v226
  v_mul_f32 v89, v89, v226
  v_mul_f32 v90, v90, v226
  v_mul_f32 v91, v91, v226
  v_mul_f32 v92, v92, v226
  v_mul_f32 v93, v93, v226
  v_mul_f32 v94, v94, v226
  v_mul_f32 v95, v95, v226
  v_mul_f32 v96, v96, v226
  v_mul_f32 v97, v97, v226
  v_mul_f32 v98, v98, v226
  v_mul_f32 v99, v99, v226
  v_mul_f32 v100, v100, v226
  v_mul_f32 v101, v101, v226
  v_mul_f32 v102, v102, v226
  v_mul_f32 v103, v103, v226
  v_mul_f32 v104, v104, v226
  v_mul_f32 v105, v105, v226
  v_mul_f32 v106, v106, v226
  v_mul_f32 v107, v107, v226
  v_mul_f32 v108, v108, v226
  v_mul_f32 v109, v109, v226
  v_mul_f32 v110, v110, v226
  v_mul_f32 v111, v111, v226
  v_mul_f32 v112, v112, v226
  v_mul_f32 v113, v113, v226
  v_mul_f32 v114, v114, v226
  v_mul_f32 v115, v115, v226
  v_mul_f32 v116, v116, v226
  v_mul_f32 v117, v117, v226
  v_mul_f32 v118, v118, v226
  v_mul_f32 v119, v119, v226
  v_mul_f32 v120, v120, v226
  v_mul_f32 v121, v121, v226
  v_mul_f32 v122, v122, v226
  v_mul_f32 v123, v123, v226
  v_mul_f32 v124, v124, v226
  v_mul_f32 v125, v125, v226
  v_mul_f32 v126, v126, v226
  v_mul_f32 v127, v127, v226
  v_fma_f32 v224, v176, s28, -v233
  v_fma_f32 v225, v177, s28, -v233
  v_exp_f32 v224, v224
  v_exp_f32 v225, v225
  s_nop 0
  v_add_f32 v237, v224, v225
  v_cvt_pk_bf16_f32 v216, v224, v225
  v_fma_f32 v226, v178, s28, -v233
  v_fma_f32 v227, v179, s28, -v233
  v_exp_f32 v226, v226
  v_exp_f32 v227, v227
  s_nop 0
  v_add_f32 v237, v237, v226
  v_add_f32 v237, v237, v227
  v_cvt_pk_bf16_f32 v217, v226, v227
  v_fma_f32 v228, v180, s28, -v233
  v_fma_f32 v229, v181, s28, -v233
  v_exp_f32 v228, v228
  v_exp_f32 v229, v229
  s_nop 0
  v_add_f32 v237, v237, v228
  v_add_f32 v237, v237, v229
  v_cvt_pk_bf16_f32 v218, v228, v229
  v_fma_f32 v230, v182, s28, -v233
  v_fma_f32 v231, v183, s28, -v233
  v_exp_f32 v230, v230
  v_exp_f32 v231, v231
  s_nop 0
  v_add_f32 v237, v237, v230
  v_add_f32 v237, v237, v231
  v_cvt_pk_bf16_f32 v219, v230, v231
  v_fma_f32 v224, v184, s28, -v233
  v_fma_f32 v225, v185, s28, -v233
  v_exp_f32 v224, v224
  v_exp_f32 v225, v225
  s_nop 0
  v_add_f32 v237, v237, v224
  v_add_f32 v237, v237, v225
  v_cvt_pk_bf16_f32 v220, v224, v225
  v_fma_f32 v226, v186, s28, -v233
  v_fma_f32 v227, v187, s28, -v233
  v_exp_f32 v226, v226
  v_exp_f32 v227, v227
  s_nop 0
  v_add_f32 v237, v237, v226
  v_add_f32 v237, v237, v227
  v_cvt_pk_bf16_f32 v221, v226, v227
  v_fma_f32 v228, v188, s28, -v233
  v_fma_f32 v229, v189, s28, -v233
  v_exp_f32 v228, v228
  v_exp_f32 v229, v229
  s_nop 0
  v_add_f32 v237, v237, v228
  v_add_f32 v237, v237, v229
  v_cvt_pk_bf16_f32 v222, v228, v229
  v_fma_f32 v230, v190, s28, -v233
  v_fma_f32 v231, v191, s28, -v233
  v_exp_f32 v230, v230
  v_exp_f32 v231, v231
  s_nop 0
  v_add_f32 v237, v237, v230
  v_add_f32 v237, v237, v231
  v_cvt_pk_bf16_f32 v223, v230, v231
  s_nop 1
  s_branch RET_5
RARE_6:
  s_nop 7
  s_nop 7
  v_max3_f32 v224, v128, v129, v130
  v_max3_f32 v224, v224, v131, v132
  v_max3_f32 v224, v224, v133, v134
  v_max3_f32 v224, v224, v135, v136
  v_max3_f32 v224, v224, v137, v138
  v_max3_f32 v224, v224, v139, v140
  v_max3_f32 v224, v224, v141, v142
  v_max_f32 v224, v224, v143
  v_mov_b32 v225, v224
  s_nop 1
  v_permlane32_swap_b32 v224, v225
  v_max_f32 v224, v224, v225
  v_mul_f32 v224, s28, v224
  v_max_f32 v224, v224, v232
  v_sub_f32 v226, v232, v224
  v_exp_f32 v226, v226
  v_mov_b32 v232, v224
  s_nop 0
  v_mul_f32 v234, v234, v226
  v_mul_f32 v0, v0, v226
  v_mul_f32 v1, v1, v226
  v_mul_f32 v2, v2, v226
  v_mul_f32 v3, v3, v226
  v_mul_f32 v4, v4, v226
  v_mul_f32 v5, v5, v226
  v_mul_f32 v6, v6, v226
  v_mul_f32 v7, v7, v226
  v_mul_f32 v8, v8, v226
  v_mul_f32 v9, v9, v226
  v_mul_f32 v10, v10, v226
  v_mul_f32 v11, v11, v226
  v_mul_f32 v12, v12, v226
  v_mul_f32 v13, v13, v226
  v_mul_f32 v14, v14, v226
  v_mul_f32 v15, v15, v226
  v_mul_f32 v16, v16, v226
  v_mul_f32 v17, v17, v226
  v_mul_f32 v18, v18, v226
  v_mul_f32 v19, v19, v226
  v_mul_f32 v20, v20, v226
  v_mul_f32 v21, v21, v226
  v_mul_f32 v22, v22, v226
  v_mul_f32 v23, v23, v226
  v_mul_f32 v24, v24, v226
  v_mul_f32 v25, v25, v226
  v_mul_f32 v26, v26, v226
  v_mul_f32 v27, v27, v226
  v_mul_f32 v28, v28, v226
  v_mul_f32 v29, v29, v226
  v_mul_f32 v30, v30, v226
  v_mul_f32 v31, v31, v226
  v_mul_f32 v32, v32, v226
  v_mul_f32 v33, v33, v226
  v_mul_f32 v34, v34, v226
  v_mul_f32 v35, v35, v226
  v_mul_f32 v36, v36, v226
  v_mul_f32 v37, v37, v226
  v_mul_f32 v38, v38, v226
  v_mul_f32 v39, v39, v226
  v_mul_f32 v40, v40, v226
  v_mul_f32 v41, v41, v226
  v_mul_f32 v42, v42, v226
  v_mul_f32 v43, v43, v226
  v_mul_f32 v44, v44, v226
  v_mul_f32 v45, v45, v226
  v_mul_f32 v46, v46, v226
  v_mul_f32 v47, v47, v226
  v_mul_f32 v48, v48, v226
  v_mul_f32 v49, v49, v226
  v_mul_f32 v50, v50, v226
  v_mul_f32 v51, v51, v226
  v_mul_f32 v52, v52, v226
  v_mul_f32 v53, v53, v226
  v_mul_f32 v54, v54, v226
  v_mul_f32 v55, v55, v226
  v_mul_f32 v56, v56, v226
  v_mul_f32 v57, v57, v226
  v_mul_f32 v58, v58, v226
  v_mul_f32 v59, v59, v226
  v_mul_f32 v60, v60, v226
  v_mul_f32 v61, v61, v226
  v_mul_f32 v62, v62, v226
  v_mul_f32 v63, v63, v226
  v_fma_f32 v224, v128, s28, -v232
  v_fma_f32 v225, v129, s28, -v232
  v_exp_f32 v224, v224
  v_exp_f32 v225, v225
  s_nop 0
  v_add_f32 v236, v224, v225
  v_cvt_pk_bf16_f32 v192, v224, v225
  v_fma_f32 v226, v130, s28, -v232
  v_fma_f32 v227, v131, s28, -v232
  v_exp_f32 v226, v226
  v_exp_f32 v227, v227
  s_nop 0
  v_add_f32 v236, v236, v226
  v_add_f32 v236, v236, v227
  v_cvt_pk_bf16_f32 v193, v226, v227
  v_fma_f32 v228, v132, s28, -v232
  v_fma_f32 v229, v133, s28, -v232
  v_exp_f32 v228, v228
  v_exp_f32 v229, v229
  s_nop 0
  v_add_f32 v236, v236, v228
  v_add_f32 v236, v236, v229
  v_cvt_pk_bf16_f32 v194, v228, v229
  v_fma_f32 v230, v134, s28, -v232
  v_fma_f32 v231, v135, s28, -v232
  v_exp_f32 v230, v230
  v_exp_f32 v231, v231
  s_nop 0
  v_add_f32 v236, v236, v230
  v_add_f32 v236, v236, v231
  v_cvt_pk_bf16_f32 v195, v230, v231
  v_fma_f32 v224, v136, s28, -v232
  v_fma_f32 v225, v137, s28, -v232
  v_exp_f32 v224, v224
  v_exp_f32 v225, v225
  s_nop 0
  v_add_f32 v236, v236, v224
  v_add_f32 v236, v236, v225
  v_cvt_pk_bf16_f32 v196, v224, v225
  v_fma_f32 v226, v138, s28, -v232
  v_fma_f32 v227, v139, s28, -v232
  v_exp_f32 v226, v226
  v_exp_f32 v227, v227
  s_nop 0
  v_add_f32 v236, v236, v226
  v_add_f32 v236, v236, v227
  v_cvt_pk_bf16_f32 v197, v226, v227
  v_fma_f32 v228, v140, s28, -v232
  v_fma_f32 v229, v141, s28, -v232
  v_exp_f32 v228, v228
  v_exp_f32 v229, v229
  s_nop 0
  v_add_f32 v236, v236, v228
  v_add_f32 v236, v236, v229
  v_cvt_pk_bf16_f32 v198, v228, v229
  v_fma_f32 v230, v142, s28, -v232
  v_fma_f32 v231, v143, s28, -v232
  v_exp_f32 v230, v230
  v_exp_f32 v231, v231
  s_nop 0
  v_add_f32 v236, v236, v230
  v_add_f32 v236, v236, v231
  v_cvt_pk_bf16_f32 v199, v230, v231
  v_max3_f32 v224, v144, v145, v146
  v_max3_f32 v224, v224, v147, v148
  v_max3_f32 v224, v224, v149, v150
  v_max3_f32 v224, v224, v151, v152
  v_max3_f32 v224, v224, v153, v154
  v_max3_f32 v224, v224, v155, v156
  v_max3_f32 v224, v224, v157, v158
  v_max_f32 v224, v224, v159
  v_mov_b32 v225, v224
  s_nop 1
  v_permlane32_swap_b32 v224, v225
  v_max_f32 v224, v224, v225
  v_mul_f32 v224, s28, v224
  v_max_f32 v224, v224, v233
  v_sub_f32 v226, v233, v224
  v_exp_f32 v226, v226
  v_mov_b32 v233, v224
  s_nop 0
  v_mul_f32 v235, v235, v226
  v_mul_f32 v64, v64, v226
  v_mul_f32 v65, v65, v226
  v_mul_f32 v66, v66, v226
  v_mul_f32 v67, v67, v226
  v_mul_f32 v68, v68, v226
  v_mul_f32 v69, v69, v226
  v_mul_f32 v70, v70, v226
  v_mul_f32 v71, v71, v226
  v_mul_f32 v72, v72, v226
  v_mul_f32 v73, v73, v226
  v_mul_f32 v74, v74, v226
  v_mul_f32 v75, v75, v226
  v_mul_f32 v76, v76, v226
  v_mul_f32 v77, v77, v226
  v_mul_f32 v78, v78, v226
  v_mul_f32 v79, v79, v226
  v_mul_f32 v80, v80, v226
  v_mul_f32 v81, v81, v226
  v_mul_f32 v82, v82, v226
  v_mul_f32 v83, v83, v226
  v_mul_f32 v84, v84, v226
  v_mul_f32 v85, v85, v226
  v_mul_f32 v86, v86, v226
  v_mul_f32 v87, v87, v226
  v_mul_f32 v88, v88, v226
  v_mul_f32 v89, v89, v226
  v_mul_f32 v90, v90, v226
  v_mul_f32 v91, v91, v226
  v_mul_f32 v92, v92, v226
  v_mul_f32 v93, v93, v226
  v_mul_f32 v94, v94, v226
  v_mul_f32 v95, v95, v226
  v_mul_f32 v96, v96, v226
  v_mul_f32 v97, v97, v226
  v_mul_f32 v98, v98, v226
  v_mul_f32 v99, v99, v226
  v_mul_f32 v100, v100, v226
  v_mul_f32 v101, v101, v226
  v_mul_f32 v102, v102, v226
  v_mul_f32 v103, v103, v226
  v_mul_f32 v104, v104, v226
  v_mul_f32 v105, v105, v226
  v_mul_f32 v106, v106, v226
  v_mul_f32 v107, v107, v226
  v_mul_f32 v108, v108, v226
  v_mul_f32 v109, v109, v226
  v_mul_f32 v110, v110, v226
  v_mul_f32 v111, v111, v226
  v_mul_f32 v112, v112, v226
  v_mul_f32 v113, v113, v226
  v_mul_f32 v114, v114, v226
  v_mul_f32 v115, v115, v226
  v_mul_f32 v116, v116, v226
  v_mul_f32 v117, v117, v226
  v_mul_f32 v118, v118, v226
  v_mul_f32 v119, v119, v226
  v_mul_f32 v120, v120, v226
  v_mul_f32 v121, v121, v226
  v_mul_f32 v122, v122, v226
  v_mul_f32 v123, v123, v226
  v_mul_f32 v124, v124, v226
  v_mul_f32 v125, v125, v226
  v_mul_f32 v126, v126, v226
  v_mul_f32 v127, v127, v226
  v_fma_f32 v224, v144, s28, -v233
  v_fma_f32 v225, v145, s28, -v233
  v_exp_f32 v224, v224
  v_exp_f32 v225, v225
  s_nop 0
  v_add_f32 v237, v224, v225
  v_cvt_pk_bf16_f32 v200, v224, v225
  v_fma_f32 v226, v146, s28, -v233
  v_fma_f32 v227, v147, s28, -v233
  v_exp_f32 v226, v226
  v_exp_f32 v227, v227
  s_nop 0
  v_add_f32 v237, v237, v226
  v_add_f32 v237, v237, v227
  v_cvt_pk_bf16_f32 v201, v226, v227
  v_fma_f32 v228, v148, s28, -v233
  v_fma_f32 v229, v149, s28, -v233
  v_exp_f32 v228, v228
  v_exp_f32 v229, v229
  s_nop 0
  v_add_f32 v237, v237, v228
  v_add_f32 v237, v237, v229
  v_cvt_pk_bf16_f32 v202, v228, v229
  v_fma_f32 v230, v150, s28, -v233
  v_fma_f32 v231, v151, s28, -v233
  v_exp_f32 v230, v230
  v_exp_f32 v231, v231
  s_nop 0
  v_add_f32 v237, v237, v230
  v_add_f32 v237, v237, v231
  v_cvt_pk_bf16_f32 v203, v230, v231
  v_fma_f32 v224, v152, s28, -v233
  v_fma_f32 v225, v153, s28, -v233
  v_exp_f32 v224, v224
  v_exp_f32 v225, v225
  s_nop 0
  v_add_f32 v237, v237, v224
  v_add_f32 v237, v237, v225
  v_cvt_pk_bf16_f32 v204, v224, v225
  v_fma_f32 v226, v154, s28, -v233
  v_fma_f32 v227, v155, s28, -v233
  v_exp_f32 v226, v226
  v_exp_f32 v227, v227
  s_nop 0
  v_add_f32 v237, v237, v226
  v_add_f32 v237, v237, v227
  v_cvt_pk_bf16_f32 v205, v226, v227
  v_fma_f32 v228, v156, s28, -v233
  v_fma_f32 v229, v157, s28, -v233
  v_exp_f32 v228, v228
  v_exp_f32 v229, v229
  s_nop 0
  v_add_f32 v237, v237, v228
  v_add_f32 v237, v237, v229
  v_cvt_pk_bf16_f32 v206, v228, v229
  v_fma_f32 v230, v158, s28, -v233
  v_fma_f32 v231, v159, s28, -v233
  v_exp_f32 v230, v230
  v_exp_f32 v231, v231
  s_nop 0
  v_add_f32 v237, v237, v230
  v_add_f32 v237, v237, v231
  v_cvt_pk_bf16_f32 v207, v230, v231
  s_nop 1
  s_branch RET_6
RARE_7:
  s_nop 7
  s_nop 7
  v_max3_f32 v224, v160, v161, v162
  v_max3_f32 v224, v224, v163, v164
  v_max3_f32 v224, v224, v165, v166
  v_max3_f32 v224, v224, v167, v168
  v_max3_f32 v224, v224, v169, v170
  v_max3_f32 v224, v224, v171, v172
  v_max3_f32 v224, v224, v173, v174
  v_max_f32 v224, v224, v175
  v_mov_b32 v225, v224
  s_nop 1
  v_permlane32_swap_b32 v224, v225
  v_max_f32 v224, v224, v225
  v_mul_f32 v224, s28, v224
  v_max_f32 v224, v224, v232
  v_sub_f32 v226, v232, v224
  v_exp_f32 v226, v226
  v_mov_b32 v232, v224
  s_nop 0
  v_mul_f32 v234, v234, v226
  v_mul_f32 v0, v0, v226
  v_mul_f32 v1, v1, v226
  v_mul_f32 v2, v2, v226
  v_mul_f32 v3, v3, v226
  v_mul_f32 v4, v4, v226
  v_mul_f32 v5, v5, v226
  v_mul_f32 v6, v6, v226
  v_mul_f32 v7, v7, v226
  v_mul_f32 v8, v8, v226
  v_mul_f32 v9, v9, v226
  v_mul_f32 v10, v10, v226
  v_mul_f32 v11, v11, v226
  v_mul_f32 v12, v12, v226
  v_mul_f32 v13, v13, v226
  v_mul_f32 v14, v14, v226
  v_mul_f32 v15, v15, v226
  v_mul_f32 v16, v16, v226
  v_mul_f32 v17, v17, v226
  v_mul_f32 v18, v18, v226
  v_mul_f32 v19, v19, v226
  v_mul_f32 v20, v20, v226
  v_mul_f32 v21, v21, v226
  v_mul_f32 v22, v22, v226
  v_mul_f32 v23, v23, v226
  v_mul_f32 v24, v24, v226
  v_mul_f32 v25, v25, v226
  v_mul_f32 v26, v26, v226
  v_mul_f32 v27, v27, v226
  v_mul_f32 v28, v28, v226
  v_mul_f32 v29, v29, v226
  v_mul_f32 v30, v30, v226
  v_mul_f32 v31, v31, v226
  v_mul_f32 v32, v32, v226
  v_mul_f32 v33, v33, v226
  v_mul_f32 v34, v34, v226
  v_mul_f32 v35, v35, v226
  v_mul_f32 v36, v36, v226
  v_mul_f32 v37, v37, v226
  v_mul_f32 v38, v38, v226
  v_mul_f32 v39, v39, v226
  v_mul_f32 v40, v40, v226
  v_mul_f32 v41, v41, v226
  v_mul_f32 v42, v42, v226
  v_mul_f32 v43, v43, v226
  v_mul_f32 v44, v44, v226
  v_mul_f32 v45, v45, v226
  v_mul_f32 v46, v46, v226
  v_mul_f32 v47, v47, v226
  v_mul_f32 v48, v48, v226
  v_mul_f32 v49, v49, v226
  v_mul_f32 v50, v50, v226
  v_mul_f32 v51, v51, v226
  v_mul_f32 v52, v52, v226
  v_mul_f32 v53, v53, v226
  v_mul_f32 v54, v54, v226
  v_mul_f32 v55, v55, v226
  v_mul_f32 v56, v56, v226
  v_mul_f32 v57, v57, v226
  v_mul_f32 v58, v58, v226
  v_mul_f32 v59, v59, v226
  v_mul_f32 v60, v60, v226
  v_mul_f32 v61, v61, v226
  v_mul_f32 v62, v62, v226
  v_mul_f32 v63, v63, v226
  v_fma_f32 v224, v160, s28, -v232
  v_fma_f32 v225, v161, s28, -v232
  v_exp_f32 v224, v224
  v_exp_f32 v225, v225
  s_nop 0
  v_add_f32 v236, v224, v225
  v_cvt_pk_bf16_f32 v208, v224, v225
  v_fma_f32 v226, v162, s28, -v232
  v_fma_f32 v227, v163, s28, -v232
  v_exp_f32 v226, v226
  v_exp_f32 v227, v227
  s_nop 0
  v_add_f32 v236, v236, v226
  v_add_f32 v236, v236, v227
  v_cvt_pk_bf16_f32 v209, v226, v227
  v_fma_f32 v228, v164, s28, -v232
  v_fma_f32 v229, v165, s28, -v232
  v_exp_f32 v228, v228
  v_exp_f32 v229, v229
  s_nop 0
  v_add_f32 v236, v236, v228
  v_add_f32 v236, v236, v229
  v_cvt_pk_bf16_f32 v210, v228, v229
  v_fma_f32 v230, v166, s28, -v232
  v_fma_f32 v231, v167, s28, -v232
  v_exp_f32 v230, v230
  v_exp_f32 v231, v231
  s_nop 0
  v_add_f32 v236, v236, v230
  v_add_f32 v236, v236, v231
  v_cvt_pk_bf16_f32 v211, v230, v231
  v_fma_f32 v224, v168, s28, -v232
  v_fma_f32 v225, v169, s28, -v232
  v_exp_f32 v224, v224
  v_exp_f32 v225, v225
  s_nop 0
  v_add_f32 v236, v236, v224
  v_add_f32 v236, v236, v225
  v_cvt_pk_bf16_f32 v212, v224, v225
  v_fma_f32 v226, v170, s28, -v232
  v_fma_f32 v227, v171, s28, -v232
  v_exp_f32 v226, v226
  v_exp_f32 v227, v227
  s_nop 0
  v_add_f32 v236, v236, v226
  v_add_f32 v236, v236, v227
  v_cvt_pk_bf16_f32 v213, v226, v227
  v_fma_f32 v228, v172, s28, -v232
  v_fma_f32 v229, v173, s28, -v232
  v_exp_f32 v228, v228
  v_exp_f32 v229, v229
  s_nop 0
  v_add_f32 v236, v236, v228
  v_add_f32 v236, v236, v229
  v_cvt_pk_bf16_f32 v214, v228, v229
  v_fma_f32 v230, v174, s28, -v232
  v_fma_f32 v231, v175, s28, -v232
  v_exp_f32 v230, v230
  v_exp_f32 v231, v231
  s_nop 0
  v_add_f32 v236, v236, v230
  v_add_f32 v236, v236, v231
  v_cvt_pk_bf16_f32 v215, v230, v231
  v_max3_f32 v224, v176, v177, v178
  v_max3_f32 v224, v224, v179, v180
  v_max3_f32 v224, v224, v181, v182
  v_max3_f32 v224, v224, v183, v184
  v_max3_f32 v224, v224, v185, v186
  v_max3_f32 v224, v224, v187, v188
  v_max3_f32 v224, v224, v189, v190
  v_max_f32 v224, v224, v191
  v_mov_b32 v225, v224
  s_nop 1
  v_permlane32_swap_b32 v224, v225
  v_max_f32 v224, v224, v225
  v_mul_f32 v224, s28, v224
  v_max_f32 v224, v224, v233
  v_sub_f32 v226, v233, v224
  v_exp_f32 v226, v226
  v_mov_b32 v233, v224
  s_nop 0
  v_mul_f32 v235, v235, v226
  v_mul_f32 v64, v64, v226
  v_mul_f32 v65, v65, v226
  v_mul_f32 v66, v66, v226
  v_mul_f32 v67, v67, v226
  v_mul_f32 v68, v68, v226
  v_mul_f32 v69, v69, v226
  v_mul_f32 v70, v70, v226
  v_mul_f32 v71, v71, v226
  v_mul_f32 v72, v72, v226
  v_mul_f32 v73, v73, v226
  v_mul_f32 v74, v74, v226
  v_mul_f32 v75, v75, v226
  v_mul_f32 v76, v76, v226
  v_mul_f32 v77, v77, v226
  v_mul_f32 v78, v78, v226
  v_mul_f32 v79, v79, v226
  v_mul_f32 v80, v80, v226
  v_mul_f32 v81, v81, v226
  v_mul_f32 v82, v82, v226
  v_mul_f32 v83, v83, v226
  v_mul_f32 v84, v84, v226
  v_mul_f32 v85, v85, v226
  v_mul_f32 v86, v86, v226
  v_mul_f32 v87, v87, v226
  v_mul_f32 v88, v88, v226
  v_mul_f32 v89, v89, v226
  v_mul_f32 v90, v90, v226
  v_mul_f32 v91, v91, v226
  v_mul_f32 v92, v92, v226
  v_mul_f32 v93, v93, v226
  v_mul_f32 v94, v94, v226
  v_mul_f32 v95, v95, v226
  v_mul_f32 v96, v96, v226
  v_mul_f32 v97, v97, v226
  v_mul_f32 v98, v98, v226
  v_mul_f32 v99, v99, v226
  v_mul_f32 v100, v100, v226
  v_mul_f32 v101, v101, v226
  v_mul_f32 v102, v102, v226
  v_mul_f32 v103, v103, v226
  v_mul_f32 v104, v104, v226
  v_mul_f32 v105, v105, v226
  v_mul_f32 v106, v106, v226
  v_mul_f32 v107, v107, v226
  v_mul_f32 v108, v108, v226
  v_mul_f32 v109, v109, v226
  v_mul_f32 v110, v110, v226
  v_mul_f32 v111, v111, v226
  v_mul_f32 v112, v112, v226
  v_mul_f32 v113, v113, v226
  v_mul_f32 v114, v114, v226
  v_mul_f32 v115, v115, v226
  v_mul_f32 v116, v116, v226
  v_mul_f32 v117, v117, v226
  v_mul_f32 v118, v118, v226
  v_mul_f32 v119, v119, v226
  v_mul_f32 v120, v120, v226
  v_mul_f32 v121, v121, v226
  v_mul_f32 v122, v122, v226
  v_mul_f32 v123, v123, v226
  v_mul_f32 v124, v124, v226
  v_mul_f32 v125, v125, v226
  v_mul_f32 v126, v126, v226
  v_mul_f32 v127, v127, v226
  v_fma_f32 v224, v176, s28, -v233
  v_fma_f32 v225, v177, s28, -v233
  v_exp_f32 v224, v224
  v_exp_f32 v225, v225
  s_nop 0
  v_add_f32 v237, v224, v225
  v_cvt_pk_bf16_f32 v216, v224, v225
  v_fma_f32 v226, v178, s28, -v233
  v_fma_f32 v227, v179, s28, -v233
  v_exp_f32 v226, v226
  v_exp_f32 v227, v227
  s_nop 0
  v_add_f32 v237, v237, v226
  v_add_f32 v237, v237, v227
  v_cvt_pk_bf16_f32 v217, v226, v227
  v_fma_f32 v228, v180, s28, -v233
  v_fma_f32 v229, v181, s28, -v233
  v_exp_f32 v228, v228
  v_exp_f32 v229, v229
  s_nop 0
  v_add_f32 v237, v237, v228
  v_add_f32 v237, v237, v229
  v_cvt_pk_bf16_f32 v218, v228, v229
  v_fma_f32 v230, v182, s28, -v233
  v_fma_f32 v231, v183, s28, -v233
  v_exp_f32 v230, v230
  v_exp_f32 v231, v231
  s_nop 0
  v_add_f32 v237, v237, v230
  v_add_f32 v237, v237, v231
  v_cvt_pk_bf16_f32 v219, v230, v231
  v_fma_f32 v224, v184, s28, -v233
  v_fma_f32 v225, v185, s28, -v233
  v_exp_f32 v224, v224
  v_exp_f32 v225, v225
  s_nop 0
  v_add_f32 v237, v237, v224
  v_add_f32 v237, v237, v225
  v_cvt_pk_bf16_f32 v220, v224, v225
  v_fma_f32 v226, v186, s28, -v233
  v_fma_f32 v227, v187, s28, -v233
  v_exp_f32 v226, v226
  v_exp_f32 v227, v227
  s_nop 0
  v_add_f32 v237, v237, v226
  v_add_f32 v237, v237, v227
  v_cvt_pk_bf16_f32 v221, v226, v227
  v_fma_f32 v228, v188, s28, -v233
  v_fma_f32 v229, v189, s28, -v233
  v_exp_f32 v228, v228
  v_exp_f32 v229, v229
  s_nop 0
  v_add_f32 v237, v237, v228
  v_add_f32 v237, v237, v229
  v_cvt_pk_bf16_f32 v222, v228, v229
  v_fma_f32 v230, v190, s28, -v233
  v_fma_f32 v231, v191, s28, -v233
  v_exp_f32 v230, v230
  v_exp_f32 v231, v231
  s_nop 0
  v_add_f32 v237, v237, v230
  v_add_f32 v237, v237, v231
  v_cvt_pk_bf16_f32 v223, v230, v231
  s_nop 1
  s_branch RET_7
RARE_8:
  s_nop 7
  s_nop 7
  v_max3_f32 v224, v128, v129, v130
  v_max3_f32 v224, v224, v131, v132
  v_max3_f32 v224, v224, v133, v134
  v_max3_f32 v224, v224, v135, v136
  v_max3_f32 v224, v224, v137, v138
  v_max3_f32 v224, v224, v139, v140
  v_max3_f32 v224, v224, v141, v142
  v_max_f32 v224, v224, v143
  v_mov_b32 v225, v224
  s_nop 1
  v_permlane32_swap_b32 v224, v225
  v_max_f32 v224, v224, v225
  v_mul_f32 v224, s28, v224
  v_max_f32 v224, v224, v232
  v_sub_f32 v226, v232, v224
  v_exp_f32 v226, v226
  v_mov_b32 v232, v224
  s_nop 0
  v_mul_f32 v234, v234, v226
  v_mul_f32 v0, v0, v226
  v_mul_f32 v1, v1, v226
  v_mul_f32 v2, v2, v226
  v_mul_f32 v3, v3, v226
  v_mul_f32 v4, v4, v226
  v_mul_f32 v5, v5, v226
  v_mul_f32 v6, v6, v226
  v_mul_f32 v7, v7, v226
  v_mul_f32 v8, v8, v226
  v_mul_f32 v9, v9, v226
  v_mul_f32 v10, v10, v226
  v_mul_f32 v11, v11, v226
  v_mul_f32 v12, v12, v226
  v_mul_f32 v13, v13, v226
  v_mul_f32 v14, v14, v226
  v_mul_f32 v15, v15, v226
  v_mul_f32 v16, v16, v226
  v_mul_f32 v17, v17, v226
  v_mul_f32 v18, v18, v226
  v_mul_f32 v19, v19, v226
  v_mul_f32 v20, v20, v226
  v_mul_f32 v21, v21, v226
  v_mul_f32 v22, v22, v226
  v_mul_f32 v23, v23, v226
  v_mul_f32 v24, v24, v226
  v_mul_f32 v25, v25, v226
  v_mul_f32 v26, v26, v226
  v_mul_f32 v27, v27, v226
  v_mul_f32 v28, v28, v226
  v_mul_f32 v29, v29, v226
  v_mul_f32 v30, v30, v226
  v_mul_f32 v31, v31, v226
  v_mul_f32 v32, v32, v226
  v_mul_f32 v33, v33, v226
  v_mul_f32 v34, v34, v226
  v_mul_f32 v35, v35, v226
  v_mul_f32 v36, v36, v226
  v_mul_f32 v37, v37, v226
  v_mul_f32 v38, v38, v226
  v_mul_f32 v39, v39, v226
  v_mul_f32 v40, v40, v226
  v_mul_f32 v41, v41, v226
  v_mul_f32 v42, v42, v226
  v_mul_f32 v43, v43, v226
  v_mul_f32 v44, v44, v226
  v_mul_f32 v45, v45, v226
  v_mul_f32 v46, v46, v226
  v_mul_f32 v47, v47, v226
  v_mul_f32 v48, v48, v226
  v_mul_f32 v49, v49, v226
  v_mul_f32 v50, v50, v226
  v_mul_f32 v51, v51, v226
  v_mul_f32 v52, v52, v226
  v_mul_f32 v53, v53, v226
  v_mul_f32 v54, v54, v226
  v_mul_f32 v55, v55, v226
  v_mul_f32 v56, v56, v226
  v_mul_f32 v57, v57, v226
  v_mul_f32 v58, v58, v226
  v_mul_f32 v59, v59, v226
  v_mul_f32 v60, v60, v226
  v_mul_f32 v61, v61, v226
  v_mul_f32 v62, v62, v226
  v_mul_f32 v63, v63, v226
  v_fma_f32 v224, v128, s28, -v232
  v_fma_f32 v225, v129, s28, -v232
  v_exp_f32 v224, v224
  v_exp_f32 v225, v225
  s_nop 0
  v_add_f32 v236, v224, v225
  v_cvt_pk_bf16_f32 v192, v224, v225
  v_fma_f32 v226, v130, s28, -v232
  v_fma_f32 v227, v131, s28, -v232
  v_exp_f32 v226, v226
  v_exp_f32 v227, v227
  s_nop 0
  v_add_f32 v236, v236, v226
  v_add_f32 v236, v236, v227
  v_cvt_pk_bf16_f32 v193, v226, v227
  v_fma_f32 v228, v132, s28, -v232
  v_fma_f32 v229, v133, s28, -v232
  v_exp_f32 v228, v228
  v_exp_f32 v229, v229
  s_nop 0
  v_add_f32 v236, v236, v228
  v_add_f32 v236, v236, v229
  v_cvt_pk_bf16_f32 v194, v228, v229
  v_fma_f32 v230, v134, s28, -v232
  v_fma_f32 v231, v135, s28, -v232
  v_exp_f32 v230, v230
  v_exp_f32 v231, v231
  s_nop 0
  v_add_f32 v236, v236, v230
  v_add_f32 v236, v236, v231
  v_cvt_pk_bf16_f32 v195, v230, v231
  v_fma_f32 v224, v136, s28, -v232
  v_fma_f32 v225, v137, s28, -v232
  v_exp_f32 v224, v224
  v_exp_f32 v225, v225
  s_nop 0
  v_add_f32 v236, v236, v224
  v_add_f32 v236, v236, v225
  v_cvt_pk_bf16_f32 v196, v224, v225
  v_fma_f32 v226, v138, s28, -v232
  v_fma_f32 v227, v139, s28, -v232
  v_exp_f32 v226, v226
  v_exp_f32 v227, v227
  s_nop 0
  v_add_f32 v236, v236, v226
  v_add_f32 v236, v236, v227
  v_cvt_pk_bf16_f32 v197, v226, v227
  v_fma_f32 v228, v140, s28, -v232
  v_fma_f32 v229, v141, s28, -v232
  v_exp_f32 v228, v228
  v_exp_f32 v229, v229
  s_nop 0
  v_add_f32 v236, v236, v228
  v_add_f32 v236, v236, v229
  v_cvt_pk_bf16_f32 v198, v228, v229
  v_fma_f32 v230, v142, s28, -v232
  v_fma_f32 v231, v143, s28, -v232
  v_exp_f32 v230, v230
  v_exp_f32 v231, v231
  s_nop 0
  v_add_f32 v236, v236, v230
  v_add_f32 v236, v236, v231
  v_cvt_pk_bf16_f32 v199, v230, v231
  v_max3_f32 v224, v144, v145, v146
  v_max3_f32 v224, v224, v147, v148
  v_max3_f32 v224, v224, v149, v150
  v_max3_f32 v224, v224, v151, v152
  v_max3_f32 v224, v224, v153, v154
  v_max3_f32 v224, v224, v155, v156
  v_max3_f32 v224, v224, v157, v158
  v_max_f32 v224, v224, v159
  v_mov_b32 v225, v224
  s_nop 1
  v_permlane32_swap_b32 v224, v225
  v_max_f32 v224, v224, v225
  v_mul_f32 v224, s28, v224
  v_max_f32 v224, v224, v233
  v_sub_f32 v226, v233, v224
  v_exp_f32 v226, v226
  v_mov_b32 v233, v224
  s_nop 0
  v_mul_f32 v235, v235, v226
  v_mul_f32 v64, v64, v226
  v_mul_f32 v65, v65, v226
  v_mul_f32 v66, v66, v226
  v_mul_f32 v67, v67, v226
  v_mul_f32 v68, v68, v226
  v_mul_f32 v69, v69, v226
  v_mul_f32 v70, v70, v226
  v_mul_f32 v71, v71, v226
  v_mul_f32 v72, v72, v226
  v_mul_f32 v73, v73, v226
  v_mul_f32 v74, v74, v226
  v_mul_f32 v75, v75, v226
  v_mul_f32 v76, v76, v226
  v_mul_f32 v77, v77, v226
  v_mul_f32 v78, v78, v226
  v_mul_f32 v79, v79, v226
  v_mul_f32 v80, v80, v226
  v_mul_f32 v81, v81, v226
  v_mul_f32 v82, v82, v226
  v_mul_f32 v83, v83, v226
  v_mul_f32 v84, v84, v226
  v_mul_f32 v85, v85, v226
  v_mul_f32 v86, v86, v226
  v_mul_f32 v87, v87, v226
  v_mul_f32 v88, v88, v226
  v_mul_f32 v89, v89, v226
  v_mul_f32 v90, v90, v226
  v_mul_f32 v91, v91, v226
  v_mul_f32 v92, v92, v226
  v_mul_f32 v93, v93, v226
  v_mul_f32 v94, v94, v226
  v_mul_f32 v95, v95, v226
  v_mul_f32 v96, v96, v226
  v_mul_f32 v97, v97, v226
  v_mul_f32 v98, v98, v226
  v_mul_f32 v99, v99, v226
  v_mul_f32 v100, v100, v226
  v_mul_f32 v101, v101, v226
  v_mul_f32 v102, v102, v226
  v_mul_f32 v103, v103, v226
  v_mul_f32 v104, v104, v226
  v_mul_f32 v105, v105, v226
  v_mul_f32 v106, v106, v226
  v_mul_f32 v107, v107, v226
  v_mul_f32 v108, v108, v226
  v_mul_f32 v109, v109, v226
  v_mul_f32 v110, v110, v226
  v_mul_f32 v111, v111, v226
  v_mul_f32 v112, v112, v226
  v_mul_f32 v113, v113, v226
  v_mul_f32 v114, v114, v226
  v_mul_f32 v115, v115, v226
  v_mul_f32 v116, v116, v226
  v_mul_f32 v117, v117, v226
  v_mul_f32 v118, v118, v226
  v_mul_f32 v119, v119, v226
  v_mul_f32 v120, v120, v226
  v_mul_f32 v121, v121, v226
  v_mul_f32 v122, v122, v226
  v_mul_f32 v123, v123, v226
  v_mul_f32 v124, v124, v226
  v_mul_f32 v125, v125, v226
  v_mul_f32 v126, v126, v226
  v_mul_f32 v127, v127, v226
  v_fma_f32 v224, v144, s28, -v233
  v_fma_f32 v225, v145, s28, -v233
  v_exp_f32 v224, v224
  v_exp_f32 v225, v225
  s_nop 0
  v_add_f32 v237, v224, v225
  v_cvt_pk_bf16_f32 v200, v224, v225
  v_fma_f32 v226, v146, s28, -v233
  v_fma_f32 v227, v147, s28, -v233
  v_exp_f32 v226, v226
  v_exp_f32 v227, v227
  s_nop 0
  v_add_f32 v237, v237, v226
  v_add_f32 v237, v237, v227
  v_cvt_pk_bf16_f32 v201, v226, v227
  v_fma_f32 v228, v148, s28, -v233
  v_fma_f32 v229, v149, s28, -v233
  v_exp_f32 v228, v228
  v_exp_f32 v229, v229
  s_nop 0
  v_add_f32 v237, v237, v228
  v_add_f32 v237, v237, v229
  v_cvt_pk_bf16_f32 v202, v228, v229
  v_fma_f32 v230, v150, s28, -v233
  v_fma_f32 v231, v151, s28, -v233
  v_exp_f32 v230, v230
  v_exp_f32 v231, v231
  s_nop 0
  v_add_f32 v237, v237, v230
  v_add_f32 v237, v237, v231
  v_cvt_pk_bf16_f32 v203, v230, v231
  v_fma_f32 v224, v152, s28, -v233
  v_fma_f32 v225, v153, s28, -v233
  v_exp_f32 v224, v224
  v_exp_f32 v225, v225
  s_nop 0
  v_add_f32 v237, v237, v224
  v_add_f32 v237, v237, v225
  v_cvt_pk_bf16_f32 v204, v224, v225
  v_fma_f32 v226, v154, s28, -v233
  v_fma_f32 v227, v155, s28, -v233
  v_exp_f32 v226, v226
  v_exp_f32 v227, v227
  s_nop 0
  v_add_f32 v237, v237, v226
  v_add_f32 v237, v237, v227
  v_cvt_pk_bf16_f32 v205, v226, v227
  v_fma_f32 v228, v156, s28, -v233
  v_fma_f32 v229, v157, s28, -v233
  v_exp_f32 v228, v228
  v_exp_f32 v229, v229
  s_nop 0
  v_add_f32 v237, v237, v228
  v_add_f32 v237, v237, v229
  v_cvt_pk_bf16_f32 v206, v228, v229
  v_fma_f32 v230, v158, s28, -v233
  v_fma_f32 v231, v159, s28, -v233
  v_exp_f32 v230, v230
  v_exp_f32 v231, v231
  s_nop 0
  v_add_f32 v237, v237, v230
  v_add_f32 v237, v237, v231
  v_cvt_pk_bf16_f32 v207, v230, v231
  s_nop 1
  s_branch RET_8
RARE_9:
  s_nop 7
  s_nop 7
  v_max3_f32 v224, v160, v161, v162
  v_max3_f32 v224, v224, v163, v164
  v_max3_f32 v224, v224, v165, v166
  v_max3_f32 v224, v224, v167, v168
  v_max3_f32 v224, v224, v169, v170
  v_max3_f32 v224, v224, v171, v172
  v_max3_f32 v224, v224, v173, v174
  v_max_f32 v224, v224, v175
  v_mov_b32 v225, v224
  s_nop 1
  v_permlane32_swap_b32 v224, v225
  v_max_f32 v224, v224, v225
  v_mul_f32 v224, s28, v224
  v_max_f32 v224, v224, v232
  v_sub_f32 v226, v232, v224
  v_exp_f32 v226, v226
  v_mov_b32 v232, v224
  s_nop 0
  v_mul_f32 v234, v234, v226
  v_mul_f32 v0, v0, v226
  v_mul_f32 v1, v1, v226
  v_mul_f32 v2, v2, v226
  v_mul_f32 v3, v3, v226
  v_mul_f32 v4, v4, v226
  v_mul_f32 v5, v5, v226
  v_mul_f32 v6, v6, v226
  v_mul_f32 v7, v7, v226
  v_mul_f32 v8, v8, v226
  v_mul_f32 v9, v9, v226
  v_mul_f32 v10, v10, v226
  v_mul_f32 v11, v11, v226
  v_mul_f32 v12, v12, v226
  v_mul_f32 v13, v13, v226
  v_mul_f32 v14, v14, v226
  v_mul_f32 v15, v15, v226
  v_mul_f32 v16, v16, v226
  v_mul_f32 v17, v17, v226
  v_mul_f32 v18, v18, v226
  v_mul_f32 v19, v19, v226
  v_mul_f32 v20, v20, v226
  v_mul_f32 v21, v21, v226
  v_mul_f32 v22, v22, v226
  v_mul_f32 v23, v23, v226
  v_mul_f32 v24, v24, v226
  v_mul_f32 v25, v25, v226
  v_mul_f32 v26, v26, v226
  v_mul_f32 v27, v27, v226
  v_mul_f32 v28, v28, v226
  v_mul_f32 v29, v29, v226
  v_mul_f32 v30, v30, v226
  v_mul_f32 v31, v31, v226
  v_mul_f32 v32, v32, v226
  v_mul_f32 v33, v33, v226
  v_mul_f32 v34, v34, v226
  v_mul_f32 v35, v35, v226
  v_mul_f32 v36, v36, v226
  v_mul_f32 v37, v37, v226
  v_mul_f32 v38, v38, v226
  v_mul_f32 v39, v39, v226
  v_mul_f32 v40, v40, v226
  v_mul_f32 v41, v41, v226
  v_mul_f32 v42, v42, v226
  v_mul_f32 v43, v43, v226
  v_mul_f32 v44, v44, v226
  v_mul_f32 v45, v45, v226
  v_mul_f32 v46, v46, v226
  v_mul_f32 v47, v47, v226
  v_mul_f32 v48, v48, v226
  v_mul_f32 v49, v49, v226
  v_mul_f32 v50, v50, v226
  v_mul_f32 v51, v51, v226
  v_mul_f32 v52, v52, v226
  v_mul_f32 v53, v53, v226
  v_mul_f32 v54, v54, v226
  v_mul_f32 v55, v55, v226
  v_mul_f32 v56, v56, v226
  v_mul_f32 v57, v57, v226
  v_mul_f32 v58, v58, v226
  v_mul_f32 v59, v59, v226
  v_mul_f32 v60, v60, v226
  v_mul_f32 v61, v61, v226
  v_mul_f32 v62, v62, v226
  v_mul_f32 v63, v63, v226
  v_fma_f32 v224, v160, s28, -v232
  v_fma_f32 v225, v161, s28, -v232
  v_exp_f32 v224, v224
  v_exp_f32 v225, v225
  s_nop 0
  v_add_f32 v236, v224, v225
  v_cvt_pk_bf16_f32 v208, v224, v225
  v_fma_f32 v226, v162, s28, -v232
  v_fma_f32 v227, v163, s28, -v232
  v_exp_f32 v226, v226
  v_exp_f32 v227, v227
  s_nop 0
  v_add_f32 v236, v236, v226
  v_add_f32 v236, v236, v227
  v_cvt_pk_bf16_f32 v209, v226, v227
  v_fma_f32 v228, v164, s28, -v232
  v_fma_f32 v229, v165, s28, -v232
  v_exp_f32 v228, v228
  v_exp_f32 v229, v229
  s_nop 0
  v_add_f32 v236, v236, v228
  v_add_f32 v236, v236, v229
  v_cvt_pk_bf16_f32 v210, v228, v229
  v_fma_f32 v230, v166, s28, -v232
  v_fma_f32 v231, v167, s28, -v232
  v_exp_f32 v230, v230
  v_exp_f32 v231, v231
  s_nop 0
  v_add_f32 v236, v236, v230
  v_add_f32 v236, v236, v231
  v_cvt_pk_bf16_f32 v211, v230, v231
  v_fma_f32 v224, v168, s28, -v232
  v_fma_f32 v225, v169, s28, -v232
  v_exp_f32 v224, v224
  v_exp_f32 v225, v225
  s_nop 0
  v_add_f32 v236, v236, v224
  v_add_f32 v236, v236, v225
  v_cvt_pk_bf16_f32 v212, v224, v225
  v_fma_f32 v226, v170, s28, -v232
  v_fma_f32 v227, v171, s28, -v232
  v_exp_f32 v226, v226
  v_exp_f32 v227, v227
  s_nop 0
  v_add_f32 v236, v236, v226
  v_add_f32 v236, v236, v227
  v_cvt_pk_bf16_f32 v213, v226, v227
  v_fma_f32 v228, v172, s28, -v232
  v_fma_f32 v229, v173, s28, -v232
  v_exp_f32 v228, v228
  v_exp_f32 v229, v229
  s_nop 0
  v_add_f32 v236, v236, v228
  v_add_f32 v236, v236, v229
  v_cvt_pk_bf16_f32 v214, v228, v229
  v_fma_f32 v230, v174, s28, -v232
  v_fma_f32 v231, v175, s28, -v232
  v_exp_f32 v230, v230
  v_exp_f32 v231, v231
  s_nop 0
  v_add_f32 v236, v236, v230
  v_add_f32 v236, v236, v231
  v_cvt_pk_bf16_f32 v215, v230, v231
  v_max3_f32 v224, v176, v177, v178
  v_max3_f32 v224, v224, v179, v180
  v_max3_f32 v224, v224, v181, v182
  v_max3_f32 v224, v224, v183, v184
  v_max3_f32 v224, v224, v185, v186
  v_max3_f32 v224, v224, v187, v188
  v_max3_f32 v224, v224, v189, v190
  v_max_f32 v224, v224, v191
  v_mov_b32 v225, v224
  s_nop 1
  v_permlane32_swap_b32 v224, v225
  v_max_f32 v224, v224, v225
  v_mul_f32 v224, s28, v224
  v_max_f32 v224, v224, v233
  v_sub_f32 v226, v233, v224
  v_exp_f32 v226, v226
  v_mov_b32 v233, v224
  s_nop 0
  v_mul_f32 v235, v235, v226
  v_mul_f32 v64, v64, v226
  v_mul_f32 v65, v65, v226
  v_mul_f32 v66, v66, v226
  v_mul_f32 v67, v67, v226
  v_mul_f32 v68, v68, v226
  v_mul_f32 v69, v69, v226
  v_mul_f32 v70, v70, v226
  v_mul_f32 v71, v71, v226
  v_mul_f32 v72, v72, v226
  v_mul_f32 v73, v73, v226
  v_mul_f32 v74, v74, v226
  v_mul_f32 v75, v75, v226
  v_mul_f32 v76, v76, v226
  v_mul_f32 v77, v77, v226
  v_mul_f32 v78, v78, v226
  v_mul_f32 v79, v79, v226
  v_mul_f32 v80, v80, v226
  v_mul_f32 v81, v81, v226
  v_mul_f32 v82, v82, v226
  v_mul_f32 v83, v83, v226
  v_mul_f32 v84, v84, v226
  v_mul_f32 v85, v85, v226
  v_mul_f32 v86, v86, v226
  v_mul_f32 v87, v87, v226
  v_mul_f32 v88, v88, v226
  v_mul_f32 v89, v89, v226
  v_mul_f32 v90, v90, v226
  v_mul_f32 v91, v91, v226
  v_mul_f32 v92, v92, v226
  v_mul_f32 v93, v93, v226
  v_mul_f32 v94, v94, v226
  v_mul_f32 v95, v95, v226
  v_mul_f32 v96, v96, v226
  v_mul_f32 v97, v97, v226
  v_mul_f32 v98, v98, v226
  v_mul_f32 v99, v99, v226
  v_mul_f32 v100, v100, v226
  v_mul_f32 v101, v101, v226
  v_mul_f32 v102, v102, v226
  v_mul_f32 v103, v103, v226
  v_mul_f32 v104, v104, v226
  v_mul_f32 v105, v105, v226
  v_mul_f32 v106, v106, v226
  v_mul_f32 v107, v107, v226
  v_mul_f32 v108, v108, v226
  v_mul_f32 v109, v109, v226
  v_mul_f32 v110, v110, v226
  v_mul_f32 v111, v111, v226
  v_mul_f32 v112, v112, v226
  v_mul_f32 v113, v113, v226
  v_mul_f32 v114, v114, v226
  v_mul_f32 v115, v115, v226
  v_mul_f32 v116, v116, v226
  v_mul_f32 v117, v117, v226
  v_mul_f32 v118, v118, v226
  v_mul_f32 v119, v119, v226
  v_mul_f32 v120, v120, v226
  v_mul_f32 v121, v121, v226
  v_mul_f32 v122, v122, v226
  v_mul_f32 v123, v123, v226
  v_mul_f32 v124, v124, v226
  v_mul_f32 v125, v125, v226
  v_mul_f32 v126, v126, v226
  v_mul_f32 v127, v127, v226
  v_fma_f32 v224, v176, s28, -v233
  v_fma_f32 v225, v177, s28, -v233
  v_exp_f32 v224, v224
  v_exp_f32 v225, v225
  s_nop 0
  v_add_f32 v237, v224, v225
  v_cvt_pk_bf16_f32 v216, v224, v225
  v_fma_f32 v226, v178, s28, -v233
  v_fma_f32 v227, v179, s28, -v233
  v_exp_f32 v226, v226
  v_exp_f32 v227, v227
  s_nop 0
  v_add_f32 v237, v237, v226
  v_add_f32 v237, v237, v227
  v_cvt_pk_bf16_f32 v217, v226, v227
  v_fma_f32 v228, v180, s28, -v233
  v_fma_f32 v229, v181, s28, -v233
  v_exp_f32 v228, v228
  v_exp_f32 v229, v229
  s_nop 0
  v_add_f32 v237, v237, v228
  v_add_f32 v237, v237, v229
  v_cvt_pk_bf16_f32 v218, v228, v229
  v_fma_f32 v230, v182, s28, -v233
  v_fma_f32 v231, v183, s28, -v233
  v_exp_f32 v230, v230
  v_exp_f32 v231, v231
  s_nop 0
  v_add_f32 v237, v237, v230
  v_add_f32 v237, v237, v231
  v_cvt_pk_bf16_f32 v219, v230, v231
  v_fma_f32 v224, v184, s28, -v233
  v_fma_f32 v225, v185, s28, -v233
  v_exp_f32 v224, v224
  v_exp_f32 v225, v225
  s_nop 0
  v_add_f32 v237, v237, v224
  v_add_f32 v237, v237, v225
  v_cvt_pk_bf16_f32 v220, v224, v225
  v_fma_f32 v226, v186, s28, -v233
  v_fma_f32 v227, v187, s28, -v233
  v_exp_f32 v226, v226
  v_exp_f32 v227, v227
  s_nop 0
  v_add_f32 v237, v237, v226
  v_add_f32 v237, v237, v227
  v_cvt_pk_bf16_f32 v221, v226, v227
  v_fma_f32 v228, v188, s28, -v233
  v_fma_f32 v229, v189, s28, -v233
  v_exp_f32 v228, v228
  v_exp_f32 v229, v229
  s_nop 0
  v_add_f32 v237, v237, v228
  v_add_f32 v237, v237, v229
  v_cvt_pk_bf16_f32 v222, v228, v229
  v_fma_f32 v230, v190, s28, -v233
  v_fma_f32 v231, v191, s28, -v233
  v_exp_f32 v230, v230
  v_exp_f32 v231, v231
  s_nop 0
  v_add_f32 v237, v237, v230
  v_add_f32 v237, v237, v231
  v_cvt_pk_bf16_f32 v223, v230, v231
  s_nop 1
  s_branch RET_9
RARE_10:
  s_nop 7
  s_nop 7
  v_max3_f32 v224, v128, v129, v130
  v_max3_f32 v224, v224, v131, v132
  v_max3_f32 v224, v224, v133, v134
  v_max3_f32 v224, v224, v135, v136
  v_max3_f32 v224, v224, v137, v138
  v_max3_f32 v224, v224, v139, v140
  v_max3_f32 v224, v224, v141, v142
  v_max_f32 v224, v224, v143
  v_mov_b32 v225, v224
  s_nop 1
  v_permlane32_swap_b32 v224, v225
  v_max_f32 v224, v224, v225
  v_mul_f32 v224, s28, v224
  v_max_f32 v224, v224, v232
  v_sub_f32 v226, v232, v224
  v_exp_f32 v226, v226
  v_mov_b32 v232, v224
  s_nop 0
  v_mul_f32 v234, v234, v226
  v_mul_f32 v0, v0, v226
  v_mul_f32 v1, v1, v226
  v_mul_f32 v2, v2, v226
  v_mul_f32 v3, v3, v226
  v_mul_f32 v4, v4, v226
  v_mul_f32 v5, v5, v226
  v_mul_f32 v6, v6, v226
  v_mul_f32 v7, v7, v226
  v_mul_f32 v8, v8, v226
  v_mul_f32 v9, v9, v226
  v_mul_f32 v10, v10, v226
  v_mul_f32 v11, v11, v226
  v_mul_f32 v12, v12, v226
  v_mul_f32 v13, v13, v226
  v_mul_f32 v14, v14, v226
  v_mul_f32 v15, v15, v226
  v_mul_f32 v16, v16, v226
  v_mul_f32 v17, v17, v226
  v_mul_f32 v18, v18, v226
  v_mul_f32 v19, v19, v226
  v_mul_f32 v20, v20, v226
  v_mul_f32 v21, v21, v226
  v_mul_f32 v22, v22, v226
  v_mul_f32 v23, v23, v226
  v_mul_f32 v24, v24, v226
  v_mul_f32 v25, v25, v226
  v_mul_f32 v26, v26, v226
  v_mul_f32 v27, v27, v226
  v_mul_f32 v28, v28, v226
  v_mul_f32 v29, v29, v226
  v_mul_f32 v30, v30, v226
  v_mul_f32 v31, v31, v226
  v_mul_f32 v32, v32, v226
  v_mul_f32 v33, v33, v226
  v_mul_f32 v34, v34, v226
  v_mul_f32 v35, v35, v226
  v_mul_f32 v36, v36, v226
  v_mul_f32 v37, v37, v226
  v_mul_f32 v38, v38, v226
  v_mul_f32 v39, v39, v226
  v_mul_f32 v40, v40, v226
  v_mul_f32 v41, v41, v226
  v_mul_f32 v42, v42, v226
  v_mul_f32 v43, v43, v226
  v_mul_f32 v44, v44, v226
  v_mul_f32 v45, v45, v226
  v_mul_f32 v46, v46, v226
  v_mul_f32 v47, v47, v226
  v_mul_f32 v48, v48, v226
  v_mul_f32 v49, v49, v226
  v_mul_f32 v50, v50, v226
  v_mul_f32 v51, v51, v226
  v_mul_f32 v52, v52, v226
  v_mul_f32 v53, v53, v226
  v_mul_f32 v54, v54, v226
  v_mul_f32 v55, v55, v226
  v_mul_f32 v56, v56, v226
  v_mul_f32 v57, v57, v226
  v_mul_f32 v58, v58, v226
  v_mul_f32 v59, v59, v226
  v_mul_f32 v60, v60, v226
  v_mul_f32 v61, v61, v226
  v_mul_f32 v62, v62, v226
  v_mul_f32 v63, v63, v226
  v_fma_f32 v224, v128, s28, -v232
  v_fma_f32 v225, v129, s28, -v232
  v_exp_f32 v224, v224
  v_exp_f32 v225, v225
  s_nop 0
  v_add_f32 v236, v224, v225
  v_cvt_pk_bf16_f32 v192, v224, v225
  v_fma_f32 v226, v130, s28, -v232
  v_fma_f32 v227, v131, s28, -v232
  v_exp_f32 v226, v226
  v_exp_f32 v227, v227
  s_nop 0
  v_add_f32 v236, v236, v226
  v_add_f32 v236, v236, v227
  v_cvt_pk_bf16_f32 v193, v226, v227
  v_fma_f32 v228, v132, s28, -v232
  v_fma_f32 v229, v133, s28, -v232
  v_exp_f32 v228, v228
  v_exp_f32 v229, v229
  s_nop 0
  v_add_f32 v236, v236, v228
  v_add_f32 v236, v236, v229
  v_cvt_pk_bf16_f32 v194, v228, v229
  v_fma_f32 v230, v134, s28, -v232
  v_fma_f32 v231, v135, s28, -v232
  v_exp_f32 v230, v230
  v_exp_f32 v231, v231
  s_nop 0
  v_add_f32 v236, v236, v230
  v_add_f32 v236, v236, v231
  v_cvt_pk_bf16_f32 v195, v230, v231
  v_fma_f32 v224, v136, s28, -v232
  v_fma_f32 v225, v137, s28, -v232
  v_exp_f32 v224, v224
  v_exp_f32 v225, v225
  s_nop 0
  v_add_f32 v236, v236, v224
  v_add_f32 v236, v236, v225
  v_cvt_pk_bf16_f32 v196, v224, v225
  v_fma_f32 v226, v138, s28, -v232
  v_fma_f32 v227, v139, s28, -v232
  v_exp_f32 v226, v226
  v_exp_f32 v227, v227
  s_nop 0
  v_add_f32 v236, v236, v226
  v_add_f32 v236, v236, v227
  v_cvt_pk_bf16_f32 v197, v226, v227
  v_fma_f32 v228, v140, s28, -v232
  v_fma_f32 v229, v141, s28, -v232
  v_exp_f32 v228, v228
  v_exp_f32 v229, v229
  s_nop 0
  v_add_f32 v236, v236, v228
  v_add_f32 v236, v236, v229
  v_cvt_pk_bf16_f32 v198, v228, v229
  v_fma_f32 v230, v142, s28, -v232
  v_fma_f32 v231, v143, s28, -v232
  v_exp_f32 v230, v230
  v_exp_f32 v231, v231
  s_nop 0
  v_add_f32 v236, v236, v230
  v_add_f32 v236, v236, v231
  v_cvt_pk_bf16_f32 v199, v230, v231
  v_max3_f32 v224, v144, v145, v146
  v_max3_f32 v224, v224, v147, v148
  v_max3_f32 v224, v224, v149, v150
  v_max3_f32 v224, v224, v151, v152
  v_max3_f32 v224, v224, v153, v154
  v_max3_f32 v224, v224, v155, v156
  v_max3_f32 v224, v224, v157, v158
  v_max_f32 v224, v224, v159
  v_mov_b32 v225, v224
  s_nop 1
  v_permlane32_swap_b32 v224, v225
  v_max_f32 v224, v224, v225
  v_mul_f32 v224, s28, v224
  v_max_f32 v224, v224, v233
  v_sub_f32 v226, v233, v224
  v_exp_f32 v226, v226
  v_mov_b32 v233, v224
  s_nop 0
  v_mul_f32 v235, v235, v226
  v_mul_f32 v64, v64, v226
  v_mul_f32 v65, v65, v226
  v_mul_f32 v66, v66, v226
  v_mul_f32 v67, v67, v226
  v_mul_f32 v68, v68, v226
  v_mul_f32 v69, v69, v226
  v_mul_f32 v70, v70, v226
  v_mul_f32 v71, v71, v226
  v_mul_f32 v72, v72, v226
  v_mul_f32 v73, v73, v226
  v_mul_f32 v74, v74, v226
  v_mul_f32 v75, v75, v226
  v_mul_f32 v76, v76, v226
  v_mul_f32 v77, v77, v226
  v_mul_f32 v78, v78, v226
  v_mul_f32 v79, v79, v226
  v_mul_f32 v80, v80, v226
  v_mul_f32 v81, v81, v226
  v_mul_f32 v82, v82, v226
  v_mul_f32 v83, v83, v226
  v_mul_f32 v84, v84, v226
  v_mul_f32 v85, v85, v226
  v_mul_f32 v86, v86, v226
  v_mul_f32 v87, v87, v226
  v_mul_f32 v88, v88, v226
  v_mul_f32 v89, v89, v226
  v_mul_f32 v90, v90, v226
  v_mul_f32 v91, v91, v226
  v_mul_f32 v92, v92, v226
  v_mul_f32 v93, v93, v226
  v_mul_f32 v94, v94, v226
  v_mul_f32 v95, v95, v226
  v_mul_f32 v96, v96, v226
  v_mul_f32 v97, v97, v226
  v_mul_f32 v98, v98, v226
  v_mul_f32 v99, v99, v226
  v_mul_f32 v100, v100, v226
  v_mul_f32 v101, v101, v226
  v_mul_f32 v102, v102, v226
  v_mul_f32 v103, v103, v226
  v_mul_f32 v104, v104, v226
  v_mul_f32 v105, v105, v226
  v_mul_f32 v106, v106, v226
  v_mul_f32 v107, v107, v226
  v_mul_f32 v108, v108, v226
  v_mul_f32 v109, v109, v226
  v_mul_f32 v110, v110, v226
  v_mul_f32 v111, v111, v226
  v_mul_f32 v112, v112, v226
  v_mul_f32 v113, v113, v226
  v_mul_f32 v114, v114, v226
  v_mul_f32 v115, v115, v226
  v_mul_f32 v116, v116, v226
  v_mul_f32 v117, v117, v226
  v_mul_f32 v118, v118, v226
  v_mul_f32 v119, v119, v226
  v_mul_f32 v120, v120, v226
  v_mul_f32 v121, v121, v226
  v_mul_f32 v122, v122, v226
  v_mul_f32 v123, v123, v226
  v_mul_f32 v124, v124, v226
  v_mul_f32 v125, v125, v226
  v_mul_f32 v126, v126, v226
  v_mul_f32 v127, v127, v226
  v_fma_f32 v224, v144, s28, -v233
  v_fma_f32 v225, v145, s28, -v233
  v_exp_f32 v224, v224
  v_exp_f32 v225, v225
  s_nop 0
  v_add_f32 v237, v224, v225
  v_cvt_pk_bf16_f32 v200, v224, v225
  v_fma_f32 v226, v146, s28, -v233
  v_fma_f32 v227, v147, s28, -v233
  v_exp_f32 v226, v226
  v_exp_f32 v227, v227
  s_nop 0
  v_add_f32 v237, v237, v226
  v_add_f32 v237, v237, v227
  v_cvt_pk_bf16_f32 v201, v226, v227
  v_fma_f32 v228, v148, s28, -v233
  v_fma_f32 v229, v149, s28, -v233
  v_exp_f32 v228, v228
  v_exp_f32 v229, v229
  s_nop 0
  v_add_f32 v237, v237, v228
  v_add_f32 v237, v237, v229
  v_cvt_pk_bf16_f32 v202, v228, v229
  v_fma_f32 v230, v150, s28, -v233
  v_fma_f32 v231, v151, s28, -v233
  v_exp_f32 v230, v230
  v_exp_f32 v231, v231
  s_nop 0
  v_add_f32 v237, v237, v230
  v_add_f32 v237, v237, v231
  v_cvt_pk_bf16_f32 v203, v230, v231
  v_fma_f32 v224, v152, s28, -v233
  v_fma_f32 v225, v153, s28, -v233
  v_exp_f32 v224, v224
  v_exp_f32 v225, v225
  s_nop 0
  v_add_f32 v237, v237, v224
  v_add_f32 v237, v237, v225
  v_cvt_pk_bf16_f32 v204, v224, v225
  v_fma_f32 v226, v154, s28, -v233
  v_fma_f32 v227, v155, s28, -v233
  v_exp_f32 v226, v226
  v_exp_f32 v227, v227
  s_nop 0
  v_add_f32 v237, v237, v226
  v_add_f32 v237, v237, v227
  v_cvt_pk_bf16_f32 v205, v226, v227
  v_fma_f32 v228, v156, s28, -v233
  v_fma_f32 v229, v157, s28, -v233
  v_exp_f32 v228, v228
  v_exp_f32 v229, v229
  s_nop 0
  v_add_f32 v237, v237, v228
  v_add_f32 v237, v237, v229
  v_cvt_pk_bf16_f32 v206, v228, v229
  v_fma_f32 v230, v158, s28, -v233
  v_fma_f32 v231, v159, s28, -v233
  v_exp_f32 v230, v230
  v_exp_f32 v231, v231
  s_nop 0
  v_add_f32 v237, v237, v230
  v_add_f32 v237, v237, v231
  v_cvt_pk_bf16_f32 v207, v230, v231
  s_nop 1
  s_branch RET_10
RARE_11:
  s_nop 7
  s_nop 7
  v_max3_f32 v224, v160, v161, v162
  v_max3_f32 v224, v224, v163, v164
  v_max3_f32 v224, v224, v165, v166
  v_max3_f32 v224, v224, v167, v168
  v_max3_f32 v224, v224, v169, v170
  v_max3_f32 v224, v224, v171, v172
  v_max3_f32 v224, v224, v173, v174
  v_max_f32 v224, v224, v175
  v_mov_b32 v225, v224
  s_nop 1
  v_permlane32_swap_b32 v224, v225
  v_max_f32 v224, v224, v225
  v_mul_f32 v224, s28, v224
  v_max_f32 v224, v224, v232
  v_sub_f32 v226, v232, v224
  v_exp_f32 v226, v226
  v_mov_b32 v232, v224
  s_nop 0
  v_mul_f32 v234, v234, v226
  v_mul_f32 v0, v0, v226
  v_mul_f32 v1, v1, v226
  v_mul_f32 v2, v2, v226
  v_mul_f32 v3, v3, v226
  v_mul_f32 v4, v4, v226
  v_mul_f32 v5, v5, v226
  v_mul_f32 v6, v6, v226
  v_mul_f32 v7, v7, v226
  v_mul_f32 v8, v8, v226
  v_mul_f32 v9, v9, v226
  v_mul_f32 v10, v10, v226
  v_mul_f32 v11, v11, v226
  v_mul_f32 v12, v12, v226
  v_mul_f32 v13, v13, v226
  v_mul_f32 v14, v14, v226
  v_mul_f32 v15, v15, v226
  v_mul_f32 v16, v16, v226
  v_mul_f32 v17, v17, v226
  v_mul_f32 v18, v18, v226
  v_mul_f32 v19, v19, v226
  v_mul_f32 v20, v20, v226
  v_mul_f32 v21, v21, v226
  v_mul_f32 v22, v22, v226
  v_mul_f32 v23, v23, v226
  v_mul_f32 v24, v24, v226
  v_mul_f32 v25, v25, v226
  v_mul_f32 v26, v26, v226
  v_mul_f32 v27, v27, v226
  v_mul_f32 v28, v28, v226
  v_mul_f32 v29, v29, v226
  v_mul_f32 v30, v30, v226
  v_mul_f32 v31, v31, v226
  v_mul_f32 v32, v32, v226
  v_mul_f32 v33, v33, v226
  v_mul_f32 v34, v34, v226
  v_mul_f32 v35, v35, v226
  v_mul_f32 v36, v36, v226
  v_mul_f32 v37, v37, v226
  v_mul_f32 v38, v38, v226
  v_mul_f32 v39, v39, v226
  v_mul_f32 v40, v40, v226
  v_mul_f32 v41, v41, v226
  v_mul_f32 v42, v42, v226
  v_mul_f32 v43, v43, v226
  v_mul_f32 v44, v44, v226
  v_mul_f32 v45, v45, v226
  v_mul_f32 v46, v46, v226
  v_mul_f32 v47, v47, v226
  v_mul_f32 v48, v48, v226
  v_mul_f32 v49, v49, v226
  v_mul_f32 v50, v50, v226
  v_mul_f32 v51, v51, v226
  v_mul_f32 v52, v52, v226
  v_mul_f32 v53, v53, v226
  v_mul_f32 v54, v54, v226
  v_mul_f32 v55, v55, v226
  v_mul_f32 v56, v56, v226
  v_mul_f32 v57, v57, v226
  v_mul_f32 v58, v58, v226
  v_mul_f32 v59, v59, v226
  v_mul_f32 v60, v60, v226
  v_mul_f32 v61, v61, v226
  v_mul_f32 v62, v62, v226
  v_mul_f32 v63, v63, v226
  v_fma_f32 v224, v160, s28, -v232
  v_fma_f32 v225, v161, s28, -v232
  v_exp_f32 v224, v224
  v_exp_f32 v225, v225
  s_nop 0
  v_add_f32 v236, v224, v225
  v_cvt_pk_bf16_f32 v208, v224, v225
  v_fma_f32 v226, v162, s28, -v232
  v_fma_f32 v227, v163, s28, -v232
  v_exp_f32 v226, v226
  v_exp_f32 v227, v227
  s_nop 0
  v_add_f32 v236, v236, v226
  v_add_f32 v236, v236, v227
  v_cvt_pk_bf16_f32 v209, v226, v227
  v_fma_f32 v228, v164, s28, -v232
  v_fma_f32 v229, v165, s28, -v232
  v_exp_f32 v228, v228
  v_exp_f32 v229, v229
  s_nop 0
  v_add_f32 v236, v236, v228
  v_add_f32 v236, v236, v229
  v_cvt_pk_bf16_f32 v210, v228, v229
  v_fma_f32 v230, v166, s28, -v232
  v_fma_f32 v231, v167, s28, -v232
  v_exp_f32 v230, v230
  v_exp_f32 v231, v231
  s_nop 0
  v_add_f32 v236, v236, v230
  v_add_f32 v236, v236, v231
  v_cvt_pk_bf16_f32 v211, v230, v231
  v_fma_f32 v224, v168, s28, -v232
  v_fma_f32 v225, v169, s28, -v232
  v_exp_f32 v224, v224
  v_exp_f32 v225, v225
  s_nop 0
  v_add_f32 v236, v236, v224
  v_add_f32 v236, v236, v225
  v_cvt_pk_bf16_f32 v212, v224, v225
  v_fma_f32 v226, v170, s28, -v232
  v_fma_f32 v227, v171, s28, -v232
  v_exp_f32 v226, v226
  v_exp_f32 v227, v227
  s_nop 0
  v_add_f32 v236, v236, v226
  v_add_f32 v236, v236, v227
  v_cvt_pk_bf16_f32 v213, v226, v227
  v_fma_f32 v228, v172, s28, -v232
  v_fma_f32 v229, v173, s28, -v232
  v_exp_f32 v228, v228
  v_exp_f32 v229, v229
  s_nop 0
  v_add_f32 v236, v236, v228
  v_add_f32 v236, v236, v229
  v_cvt_pk_bf16_f32 v214, v228, v229
  v_fma_f32 v230, v174, s28, -v232
  v_fma_f32 v231, v175, s28, -v232
  v_exp_f32 v230, v230
  v_exp_f32 v231, v231
  s_nop 0
  v_add_f32 v236, v236, v230
  v_add_f32 v236, v236, v231
  v_cvt_pk_bf16_f32 v215, v230, v231
  v_max3_f32 v224, v176, v177, v178
  v_max3_f32 v224, v224, v179, v180
  v_max3_f32 v224, v224, v181, v182
  v_max3_f32 v224, v224, v183, v184
  v_max3_f32 v224, v224, v185, v186
  v_max3_f32 v224, v224, v187, v188
  v_max3_f32 v224, v224, v189, v190
  v_max_f32 v224, v224, v191
  v_mov_b32 v225, v224
  s_nop 1
  v_permlane32_swap_b32 v224, v225
  v_max_f32 v224, v224, v225
  v_mul_f32 v224, s28, v224
  v_max_f32 v224, v224, v233
  v_sub_f32 v226, v233, v224
  v_exp_f32 v226, v226
  v_mov_b32 v233, v224
  s_nop 0
  v_mul_f32 v235, v235, v226
  v_mul_f32 v64, v64, v226
  v_mul_f32 v65, v65, v226
  v_mul_f32 v66, v66, v226
  v_mul_f32 v67, v67, v226
  v_mul_f32 v68, v68, v226
  v_mul_f32 v69, v69, v226
  v_mul_f32 v70, v70, v226
  v_mul_f32 v71, v71, v226
  v_mul_f32 v72, v72, v226
  v_mul_f32 v73, v73, v226
  v_mul_f32 v74, v74, v226
  v_mul_f32 v75, v75, v226
  v_mul_f32 v76, v76, v226
  v_mul_f32 v77, v77, v226
  v_mul_f32 v78, v78, v226
  v_mul_f32 v79, v79, v226
  v_mul_f32 v80, v80, v226
  v_mul_f32 v81, v81, v226
  v_mul_f32 v82, v82, v226
  v_mul_f32 v83, v83, v226
  v_mul_f32 v84, v84, v226
  v_mul_f32 v85, v85, v226
  v_mul_f32 v86, v86, v226
  v_mul_f32 v87, v87, v226
  v_mul_f32 v88, v88, v226
  v_mul_f32 v89, v89, v226
  v_mul_f32 v90, v90, v226
  v_mul_f32 v91, v91, v226
  v_mul_f32 v92, v92, v226
  v_mul_f32 v93, v93, v226
  v_mul_f32 v94, v94, v226
  v_mul_f32 v95, v95, v226
  v_mul_f32 v96, v96, v226
  v_mul_f32 v97, v97, v226
  v_mul_f32 v98, v98, v226
  v_mul_f32 v99, v99, v226
  v_mul_f32 v100, v100, v226
  v_mul_f32 v101, v101, v226
  v_mul_f32 v102, v102, v226
  v_mul_f32 v103, v103, v226
  v_mul_f32 v104, v104, v226
  v_mul_f32 v105, v105, v226
  v_mul_f32 v106, v106, v226
  v_mul_f32 v107, v107, v226
  v_mul_f32 v108, v108, v226
  v_mul_f32 v109, v109, v226
  v_mul_f32 v110, v110, v226
  v_mul_f32 v111, v111, v226
  v_mul_f32 v112, v112, v226
  v_mul_f32 v113, v113, v226
  v_mul_f32 v114, v114, v226
  v_mul_f32 v115, v115, v226
  v_mul_f32 v116, v116, v226
  v_mul_f32 v117, v117, v226
  v_mul_f32 v118, v118, v226
  v_mul_f32 v119, v119, v226
  v_mul_f32 v120, v120, v226
  v_mul_f32 v121, v121, v226
  v_mul_f32 v122, v122, v226
  v_mul_f32 v123, v123, v226
  v_mul_f32 v124, v124, v226
  v_mul_f32 v125, v125, v226
  v_mul_f32 v126, v126, v226
  v_mul_f32 v127, v127, v226
  v_fma_f32 v224, v176, s28, -v233
  v_fma_f32 v225, v177, s28, -v233
  v_exp_f32 v224, v224
  v_exp_f32 v225, v225
  s_nop 0
  v_add_f32 v237, v224, v225
  v_cvt_pk_bf16_f32 v216, v224, v225
  v_fma_f32 v226, v178, s28, -v233
  v_fma_f32 v227, v179, s28, -v233
  v_exp_f32 v226, v226
  v_exp_f32 v227, v227
  s_nop 0
  v_add_f32 v237, v237, v226
  v_add_f32 v237, v237, v227
  v_cvt_pk_bf16_f32 v217, v226, v227
  v_fma_f32 v228, v180, s28, -v233
  v_fma_f32 v229, v181, s28, -v233
  v_exp_f32 v228, v228
  v_exp_f32 v229, v229
  s_nop 0
  v_add_f32 v237, v237, v228
  v_add_f32 v237, v237, v229
  v_cvt_pk_bf16_f32 v218, v228, v229
  v_fma_f32 v230, v182, s28, -v233
  v_fma_f32 v231, v183, s28, -v233
  v_exp_f32 v230, v230
  v_exp_f32 v231, v231
  s_nop 0
  v_add_f32 v237, v237, v230
  v_add_f32 v237, v237, v231
  v_cvt_pk_bf16_f32 v219, v230, v231
  v_fma_f32 v224, v184, s28, -v233
  v_fma_f32 v225, v185, s28, -v233
  v_exp_f32 v224, v224
  v_exp_f32 v225, v225
  s_nop 0
  v_add_f32 v237, v237, v224
  v_add_f32 v237, v237, v225
  v_cvt_pk_bf16_f32 v220, v224, v225
  v_fma_f32 v226, v186, s28, -v233
  v_fma_f32 v227, v187, s28, -v233
  v_exp_f32 v226, v226
  v_exp_f32 v227, v227
  s_nop 0
  v_add_f32 v237, v237, v226
  v_add_f32 v237, v237, v227
  v_cvt_pk_bf16_f32 v221, v226, v227
  v_fma_f32 v228, v188, s28, -v233
  v_fma_f32 v229, v189, s28, -v233
  v_exp_f32 v228, v228
  v_exp_f32 v229, v229
  s_nop 0
  v_add_f32 v237, v237, v228
  v_add_f32 v237, v237, v229
  v_cvt_pk_bf16_f32 v222, v228, v229
  v_fma_f32 v230, v190, s28, -v233
  v_fma_f32 v231, v191, s28, -v233
  v_exp_f32 v230, v230
  v_exp_f32 v231, v231
  s_nop 0
  v_add_f32 v237, v237, v230
  v_add_f32 v237, v237, v231
  v_cvt_pk_bf16_f32 v223, v230, v231
  s_nop 1
  s_branch RET_11
RARE_12:
  s_nop 7
  s_nop 7
  v_max3_f32 v224, v128, v129, v130
  v_max3_f32 v224, v224, v131, v132
  v_max3_f32 v224, v224, v133, v134
  v_max3_f32 v224, v224, v135, v136
  v_max3_f32 v224, v224, v137, v138
  v_max3_f32 v224, v224, v139, v140
  v_max3_f32 v224, v224, v141, v142
  v_max_f32 v224, v224, v143
  v_mov_b32 v225, v224
  s_nop 1
  v_permlane32_swap_b32 v224, v225
  v_max_f32 v224, v224, v225
  v_mul_f32 v224, s28, v224
  v_max_f32 v224, v224, v232
  v_sub_f32 v226, v232, v224
  v_exp_f32 v226, v226
  v_mov_b32 v232, v224
  s_nop 0
  v_mul_f32 v234, v234, v226
  v_mul_f32 v0, v0, v226
  v_mul_f32 v1, v1, v226
  v_mul_f32 v2, v2, v226
  v_mul_f32 v3, v3, v226
  v_mul_f32 v4, v4, v226
  v_mul_f32 v5, v5, v226
  v_mul_f32 v6, v6, v226
  v_mul_f32 v7, v7, v226
  v_mul_f32 v8, v8, v226
  v_mul_f32 v9, v9, v226
  v_mul_f32 v10, v10, v226
  v_mul_f32 v11, v11, v226
  v_mul_f32 v12, v12, v226
  v_mul_f32 v13, v13, v226
  v_mul_f32 v14, v14, v226
  v_mul_f32 v15, v15, v226
  v_mul_f32 v16, v16, v226
  v_mul_f32 v17, v17, v226
  v_mul_f32 v18, v18, v226
  v_mul_f32 v19, v19, v226
  v_mul_f32 v20, v20, v226
  v_mul_f32 v21, v21, v226
  v_mul_f32 v22, v22, v226
  v_mul_f32 v23, v23, v226
  v_mul_f32 v24, v24, v226
  v_mul_f32 v25, v25, v226
  v_mul_f32 v26, v26, v226
  v_mul_f32 v27, v27, v226
  v_mul_f32 v28, v28, v226
  v_mul_f32 v29, v29, v226
  v_mul_f32 v30, v30, v226
  v_mul_f32 v31, v31, v226
  v_mul_f32 v32, v32, v226
  v_mul_f32 v33, v33, v226
  v_mul_f32 v34, v34, v226
  v_mul_f32 v35, v35, v226
  v_mul_f32 v36, v36, v226
  v_mul_f32 v37, v37, v226
  v_mul_f32 v38, v38, v226
  v_mul_f32 v39, v39, v226
  v_mul_f32 v40, v40, v226
  v_mul_f32 v41, v41, v226
  v_mul_f32 v42, v42, v226
  v_mul_f32 v43, v43, v226
  v_mul_f32 v44, v44, v226
  v_mul_f32 v45, v45, v226
  v_mul_f32 v46, v46, v226
  v_mul_f32 v47, v47, v226
  v_mul_f32 v48, v48, v226
  v_mul_f32 v49, v49, v226
  v_mul_f32 v50, v50, v226
  v_mul_f32 v51, v51, v226
  v_mul_f32 v52, v52, v226
  v_mul_f32 v53, v53, v226
  v_mul_f32 v54, v54, v226
  v_mul_f32 v55, v55, v226
  v_mul_f32 v56, v56, v226
  v_mul_f32 v57, v57, v226
  v_mul_f32 v58, v58, v226
  v_mul_f32 v59, v59, v226
  v_mul_f32 v60, v60, v226
  v_mul_f32 v61, v61, v226
  v_mul_f32 v62, v62, v226
  v_mul_f32 v63, v63, v226
  v_fma_f32 v224, v128, s28, -v232
  v_fma_f32 v225, v129, s28, -v232
  v_exp_f32 v224, v224
  v_exp_f32 v225, v225
  s_nop 0
  v_add_f32 v236, v224, v225
  v_cvt_pk_bf16_f32 v192, v224, v225
  v_fma_f32 v226, v130, s28, -v232
  v_fma_f32 v227, v131, s28, -v232
  v_exp_f32 v226, v226
  v_exp_f32 v227, v227
  s_nop 0
  v_add_f32 v236, v236, v226
  v_add_f32 v236, v236, v227
  v_cvt_pk_bf16_f32 v193, v226, v227
  v_fma_f32 v228, v132, s28, -v232
  v_fma_f32 v229, v133, s28, -v232
  v_exp_f32 v228, v228
  v_exp_f32 v229, v229
  s_nop 0
  v_add_f32 v236, v236, v228
  v_add_f32 v236, v236, v229
  v_cvt_pk_bf16_f32 v194, v228, v229
  v_fma_f32 v230, v134, s28, -v232
  v_fma_f32 v231, v135, s28, -v232
  v_exp_f32 v230, v230
  v_exp_f32 v231, v231
  s_nop 0
  v_add_f32 v236, v236, v230
  v_add_f32 v236, v236, v231
  v_cvt_pk_bf16_f32 v195, v230, v231
  v_fma_f32 v224, v136, s28, -v232
  v_fma_f32 v225, v137, s28, -v232
  v_exp_f32 v224, v224
  v_exp_f32 v225, v225
  s_nop 0
  v_add_f32 v236, v236, v224
  v_add_f32 v236, v236, v225
  v_cvt_pk_bf16_f32 v196, v224, v225
  v_fma_f32 v226, v138, s28, -v232
  v_fma_f32 v227, v139, s28, -v232
  v_exp_f32 v226, v226
  v_exp_f32 v227, v227
  s_nop 0
  v_add_f32 v236, v236, v226
  v_add_f32 v236, v236, v227
  v_cvt_pk_bf16_f32 v197, v226, v227
  v_fma_f32 v228, v140, s28, -v232
  v_fma_f32 v229, v141, s28, -v232
  v_exp_f32 v228, v228
  v_exp_f32 v229, v229
  s_nop 0
  v_add_f32 v236, v236, v228
  v_add_f32 v236, v236, v229
  v_cvt_pk_bf16_f32 v198, v228, v229
  v_fma_f32 v230, v142, s28, -v232
  v_fma_f32 v231, v143, s28, -v232
  v_exp_f32 v230, v230
  v_exp_f32 v231, v231
  s_nop 0
  v_add_f32 v236, v236, v230
  v_add_f32 v236, v236, v231
  v_cvt_pk_bf16_f32 v199, v230, v231
  v_max3_f32 v224, v144, v145, v146
  v_max3_f32 v224, v224, v147, v148
  v_max3_f32 v224, v224, v149, v150
  v_max3_f32 v224, v224, v151, v152
  v_max3_f32 v224, v224, v153, v154
  v_max3_f32 v224, v224, v155, v156
  v_max3_f32 v224, v224, v157, v158
  v_max_f32 v224, v224, v159
  v_mov_b32 v225, v224
  s_nop 1
  v_permlane32_swap_b32 v224, v225
  v_max_f32 v224, v224, v225
  v_mul_f32 v224, s28, v224
  v_max_f32 v224, v224, v233
  v_sub_f32 v226, v233, v224
  v_exp_f32 v226, v226
  v_mov_b32 v233, v224
  s_nop 0
  v_mul_f32 v235, v235, v226
  v_mul_f32 v64, v64, v226
  v_mul_f32 v65, v65, v226
  v_mul_f32 v66, v66, v226
  v_mul_f32 v67, v67, v226
  v_mul_f32 v68, v68, v226
  v_mul_f32 v69, v69, v226
  v_mul_f32 v70, v70, v226
  v_mul_f32 v71, v71, v226
  v_mul_f32 v72, v72, v226
  v_mul_f32 v73, v73, v226
  v_mul_f32 v74, v74, v226
  v_mul_f32 v75, v75, v226
  v_mul_f32 v76, v76, v226
  v_mul_f32 v77, v77, v226
  v_mul_f32 v78, v78, v226
  v_mul_f32 v79, v79, v226
  v_mul_f32 v80, v80, v226
  v_mul_f32 v81, v81, v226
  v_mul_f32 v82, v82, v226
  v_mul_f32 v83, v83, v226
  v_mul_f32 v84, v84, v226
  v_mul_f32 v85, v85, v226
  v_mul_f32 v86, v86, v226
  v_mul_f32 v87, v87, v226
  v_mul_f32 v88, v88, v226
  v_mul_f32 v89, v89, v226
  v_mul_f32 v90, v90, v226
  v_mul_f32 v91, v91, v226
  v_mul_f32 v92, v92, v226
  v_mul_f32 v93, v93, v226
  v_mul_f32 v94, v94, v226
  v_mul_f32 v95, v95, v226
  v_mul_f32 v96, v96, v226
  v_mul_f32 v97, v97, v226
  v_mul_f32 v98, v98, v226
  v_mul_f32 v99, v99, v226
  v_mul_f32 v100, v100, v226
  v_mul_f32 v101, v101, v226
  v_mul_f32 v102, v102, v226
  v_mul_f32 v103, v103, v226
  v_mul_f32 v104, v104, v226
  v_mul_f32 v105, v105, v226
  v_mul_f32 v106, v106, v226
  v_mul_f32 v107, v107, v226
  v_mul_f32 v108, v108, v226
  v_mul_f32 v109, v109, v226
  v_mul_f32 v110, v110, v226
  v_mul_f32 v111, v111, v226
  v_mul_f32 v112, v112, v226
  v_mul_f32 v113, v113, v226
  v_mul_f32 v114, v114, v226
  v_mul_f32 v115, v115, v226
  v_mul_f32 v116, v116, v226
  v_mul_f32 v117, v117, v226
  v_mul_f32 v118, v118, v226
  v_mul_f32 v119, v119, v226
  v_mul_f32 v120, v120, v226
  v_mul_f32 v121, v121, v226
  v_mul_f32 v122, v122, v226
  v_mul_f32 v123, v123, v226
  v_mul_f32 v124, v124, v226
  v_mul_f32 v125, v125, v226
  v_mul_f32 v126, v126, v226
  v_mul_f32 v127, v127, v226
  v_fma_f32 v224, v144, s28, -v233
  v_fma_f32 v225, v145, s28, -v233
  v_exp_f32 v224, v224
  v_exp_f32 v225, v225
  s_nop 0
  v_add_f32 v237, v224, v225
  v_cvt_pk_bf16_f32 v200, v224, v225
  v_fma_f32 v226, v146, s28, -v233
  v_fma_f32 v227, v147, s28, -v233
  v_exp_f32 v226, v226
  v_exp_f32 v227, v227
  s_nop 0
  v_add_f32 v237, v237, v226
  v_add_f32 v237, v237, v227
  v_cvt_pk_bf16_f32 v201, v226, v227
  v_fma_f32 v228, v148, s28, -v233
  v_fma_f32 v229, v149, s28, -v233
  v_exp_f32 v228, v228
  v_exp_f32 v229, v229
  s_nop 0
  v_add_f32 v237, v237, v228
  v_add_f32 v237, v237, v229
  v_cvt_pk_bf16_f32 v202, v228, v229
  v_fma_f32 v230, v150, s28, -v233
  v_fma_f32 v231, v151, s28, -v233
  v_exp_f32 v230, v230
  v_exp_f32 v231, v231
  s_nop 0
  v_add_f32 v237, v237, v230
  v_add_f32 v237, v237, v231
  v_cvt_pk_bf16_f32 v203, v230, v231
  v_fma_f32 v224, v152, s28, -v233
  v_fma_f32 v225, v153, s28, -v233
  v_exp_f32 v224, v224
  v_exp_f32 v225, v225
  s_nop 0
  v_add_f32 v237, v237, v224
  v_add_f32 v237, v237, v225
  v_cvt_pk_bf16_f32 v204, v224, v225
  v_fma_f32 v226, v154, s28, -v233
  v_fma_f32 v227, v155, s28, -v233
  v_exp_f32 v226, v226
  v_exp_f32 v227, v227
  s_nop 0
  v_add_f32 v237, v237, v226
  v_add_f32 v237, v237, v227
  v_cvt_pk_bf16_f32 v205, v226, v227
  v_fma_f32 v228, v156, s28, -v233
  v_fma_f32 v229, v157, s28, -v233
  v_exp_f32 v228, v228
  v_exp_f32 v229, v229
  s_nop 0
  v_add_f32 v237, v237, v228
  v_add_f32 v237, v237, v229
  v_cvt_pk_bf16_f32 v206, v228, v229
  v_fma_f32 v230, v158, s28, -v233
  v_fma_f32 v231, v159, s28, -v233
  v_exp_f32 v230, v230
  v_exp_f32 v231, v231
  s_nop 0
  v_add_f32 v237, v237, v230
  v_add_f32 v237, v237, v231
  v_cvt_pk_bf16_f32 v207, v230, v231
  s_nop 1
  s_branch RET_12
RARE_13:
  s_nop 7
  s_nop 7
  v_max3_f32 v224, v160, v161, v162
  v_max3_f32 v224, v224, v163, v164
  v_max3_f32 v224, v224, v165, v166
  v_max3_f32 v224, v224, v167, v168
  v_max3_f32 v224, v224, v169, v170
  v_max3_f32 v224, v224, v171, v172
  v_max3_f32 v224, v224, v173, v174
  v_max_f32 v224, v224, v175
  v_mov_b32 v225, v224
  s_nop 1
  v_permlane32_swap_b32 v224, v225
  v_max_f32 v224, v224, v225
  v_mul_f32 v224, s28, v224
  v_max_f32 v224, v224, v232
  v_sub_f32 v226, v232, v224
  v_exp_f32 v226, v226
  v_mov_b32 v232, v224
  s_nop 0
  v_mul_f32 v234, v234, v226
  v_mul_f32 v0, v0, v226
  v_mul_f32 v1, v1, v226
  v_mul_f32 v2, v2, v226
  v_mul_f32 v3, v3, v226
  v_mul_f32 v4, v4, v226
  v_mul_f32 v5, v5, v226
  v_mul_f32 v6, v6, v226
  v_mul_f32 v7, v7, v226
  v_mul_f32 v8, v8, v226
  v_mul_f32 v9, v9, v226
  v_mul_f32 v10, v10, v226
  v_mul_f32 v11, v11, v226
  v_mul_f32 v12, v12, v226
  v_mul_f32 v13, v13, v226
  v_mul_f32 v14, v14, v226
  v_mul_f32 v15, v15, v226
  v_mul_f32 v16, v16, v226
  v_mul_f32 v17, v17, v226
  v_mul_f32 v18, v18, v226
  v_mul_f32 v19, v19, v226
  v_mul_f32 v20, v20, v226
  v_mul_f32 v21, v21, v226
  v_mul_f32 v22, v22, v226
  v_mul_f32 v23, v23, v226
  v_mul_f32 v24, v24, v226
  v_mul_f32 v25, v25, v226
  v_mul_f32 v26, v26, v226
  v_mul_f32 v27, v27, v226
  v_mul_f32 v28, v28, v226
  v_mul_f32 v29, v29, v226
  v_mul_f32 v30, v30, v226
  v_mul_f32 v31, v31, v226
  v_mul_f32 v32, v32, v226
  v_mul_f32 v33, v33, v226
  v_mul_f32 v34, v34, v226
  v_mul_f32 v35, v35, v226
  v_mul_f32 v36, v36, v226
  v_mul_f32 v37, v37, v226
  v_mul_f32 v38, v38, v226
  v_mul_f32 v39, v39, v226
  v_mul_f32 v40, v40, v226
  v_mul_f32 v41, v41, v226
  v_mul_f32 v42, v42, v226
  v_mul_f32 v43, v43, v226
  v_mul_f32 v44, v44, v226
  v_mul_f32 v45, v45, v226
  v_mul_f32 v46, v46, v226
  v_mul_f32 v47, v47, v226
  v_mul_f32 v48, v48, v226
  v_mul_f32 v49, v49, v226
  v_mul_f32 v50, v50, v226
  v_mul_f32 v51, v51, v226
  v_mul_f32 v52, v52, v226
  v_mul_f32 v53, v53, v226
  v_mul_f32 v54, v54, v226
  v_mul_f32 v55, v55, v226
  v_mul_f32 v56, v56, v226
  v_mul_f32 v57, v57, v226
  v_mul_f32 v58, v58, v226
  v_mul_f32 v59, v59, v226
  v_mul_f32 v60, v60, v226
  v_mul_f32 v61, v61, v226
  v_mul_f32 v62, v62, v226
  v_mul_f32 v63, v63, v226
  v_fma_f32 v224, v160, s28, -v232
  v_fma_f32 v225, v161, s28, -v232
  v_exp_f32 v224, v224
  v_exp_f32 v225, v225
  s_nop 0
  v_add_f32 v236, v224, v225
  v_cvt_pk_bf16_f32 v208, v224, v225
  v_fma_f32 v226, v162, s28, -v232
  v_fma_f32 v227, v163, s28, -v232
  v_exp_f32 v226, v226
  v_exp_f32 v227, v227
  s_nop 0
  v_add_f32 v236, v236, v226
  v_add_f32 v236, v236, v227
  v_cvt_pk_bf16_f32 v209, v226, v227
  v_fma_f32 v228, v164, s28, -v232
  v_fma_f32 v229, v165, s28, -v232
  v_exp_f32 v228, v228
  v_exp_f32 v229, v229
  s_nop 0
  v_add_f32 v236, v236, v228
  v_add_f32 v236, v236, v229
  v_cvt_pk_bf16_f32 v210, v228, v229
  v_fma_f32 v230, v166, s28, -v232
  v_fma_f32 v231, v167, s28, -v232
  v_exp_f32 v230, v230
  v_exp_f32 v231, v231
  s_nop 0
  v_add_f32 v236, v236, v230
  v_add_f32 v236, v236, v231
  v_cvt_pk_bf16_f32 v211, v230, v231
  v_fma_f32 v224, v168, s28, -v232
  v_fma_f32 v225, v169, s28, -v232
  v_exp_f32 v224, v224
  v_exp_f32 v225, v225
  s_nop 0
  v_add_f32 v236, v236, v224
  v_add_f32 v236, v236, v225
  v_cvt_pk_bf16_f32 v212, v224, v225
  v_fma_f32 v226, v170, s28, -v232
  v_fma_f32 v227, v171, s28, -v232
  v_exp_f32 v226, v226
  v_exp_f32 v227, v227
  s_nop 0
  v_add_f32 v236, v236, v226
  v_add_f32 v236, v236, v227
  v_cvt_pk_bf16_f32 v213, v226, v227
  v_fma_f32 v228, v172, s28, -v232
  v_fma_f32 v229, v173, s28, -v232
  v_exp_f32 v228, v228
  v_exp_f32 v229, v229
  s_nop 0
  v_add_f32 v236, v236, v228
  v_add_f32 v236, v236, v229
  v_cvt_pk_bf16_f32 v214, v228, v229
  v_fma_f32 v230, v174, s28, -v232
  v_fma_f32 v231, v175, s28, -v232
  v_exp_f32 v230, v230
  v_exp_f32 v231, v231
  s_nop 0
  v_add_f32 v236, v236, v230
  v_add_f32 v236, v236, v231
  v_cvt_pk_bf16_f32 v215, v230, v231
  v_max3_f32 v224, v176, v177, v178
  v_max3_f32 v224, v224, v179, v180
  v_max3_f32 v224, v224, v181, v182
  v_max3_f32 v224, v224, v183, v184
  v_max3_f32 v224, v224, v185, v186
  v_max3_f32 v224, v224, v187, v188
  v_max3_f32 v224, v224, v189, v190
  v_max_f32 v224, v224, v191
  v_mov_b32 v225, v224
  s_nop 1
  v_permlane32_swap_b32 v224, v225
  v_max_f32 v224, v224, v225
  v_mul_f32 v224, s28, v224
  v_max_f32 v224, v224, v233
  v_sub_f32 v226, v233, v224
  v_exp_f32 v226, v226
  v_mov_b32 v233, v224
  s_nop 0
  v_mul_f32 v235, v235, v226
  v_mul_f32 v64, v64, v226
  v_mul_f32 v65, v65, v226
  v_mul_f32 v66, v66, v226
  v_mul_f32 v67, v67, v226
  v_mul_f32 v68, v68, v226
  v_mul_f32 v69, v69, v226
  v_mul_f32 v70, v70, v226
  v_mul_f32 v71, v71, v226
  v_mul_f32 v72, v72, v226
  v_mul_f32 v73, v73, v226
  v_mul_f32 v74, v74, v226
  v_mul_f32 v75, v75, v226
  v_mul_f32 v76, v76, v226
  v_mul_f32 v77, v77, v226
  v_mul_f32 v78, v78, v226
  v_mul_f32 v79, v79, v226
  v_mul_f32 v80, v80, v226
  v_mul_f32 v81, v81, v226
  v_mul_f32 v82, v82, v226
  v_mul_f32 v83, v83, v226
  v_mul_f32 v84, v84, v226
  v_mul_f32 v85, v85, v226
  v_mul_f32 v86, v86, v226
  v_mul_f32 v87, v87, v226
  v_mul_f32 v88, v88, v226
  v_mul_f32 v89, v89, v226
  v_mul_f32 v90, v90, v226
  v_mul_f32 v91, v91, v226
  v_mul_f32 v92, v92, v226
  v_mul_f32 v93, v93, v226
  v_mul_f32 v94, v94, v226
  v_mul_f32 v95, v95, v226
  v_mul_f32 v96, v96, v226
  v_mul_f32 v97, v97, v226
  v_mul_f32 v98, v98, v226
  v_mul_f32 v99, v99, v226
  v_mul_f32 v100, v100, v226
  v_mul_f32 v101, v101, v226
  v_mul_f32 v102, v102, v226
  v_mul_f32 v103, v103, v226
  v_mul_f32 v104, v104, v226
  v_mul_f32 v105, v105, v226
  v_mul_f32 v106, v106, v226
  v_mul_f32 v107, v107, v226
  v_mul_f32 v108, v108, v226
  v_mul_f32 v109, v109, v226
  v_mul_f32 v110, v110, v226
  v_mul_f32 v111, v111, v226
  v_mul_f32 v112, v112, v226
  v_mul_f32 v113, v113, v226
  v_mul_f32 v114, v114, v226
  v_mul_f32 v115, v115, v226
  v_mul_f32 v116, v116, v226
  v_mul_f32 v117, v117, v226
  v_mul_f32 v118, v118, v226
  v_mul_f32 v119, v119, v226
  v_mul_f32 v120, v120, v226
  v_mul_f32 v121, v121, v226
  v_mul_f32 v122, v122, v226
  v_mul_f32 v123, v123, v226
  v_mul_f32 v124, v124, v226
  v_mul_f32 v125, v125, v226
  v_mul_f32 v126, v126, v226
  v_mul_f32 v127, v127, v226
  v_fma_f32 v224, v176, s28, -v233
  v_fma_f32 v225, v177, s28, -v233
  v_exp_f32 v224, v224
  v_exp_f32 v225, v225
  s_nop 0
  v_add_f32 v237, v224, v225
  v_cvt_pk_bf16_f32 v216, v224, v225
  v_fma_f32 v226, v178, s28, -v233
  v_fma_f32 v227, v179, s28, -v233
  v_exp_f32 v226, v226
  v_exp_f32 v227, v227
  s_nop 0
  v_add_f32 v237, v237, v226
  v_add_f32 v237, v237, v227
  v_cvt_pk_bf16_f32 v217, v226, v227
  v_fma_f32 v228, v180, s28, -v233
  v_fma_f32 v229, v181, s28, -v233
  v_exp_f32 v228, v228
  v_exp_f32 v229, v229
  s_nop 0
  v_add_f32 v237, v237, v228
  v_add_f32 v237, v237, v229
  v_cvt_pk_bf16_f32 v218, v228, v229
  v_fma_f32 v230, v182, s28, -v233
  v_fma_f32 v231, v183, s28, -v233
  v_exp_f32 v230, v230
  v_exp_f32 v231, v231
  s_nop 0
  v_add_f32 v237, v237, v230
  v_add_f32 v237, v237, v231
  v_cvt_pk_bf16_f32 v219, v230, v231
  v_fma_f32 v224, v184, s28, -v233
  v_fma_f32 v225, v185, s28, -v233
  v_exp_f32 v224, v224
  v_exp_f32 v225, v225
  s_nop 0
  v_add_f32 v237, v237, v224
  v_add_f32 v237, v237, v225
  v_cvt_pk_bf16_f32 v220, v224, v225
  v_fma_f32 v226, v186, s28, -v233
  v_fma_f32 v227, v187, s28, -v233
  v_exp_f32 v226, v226
  v_exp_f32 v227, v227
  s_nop 0
  v_add_f32 v237, v237, v226
  v_add_f32 v237, v237, v227
  v_cvt_pk_bf16_f32 v221, v226, v227
  v_fma_f32 v228, v188, s28, -v233
  v_fma_f32 v229, v189, s28, -v233
  v_exp_f32 v228, v228
  v_exp_f32 v229, v229
  s_nop 0
  v_add_f32 v237, v237, v228
  v_add_f32 v237, v237, v229
  v_cvt_pk_bf16_f32 v222, v228, v229
  v_fma_f32 v230, v190, s28, -v233
  v_fma_f32 v231, v191, s28, -v233
  v_exp_f32 v230, v230
  v_exp_f32 v231, v231
  s_nop 0
  v_add_f32 v237, v237, v230
  v_add_f32 v237, v237, v231
  v_cvt_pk_bf16_f32 v223, v230, v231
  s_nop 1
  s_branch RET_13
RARE_14:
  s_nop 7
  s_nop 7
  v_max3_f32 v224, v128, v129, v130
  v_max3_f32 v224, v224, v131, v132
  v_max3_f32 v224, v224, v133, v134
  v_max3_f32 v224, v224, v135, v136
  v_max3_f32 v224, v224, v137, v138
  v_max3_f32 v224, v224, v139, v140
  v_max3_f32 v224, v224, v141, v142
  v_max_f32 v224, v224, v143
  v_mov_b32 v225, v224
  s_nop 1
  v_permlane32_swap_b32 v224, v225
  v_max_f32 v224, v224, v225
  v_mul_f32 v224, s28, v224
  v_max_f32 v224, v224, v232
  v_sub_f32 v226, v232, v224
  v_exp_f32 v226, v226
  v_mov_b32 v232, v224
  s_nop 0
  v_mul_f32 v234, v234, v226
  v_mul_f32 v0, v0, v226
  v_mul_f32 v1, v1, v226
  v_mul_f32 v2, v2, v226
  v_mul_f32 v3, v3, v226
  v_mul_f32 v4, v4, v226
  v_mul_f32 v5, v5, v226
  v_mul_f32 v6, v6, v226
  v_mul_f32 v7, v7, v226
  v_mul_f32 v8, v8, v226
  v_mul_f32 v9, v9, v226
  v_mul_f32 v10, v10, v226
  v_mul_f32 v11, v11, v226
  v_mul_f32 v12, v12, v226
  v_mul_f32 v13, v13, v226
  v_mul_f32 v14, v14, v226
  v_mul_f32 v15, v15, v226
  v_mul_f32 v16, v16, v226
  v_mul_f32 v17, v17, v226
  v_mul_f32 v18, v18, v226
  v_mul_f32 v19, v19, v226
  v_mul_f32 v20, v20, v226
  v_mul_f32 v21, v21, v226
  v_mul_f32 v22, v22, v226
  v_mul_f32 v23, v23, v226
  v_mul_f32 v24, v24, v226
  v_mul_f32 v25, v25, v226
  v_mul_f32 v26, v26, v226
  v_mul_f32 v27, v27, v226
  v_mul_f32 v28, v28, v226
  v_mul_f32 v29, v29, v226
  v_mul_f32 v30, v30, v226
  v_mul_f32 v31, v31, v226
  v_mul_f32 v32, v32, v226
  v_mul_f32 v33, v33, v226
  v_mul_f32 v34, v34, v226
  v_mul_f32 v35, v35, v226
  v_mul_f32 v36, v36, v226
  v_mul_f32 v37, v37, v226
  v_mul_f32 v38, v38, v226
  v_mul_f32 v39, v39, v226
  v_mul_f32 v40, v40, v226
  v_mul_f32 v41, v41, v226
  v_mul_f32 v42, v42, v226
  v_mul_f32 v43, v43, v226
  v_mul_f32 v44, v44, v226
  v_mul_f32 v45, v45, v226
  v_mul_f32 v46, v46, v226
  v_mul_f32 v47, v47, v226
  v_mul_f32 v48, v48, v226
  v_mul_f32 v49, v49, v226
  v_mul_f32 v50, v50, v226
  v_mul_f32 v51, v51, v226
  v_mul_f32 v52, v52, v226
  v_mul_f32 v53, v53, v226
  v_mul_f32 v54, v54, v226
  v_mul_f32 v55, v55, v226
  v_mul_f32 v56, v56, v226
  v_mul_f32 v57, v57, v226
  v_mul_f32 v58, v58, v226
  v_mul_f32 v59, v59, v226
  v_mul_f32 v60, v60, v226
  v_mul_f32 v61, v61, v226
  v_mul_f32 v62, v62, v226
  v_mul_f32 v63, v63, v226
  v_fma_f32 v224, v128, s28, -v232
  v_fma_f32 v225, v129, s28, -v232
  v_exp_f32 v224, v224
  v_exp_f32 v225, v225
  s_nop 0
  v_add_f32 v236, v224, v225
  v_cvt_pk_bf16_f32 v192, v224, v225
  v_fma_f32 v226, v130, s28, -v232
  v_fma_f32 v227, v131, s28, -v232
  v_exp_f32 v226, v226
  v_exp_f32 v227, v227
  s_nop 0
  v_add_f32 v236, v236, v226
  v_add_f32 v236, v236, v227
  v_cvt_pk_bf16_f32 v193, v226, v227
  v_fma_f32 v228, v132, s28, -v232
  v_fma_f32 v229, v133, s28, -v232
  v_exp_f32 v228, v228
  v_exp_f32 v229, v229
  s_nop 0
  v_add_f32 v236, v236, v228
  v_add_f32 v236, v236, v229
  v_cvt_pk_bf16_f32 v194, v228, v229
  v_fma_f32 v230, v134, s28, -v232
  v_fma_f32 v231, v135, s28, -v232
  v_exp_f32 v230, v230
  v_exp_f32 v231, v231
  s_nop 0
  v_add_f32 v236, v236, v230
  v_add_f32 v236, v236, v231
  v_cvt_pk_bf16_f32 v195, v230, v231
  v_fma_f32 v224, v136, s28, -v232
  v_fma_f32 v225, v137, s28, -v232
  v_exp_f32 v224, v224
  v_exp_f32 v225, v225
  s_nop 0
  v_add_f32 v236, v236, v224
  v_add_f32 v236, v236, v225
  v_cvt_pk_bf16_f32 v196, v224, v225
  v_fma_f32 v226, v138, s28, -v232
  v_fma_f32 v227, v139, s28, -v232
  v_exp_f32 v226, v226
  v_exp_f32 v227, v227
  s_nop 0
  v_add_f32 v236, v236, v226
  v_add_f32 v236, v236, v227
  v_cvt_pk_bf16_f32 v197, v226, v227
  v_fma_f32 v228, v140, s28, -v232
  v_fma_f32 v229, v141, s28, -v232
  v_exp_f32 v228, v228
  v_exp_f32 v229, v229
  s_nop 0
  v_add_f32 v236, v236, v228
  v_add_f32 v236, v236, v229
  v_cvt_pk_bf16_f32 v198, v228, v229
  v_fma_f32 v230, v142, s28, -v232
  v_fma_f32 v231, v143, s28, -v232
  v_exp_f32 v230, v230
  v_exp_f32 v231, v231
  s_nop 0
  v_add_f32 v236, v236, v230
  v_add_f32 v236, v236, v231
  v_cvt_pk_bf16_f32 v199, v230, v231
  v_max3_f32 v224, v144, v145, v146
  v_max3_f32 v224, v224, v147, v148
  v_max3_f32 v224, v224, v149, v150
  v_max3_f32 v224, v224, v151, v152
  v_max3_f32 v224, v224, v153, v154
  v_max3_f32 v224, v224, v155, v156
  v_max3_f32 v224, v224, v157, v158
  v_max_f32 v224, v224, v159
  v_mov_b32 v225, v224
  s_nop 1
  v_permlane32_swap_b32 v224, v225
  v_max_f32 v224, v224, v225
  v_mul_f32 v224, s28, v224
  v_max_f32 v224, v224, v233
  v_sub_f32 v226, v233, v224
  v_exp_f32 v226, v226
  v_mov_b32 v233, v224
  s_nop 0
  v_mul_f32 v235, v235, v226
  v_mul_f32 v64, v64, v226
  v_mul_f32 v65, v65, v226
  v_mul_f32 v66, v66, v226
  v_mul_f32 v67, v67, v226
  v_mul_f32 v68, v68, v226
  v_mul_f32 v69, v69, v226
  v_mul_f32 v70, v70, v226
  v_mul_f32 v71, v71, v226
  v_mul_f32 v72, v72, v226
  v_mul_f32 v73, v73, v226
  v_mul_f32 v74, v74, v226
  v_mul_f32 v75, v75, v226
  v_mul_f32 v76, v76, v226
  v_mul_f32 v77, v77, v226
  v_mul_f32 v78, v78, v226
  v_mul_f32 v79, v79, v226
  v_mul_f32 v80, v80, v226
  v_mul_f32 v81, v81, v226
  v_mul_f32 v82, v82, v226
  v_mul_f32 v83, v83, v226
  v_mul_f32 v84, v84, v226
  v_mul_f32 v85, v85, v226
  v_mul_f32 v86, v86, v226
  v_mul_f32 v87, v87, v226
  v_mul_f32 v88, v88, v226
  v_mul_f32 v89, v89, v226
  v_mul_f32 v90, v90, v226
  v_mul_f32 v91, v91, v226
  v_mul_f32 v92, v92, v226
  v_mul_f32 v93, v93, v226
  v_mul_f32 v94, v94, v226
  v_mul_f32 v95, v95, v226
  v_mul_f32 v96, v96, v226
  v_mul_f32 v97, v97, v226
  v_mul_f32 v98, v98, v226
  v_mul_f32 v99, v99, v226
  v_mul_f32 v100, v100, v226
  v_mul_f32 v101, v101, v226
  v_mul_f32 v102, v102, v226
  v_mul_f32 v103, v103, v226
  v_mul_f32 v104, v104, v226
  v_mul_f32 v105, v105, v226
  v_mul_f32 v106, v106, v226
  v_mul_f32 v107, v107, v226
  v_mul_f32 v108, v108, v226
  v_mul_f32 v109, v109, v226
  v_mul_f32 v110, v110, v226
  v_mul_f32 v111, v111, v226
  v_mul_f32 v112, v112, v226
  v_mul_f32 v113, v113, v226
  v_mul_f32 v114, v114, v226
  v_mul_f32 v115, v115, v226
  v_mul_f32 v116, v116, v226
  v_mul_f32 v117, v117, v226
  v_mul_f32 v118, v118, v226
  v_mul_f32 v119, v119, v226
  v_mul_f32 v120, v120, v226
  v_mul_f32 v121, v121, v226
  v_mul_f32 v122, v122, v226
  v_mul_f32 v123, v123, v226
  v_mul_f32 v124, v124, v226
  v_mul_f32 v125, v125, v226
  v_mul_f32 v126, v126, v226
  v_mul_f32 v127, v127, v226
  v_fma_f32 v224, v144, s28, -v233
  v_fma_f32 v225, v145, s28, -v233
  v_exp_f32 v224, v224
  v_exp_f32 v225, v225
  s_nop 0
  v_add_f32 v237, v224, v225
  v_cvt_pk_bf16_f32 v200, v224, v225
  v_fma_f32 v226, v146, s28, -v233
  v_fma_f32 v227, v147, s28, -v233
  v_exp_f32 v226, v226
  v_exp_f32 v227, v227
  s_nop 0
  v_add_f32 v237, v237, v226
  v_add_f32 v237, v237, v227
  v_cvt_pk_bf16_f32 v201, v226, v227
  v_fma_f32 v228, v148, s28, -v233
  v_fma_f32 v229, v149, s28, -v233
  v_exp_f32 v228, v228
  v_exp_f32 v229, v229
  s_nop 0
  v_add_f32 v237, v237, v228
  v_add_f32 v237, v237, v229
  v_cvt_pk_bf16_f32 v202, v228, v229
  v_fma_f32 v230, v150, s28, -v233
  v_fma_f32 v231, v151, s28, -v233
  v_exp_f32 v230, v230
  v_exp_f32 v231, v231
  s_nop 0
  v_add_f32 v237, v237, v230
  v_add_f32 v237, v237, v231
  v_cvt_pk_bf16_f32 v203, v230, v231
  v_fma_f32 v224, v152, s28, -v233
  v_fma_f32 v225, v153, s28, -v233
  v_exp_f32 v224, v224
  v_exp_f32 v225, v225
  s_nop 0
  v_add_f32 v237, v237, v224
  v_add_f32 v237, v237, v225
  v_cvt_pk_bf16_f32 v204, v224, v225
  v_fma_f32 v226, v154, s28, -v233
  v_fma_f32 v227, v155, s28, -v233
  v_exp_f32 v226, v226
  v_exp_f32 v227, v227
  s_nop 0
  v_add_f32 v237, v237, v226
  v_add_f32 v237, v237, v227
  v_cvt_pk_bf16_f32 v205, v226, v227
  v_fma_f32 v228, v156, s28, -v233
  v_fma_f32 v229, v157, s28, -v233
  v_exp_f32 v228, v228
  v_exp_f32 v229, v229
  s_nop 0
  v_add_f32 v237, v237, v228
  v_add_f32 v237, v237, v229
  v_cvt_pk_bf16_f32 v206, v228, v229
  v_fma_f32 v230, v158, s28, -v233
  v_fma_f32 v231, v159, s28, -v233
  v_exp_f32 v230, v230
  v_exp_f32 v231, v231
  s_nop 0
  v_add_f32 v237, v237, v230
  v_add_f32 v237, v237, v231
  v_cvt_pk_bf16_f32 v207, v230, v231
  s_nop 1
  s_branch RET_14
RARE_15:
  s_nop 7
  s_nop 7
  v_max3_f32 v224, v160, v161, v162
  v_max3_f32 v224, v224, v163, v164
  v_max3_f32 v224, v224, v165, v166
  v_max3_f32 v224, v224, v167, v168
  v_max3_f32 v224, v224, v169, v170
  v_max3_f32 v224, v224, v171, v172
  v_max3_f32 v224, v224, v173, v174
  v_max_f32 v224, v224, v175
  v_mov_b32 v225, v224
  s_nop 1
  v_permlane32_swap_b32 v224, v225
  v_max_f32 v224, v224, v225
  v_mul_f32 v224, s28, v224
  v_max_f32 v224, v224, v232
  v_sub_f32 v226, v232, v224
  v_exp_f32 v226, v226
  v_mov_b32 v232, v224
  s_nop 0
  v_mul_f32 v234, v234, v226
  v_mul_f32 v0, v0, v226
  v_mul_f32 v1, v1, v226
  v_mul_f32 v2, v2, v226
  v_mul_f32 v3, v3, v226
  v_mul_f32 v4, v4, v226
  v_mul_f32 v5, v5, v226
  v_mul_f32 v6, v6, v226
  v_mul_f32 v7, v7, v226
  v_mul_f32 v8, v8, v226
  v_mul_f32 v9, v9, v226
  v_mul_f32 v10, v10, v226
  v_mul_f32 v11, v11, v226
  v_mul_f32 v12, v12, v226
  v_mul_f32 v13, v13, v226
  v_mul_f32 v14, v14, v226
  v_mul_f32 v15, v15, v226
  v_mul_f32 v16, v16, v226
  v_mul_f32 v17, v17, v226
  v_mul_f32 v18, v18, v226
  v_mul_f32 v19, v19, v226
  v_mul_f32 v20, v20, v226
  v_mul_f32 v21, v21, v226
  v_mul_f32 v22, v22, v226
  v_mul_f32 v23, v23, v226
  v_mul_f32 v24, v24, v226
  v_mul_f32 v25, v25, v226
  v_mul_f32 v26, v26, v226
  v_mul_f32 v27, v27, v226
  v_mul_f32 v28, v28, v226
  v_mul_f32 v29, v29, v226
  v_mul_f32 v30, v30, v226
  v_mul_f32 v31, v31, v226
  v_mul_f32 v32, v32, v226
  v_mul_f32 v33, v33, v226
  v_mul_f32 v34, v34, v226
  v_mul_f32 v35, v35, v226
  v_mul_f32 v36, v36, v226
  v_mul_f32 v37, v37, v226
  v_mul_f32 v38, v38, v226
  v_mul_f32 v39, v39, v226
  v_mul_f32 v40, v40, v226
  v_mul_f32 v41, v41, v226
  v_mul_f32 v42, v42, v226
  v_mul_f32 v43, v43, v226
  v_mul_f32 v44, v44, v226
  v_mul_f32 v45, v45, v226
  v_mul_f32 v46, v46, v226
  v_mul_f32 v47, v47, v226
  v_mul_f32 v48, v48, v226
  v_mul_f32 v49, v49, v226
  v_mul_f32 v50, v50, v226
  v_mul_f32 v51, v51, v226
  v_mul_f32 v52, v52, v226
  v_mul_f32 v53, v53, v226
  v_mul_f32 v54, v54, v226
  v_mul_f32 v55, v55, v226
  v_mul_f32 v56, v56, v226
  v_mul_f32 v57, v57, v226
  v_mul_f32 v58, v58, v226
  v_mul_f32 v59, v59, v226
  v_mul_f32 v60, v60, v226
  v_mul_f32 v61, v61, v226
  v_mul_f32 v62, v62, v226
  v_mul_f32 v63, v63, v226
  v_fma_f32 v224, v160, s28, -v232
  v_fma_f32 v225, v161, s28, -v232
  v_exp_f32 v224, v224
  v_exp_f32 v225, v225
  s_nop 0
  v_add_f32 v236, v224, v225
  v_cvt_pk_bf16_f32 v208, v224, v225
  v_fma_f32 v226, v162, s28, -v232
  v_fma_f32 v227, v163, s28, -v232
  v_exp_f32 v226, v226
  v_exp_f32 v227, v227
  s_nop 0
  v_add_f32 v236, v236, v226
  v_add_f32 v236, v236, v227
  v_cvt_pk_bf16_f32 v209, v226, v227
  v_fma_f32 v228, v164, s28, -v232
  v_fma_f32 v229, v165, s28, -v232
  v_exp_f32 v228, v228
  v_exp_f32 v229, v229
  s_nop 0
  v_add_f32 v236, v236, v228
  v_add_f32 v236, v236, v229
  v_cvt_pk_bf16_f32 v210, v228, v229
  v_fma_f32 v230, v166, s28, -v232
  v_fma_f32 v231, v167, s28, -v232
  v_exp_f32 v230, v230
  v_exp_f32 v231, v231
  s_nop 0
  v_add_f32 v236, v236, v230
  v_add_f32 v236, v236, v231
  v_cvt_pk_bf16_f32 v211, v230, v231
  v_fma_f32 v224, v168, s28, -v232
  v_fma_f32 v225, v169, s28, -v232
  v_exp_f32 v224, v224
  v_exp_f32 v225, v225
  s_nop 0
  v_add_f32 v236, v236, v224
  v_add_f32 v236, v236, v225
  v_cvt_pk_bf16_f32 v212, v224, v225
  v_fma_f32 v226, v170, s28, -v232
  v_fma_f32 v227, v171, s28, -v232
  v_exp_f32 v226, v226
  v_exp_f32 v227, v227
  s_nop 0
  v_add_f32 v236, v236, v226
  v_add_f32 v236, v236, v227
  v_cvt_pk_bf16_f32 v213, v226, v227
  v_fma_f32 v228, v172, s28, -v232
  v_fma_f32 v229, v173, s28, -v232
  v_exp_f32 v228, v228
  v_exp_f32 v229, v229
  s_nop 0
  v_add_f32 v236, v236, v228
  v_add_f32 v236, v236, v229
  v_cvt_pk_bf16_f32 v214, v228, v229
  v_fma_f32 v230, v174, s28, -v232
  v_fma_f32 v231, v175, s28, -v232
  v_exp_f32 v230, v230
  v_exp_f32 v231, v231
  s_nop 0
  v_add_f32 v236, v236, v230
  v_add_f32 v236, v236, v231
  v_cvt_pk_bf16_f32 v215, v230, v231
  v_max3_f32 v224, v176, v177, v178
  v_max3_f32 v224, v224, v179, v180
  v_max3_f32 v224, v224, v181, v182
  v_max3_f32 v224, v224, v183, v184
  v_max3_f32 v224, v224, v185, v186
  v_max3_f32 v224, v224, v187, v188
  v_max3_f32 v224, v224, v189, v190
  v_max_f32 v224, v224, v191
  v_mov_b32 v225, v224
  s_nop 1
  v_permlane32_swap_b32 v224, v225
  v_max_f32 v224, v224, v225
  v_mul_f32 v224, s28, v224
  v_max_f32 v224, v224, v233
  v_sub_f32 v226, v233, v224
  v_exp_f32 v226, v226
  v_mov_b32 v233, v224
  s_nop 0
  v_mul_f32 v235, v235, v226
  v_mul_f32 v64, v64, v226
  v_mul_f32 v65, v65, v226
  v_mul_f32 v66, v66, v226
  v_mul_f32 v67, v67, v226
  v_mul_f32 v68, v68, v226
  v_mul_f32 v69, v69, v226
  v_mul_f32 v70, v70, v226
  v_mul_f32 v71, v71, v226
  v_mul_f32 v72, v72, v226
  v_mul_f32 v73, v73, v226
  v_mul_f32 v74, v74, v226
  v_mul_f32 v75, v75, v226
  v_mul_f32 v76, v76, v226
  v_mul_f32 v77, v77, v226
  v_mul_f32 v78, v78, v226
  v_mul_f32 v79, v79, v226
  v_mul_f32 v80, v80, v226
  v_mul_f32 v81, v81, v226
  v_mul_f32 v82, v82, v226
  v_mul_f32 v83, v83, v226
  v_mul_f32 v84, v84, v226
  v_mul_f32 v85, v85, v226
  v_mul_f32 v86, v86, v226
  v_mul_f32 v87, v87, v226
  v_mul_f32 v88, v88, v226
  v_mul_f32 v89, v89, v226
  v_mul_f32 v90, v90, v226
  v_mul_f32 v91, v91, v226
  v_mul_f32 v92, v92, v226
  v_mul_f32 v93, v93, v226
  v_mul_f32 v94, v94, v226
  v_mul_f32 v95, v95, v226
  v_mul_f32 v96, v96, v226
  v_mul_f32 v97, v97, v226
  v_mul_f32 v98, v98, v226
  v_mul_f32 v99, v99, v226
  v_mul_f32 v100, v100, v226
  v_mul_f32 v101, v101, v226
  v_mul_f32 v102, v102, v226
  v_mul_f32 v103, v103, v226
  v_mul_f32 v104, v104, v226
  v_mul_f32 v105, v105, v226
  v_mul_f32 v106, v106, v226
  v_mul_f32 v107, v107, v226
  v_mul_f32 v108, v108, v226
  v_mul_f32 v109, v109, v226
  v_mul_f32 v110, v110, v226
  v_mul_f32 v111, v111, v226
  v_mul_f32 v112, v112, v226
  v_mul_f32 v113, v113, v226
  v_mul_f32 v114, v114, v226
  v_mul_f32 v115, v115, v226
  v_mul_f32 v116, v116, v226
  v_mul_f32 v117, v117, v226
  v_mul_f32 v118, v118, v226
  v_mul_f32 v119, v119, v226
  v_mul_f32 v120, v120, v226
  v_mul_f32 v121, v121, v226
  v_mul_f32 v122, v122, v226
  v_mul_f32 v123, v123, v226
  v_mul_f32 v124, v124, v226
  v_mul_f32 v125, v125, v226
  v_mul_f32 v126, v126, v226
  v_mul_f32 v127, v127, v226
  v_fma_f32 v224, v176, s28, -v233
  v_fma_f32 v225, v177, s28, -v233
  v_exp_f32 v224, v224
  v_exp_f32 v225, v225
  s_nop 0
  v_add_f32 v237, v224, v225
  v_cvt_pk_bf16_f32 v216, v224, v225
  v_fma_f32 v226, v178, s28, -v233
  v_fma_f32 v227, v179, s28, -v233
  v_exp_f32 v226, v226
  v_exp_f32 v227, v227
  s_nop 0
  v_add_f32 v237, v237, v226
  v_add_f32 v237, v237, v227
  v_cvt_pk_bf16_f32 v217, v226, v227
  v_fma_f32 v228, v180, s28, -v233
  v_fma_f32 v229, v181, s28, -v233
  v_exp_f32 v228, v228
  v_exp_f32 v229, v229
  s_nop 0
  v_add_f32 v237, v237, v228
  v_add_f32 v237, v237, v229
  v_cvt_pk_bf16_f32 v218, v228, v229
  v_fma_f32 v230, v182, s28, -v233
  v_fma_f32 v231, v183, s28, -v233
  v_exp_f32 v230, v230
  v_exp_f32 v231, v231
  s_nop 0
  v_add_f32 v237, v237, v230
  v_add_f32 v237, v237, v231
  v_cvt_pk_bf16_f32 v219, v230, v231
  v_fma_f32 v224, v184, s28, -v233
  v_fma_f32 v225, v185, s28, -v233
  v_exp_f32 v224, v224
  v_exp_f32 v225, v225
  s_nop 0
  v_add_f32 v237, v237, v224
  v_add_f32 v237, v237, v225
  v_cvt_pk_bf16_f32 v220, v224, v225
  v_fma_f32 v226, v186, s28, -v233
  v_fma_f32 v227, v187, s28, -v233
  v_exp_f32 v226, v226
  v_exp_f32 v227, v227
  s_nop 0
  v_add_f32 v237, v237, v226
  v_add_f32 v237, v237, v227
  v_cvt_pk_bf16_f32 v221, v226, v227
  v_fma_f32 v228, v188, s28, -v233
  v_fma_f32 v229, v189, s28, -v233
  v_exp_f32 v228, v228
  v_exp_f32 v229, v229
  s_nop 0
  v_add_f32 v237, v237, v228
  v_add_f32 v237, v237, v229
  v_cvt_pk_bf16_f32 v222, v228, v229
  v_fma_f32 v230, v190, s28, -v233
  v_fma_f32 v231, v191, s28, -v233
  v_exp_f32 v230, v230
  v_exp_f32 v231, v231
  s_nop 0
  v_add_f32 v237, v237, v230
  v_add_f32 v237, v237, v231
  v_cvt_pk_bf16_f32 v223, v230, v231
  s_nop 1
  s_branch RET_15
FIN:
  ds_read_b128 a[224:227], v216 offset:0
  ds_read_b128 a[228:231], v221 offset:1024
  ds_read_b128 a[232:235], v216 offset:2048
  ds_read_b128 a[236:239], v221 offset:3072
  ds_write_b128 v208, v[96:99] offset:4096
  ds_write_b128 v209, v[104:107] offset:4096
  ds_write_b128 v210, v[112:115] offset:4096
  ds_write_b128 v211, v[120:123] offset:4096
  ds_read_b128 a[240:243], v216 offset:4096
  ds_read_b128 a[244:247], v221 offset:5120
  ds_read_b128 a[248:251], v216 offset:6144
  ds_read_b128 a[252:255], v221 offset:7168
  s_waitcnt lgkmcnt(0)
  buffer_store_dwordx4 a[192:195], v255, s[16:19], s80 offen offset:0 nt
  buffer_store_dwordx4 a[208:211], v255, s[16:19], s80 offen offset:128 nt
  buffer_store_dwordx4 a[196:199], v255, s[16:19], s80 offen offset:2048 nt
  buffer_store_dwordx4 a[212:215], v255, s[16:19], s80 offen offset:2176 nt
  buffer_store_dwordx4 a[200:203], v255, s[16:19], s81 offen offset:0 nt
  buffer_store_dwordx4 a[216:219], v255, s[16:19], s81 offen offset:128 nt
  buffer_store_dwordx4 a[204:207], v255, s[16:19], s81 offen offset:2048 nt
  buffer_store_dwordx4 a[220:223], v255, s[16:19], s81 offen offset:2176 nt
  buffer_store_dwordx4 a[224:227], v255, s[16:19], s82 offen offset:0 nt
  buffer_store_dwordx4 a[240:243], v255, s[16:19], s82 offen offset:128 nt
  buffer_store_dwordx4 a[228:231], v255, s[16:19], s82 offen offset:2048 nt
  buffer_store_dwordx4 a[244:247], v255, s[16:19], s82 offen offset:2176 nt
  buffer_store_dwordx4 a[232:235], v255, s[16:19], s83 offen offset:0 nt
  buffer_store_dwordx4 a[248:251], v255, s[16:19], s83 offen offset:128 nt
  buffer_store_dwordx4 a[236:239], v255, s[16:19], s83 offen offset:2048 nt
  buffer_store_dwordx4 a[252:255], v255, s[16:19], s83 offen offset:2176 nt
DONE:
  s_endpgm
.section .rodata,"a"
.p2align 6
.amdhsa_kernel standalone__gqa_softmax__near_ridge_kernel
  .amdhsa_next_free_vgpr 512
  .amdhsa_next_free_sgpr 96
  .amdhsa_accum_offset 256
  .amdhsa_group_segment_fixed_size 0
  .amdhsa_kernarg_size 48
  .amdhsa_user_sgpr_count 2
  .amdhsa_user_sgpr_kernarg_segment_ptr 1
  .amdhsa_system_sgpr_workgroup_id_x 1
.end_amdhsa_kernel
```
